```python
import torch

def _softmax(x, axis=-1):
    return torch.softmax(x, dim=axis)
def _gelu(x):
    return torch.nn.functional.gelu(x, approximate="tanh")
def _silu(x):
    return torch.nn.functional.silu(x)
def _sigmoid(x):
    return torch.sigmoid(x)
def _layernorm(x, axis=-1, eps=1e-5):
    m = x.mean(dim=axis, keepdim=True)
    v = x.var(dim=axis, keepdim=True, unbiased=False)
    return (x - m) / torch.sqrt(v + eps)
def _scatter_add(tgt, idx, src, axis=0):
    return tgt.clone().index_add_(axis, idx, src)
def _segment_sum(src, seg, n):
    out = torch.zeros((n,) + src.shape[1:], dtype=src.dtype)
    return out.index_add_(0, seg, src)
def _pad(x, pw):
    flat = tuple(v for pair in reversed(pw) for v in pair)
    return torch.nn.functional.pad(x, flat)

kernel_name = 'parallel_sum__linear_attn_block__dense_activation_mish__prompt'

def setup_inputs():

    _w = (lambda a: (lambda t: t.to(torch.bfloat16) if t.is_floating_point() else t)(torch.as_tensor(a)))
    def _A_setup():
        B, S, D = 1, 2048, 512
        return {
            "x": _w((lambda *s: torch.randn(*s, dtype=torch.bfloat16) * 0.05)(B, S, D)),
            "wqkv": _w((lambda *s: torch.randn(*s, dtype=torch.bfloat16) * 0.1)(D, 3 * D)),
            "wo": _w((lambda *s: torch.randn(*s, dtype=torch.bfloat16) * 0.05)(D, D)),
        }
    _A_in = _A_setup()

    def _B_setup():
        B, S, D, F = 1, 2048, 512, 1792
        return {
            "x": _w((lambda *s: torch.randn(*s, dtype=torch.bfloat16) * 0.05)(B, S, D)),
            "w1": _w((lambda *s: torch.randn(*s, dtype=torch.bfloat16) * 0.8)(D, F) * (D ** -0.5)),
            "b1": _w((lambda *s: torch.randn(*s, dtype=torch.bfloat16) * 0.4)(F)),
            "w2": _w((lambda *s: torch.randn(*s, dtype=torch.bfloat16) * 0.1)(F, D) * (F ** -0.5)),
        }
    _B_in = _B_setup()

    return {
        "A_x": _A_in["x"],
        "A_wqkv": _A_in["wqkv"],
        "A_wo": _A_in["wo"],
        "B_x": _B_in["x"],
        "B_w1": _B_in["w1"],
        "B_b1": _B_in["b1"],
        "B_w2": _B_in["w2"],
    }

def reference(A_x, A_wqkv, A_wo, B_x, B_w1, B_b1, B_w2):
    def _A_ref(x, wqkv, wo):
        B, S, D = x.shape
        H = 32; Dh = D // H
        qkv = (lambda x, *d: x.permute(*d))((x @ wqkv).reshape(B, S, 3, H, Dh), 2, 0, 3, 1, 4)
        q, k, v = qkv[0], qkv[1], qkv[2]
        phi = lambda t: torch.where(t > 0, t + 1, torch.exp(t)) + 1e-6
        pq, pk = phi(q), phi(k)
        kv = torch.einsum("bhsd,bhse->bhde", pk, v)
        z = torch.einsum("bhsd->bhd", pk)
        num = torch.einsum("bhqd,bhde->bhqe", pq, kv)
        den = torch.einsum("bhqd,bhd->bhq", pq, z)[..., None] + 1e-6
        o = num / den
        return (lambda x, *d: x.permute(*d))(o, 0, 2, 1, 3).reshape(B, S, D) @ wo

    def _B_ref(x, w1, b1, w2):
        h = torch.einsum("bsd,df->bsf", x, w1) + b1
        sp = torch.log1p(torch.exp(-torch.abs(h))) + torch.where(h > 0, h, torch.zeros_like(h))
        act = h * torch.tanh(sp)
        return torch.einsum("bsf,fd->bsd", act, w2)

    x = A_x
    xn = _layernorm(x, axis=-1)
    return x + _A_ref(xn, A_wqkv, A_wo) + _B_ref(xn, B_w1, B_b1, B_w2)
```

```asm
; @launch grid=(256,1,1) block=(512,1,1) lds=163456
.amdgcn_target "amdgcn-amd-amdhsa--gfx950"
.text
.globl parallel_sum__linear_attn_block__dense_activation_mish__prompt_kernel
.p2align 12
.p2align 8
.type parallel_sum__linear_attn_block__dense_activation_mish__prompt_kernel,@function
parallel_sum__linear_attn_block__dense_activation_mish__prompt_kernel:
  s_cmp_ge_u32 s2, 256
  s_cbranch_scc1 L_end
  s_load_dwordx16 s[36:51], s[0:1], 0
  s_load_dwordx4 s[52:55], s[0:1], 64
  v_lshrrev_b32 v1, 6, v0
  v_and_b32 v0, 63, v0
  s_and_b32 s64, s2, 7
  s_lshr_b32 s65, s2, 3
  s_getpc_b64 s[68:69]
L_pc:
  s_mul_i32 s66, s65, 2048
  v_mad_u32_u24 v2, v1, 2, v0
  v_lshl_add_u32 v2, v2, 7, s66
  v_and_b32 v2, 0xffff, v2
  v_min_u32 v2, L_code_end-L_pc-4, v2
  s_mov_b64 exec, 3
  global_load_dword v255, v2, s[68:69]
  s_mov_b64 exec, -1
  v_readfirstlane_b32 s56, v1
  s_lshr_b32 s57, s64, 2
  s_lshl_b32 s57, s57, 3
  s_lshr_b32 s66, s65, 2
  s_add_u32 s57, s57, s66
  s_and_b32 s62, s64, 3
  s_lshl_b32 s62, s62, 1
  s_and_b32 s66, s65, 1
  s_add_u32 s58, s62, s66
  s_bfe_u32 s59, s65, 0x10001
  s_lshl_b32 s66, s57, 1
  s_add_u32 s62, s62, s66
  s_and_b32 s62, s62, 7
  s_cmp_lt_u32 s56, 4
  s_cbranch_scc1 L_p1
  s_sub_u32 s78, s56, 4
  v_lshrrev_b32 v70, 3, v0
  v_and_b32 v71, 7, v0
  v_lshrrev_b32 v72, 1, v70
  v_xor_b32 v72, v72, v71
  s_lshl_b32 s64, s57, 7
  s_lshl_b32 s65, s78, 5
  s_add_u32 s64, s64, s65
  v_add_u32 v73, s64, v70
  v_lshlrev_b32 v73, 10, v73
  v_lshl_add_u32 v16, v72, 4, v73
  v_xor_b32 v74, 64, v16
  v_add_u32 v17, 7168, v74
  v_add_u32 v18, 14336, v16
  v_add_u32 v19, 21504, v74
  s_lshl_b32 s82, s78, 12
  s_mul_i32 s35, s56, 336
  s_add_u32 s35, s35, 147456
  v_lshl_add_u32 v2, v0, 2, s35
  v_mov_b32 v15, 0x40000000
  ds_write_b32 v2, v15
  s_add_u32 s64, s62, 0
  s_and_b32 s64, s64, 7
  s_add_u32 m0, s82, 16384
  s_lshl_b32 s64, s64, 7
  s_mov_b32 s6, 0x200000
  s_mov_b32 s7, 0x20000
  s_waitcnt lgkmcnt(0)
  s_mov_b64 s[4:5], s[36:37]
  buffer_load_dwordx4 v16, s[4:7], s64 offen offset:0 lds
  buffer_load_dwordx4 v17, s[4:7], s64 offen offset:1024 lds
  buffer_load_dwordx4 v18, s[4:7], s64 offen offset:2048 lds
  buffer_load_dwordx4 v19, s[4:7], s64 offen offset:3072 lds
  s_mov_b32 m0, s35
  s_nop 0
  buffer_load_dword v15, s[4:7], 0 offen offset:76 lds
  s_add_u32 s64, s62, 1
  s_and_b32 s64, s64, 7
  s_add_u32 m0, s82, 32768
  s_lshl_b32 s64, s64, 7
  buffer_load_dwordx4 v16, s[4:7], s64 offen offset:0 lds
  buffer_load_dwordx4 v17, s[4:7], s64 offen offset:1024 lds
  buffer_load_dwordx4 v18, s[4:7], s64 offen offset:2048 lds
  buffer_load_dwordx4 v19, s[4:7], s64 offen offset:3072 lds
  s_mov_b32 m0, s35
  s_nop 0
  buffer_load_dword v15, s[4:7], 0 offen offset:72 lds
  s_branch L_lwave
L_p1:
  s_setprio 2
  s_lshl_b32 s73, s57, 3
  s_add_u32 s73, s73, s58
  s_and_b32 s66, s73, 1
  s_xor_b32 s67, s56, 3
  s_or_b32 s74, s66, s67
  s_lshr_b32 s73, s73, 1
  s_lshr_b32 s65, s73, 5
  s_add_u32 s65, s65, 16
  s_bfe_u32 s66, s73, 0x20003
  s_and_b32 s73, s73, 7
  s_lshl_b32 s67, s66, 2
  s_add_u32 s67, s67, s65
  s_sub_u32 s67, s67, 14
  s_mov_b32 s18, 0x80000
  s_mov_b32 s19, 0x20000
  s_lshl_b32 s67, s67, 15
  s_lshl_b32 s73, s73, 7
  s_add_u32 s73, s73, s67
  v_lshrrev_b32 v70, 3, v0
  v_and_b32 v71, 7, v0
  v_and_b32 v72, 6, v70
  v_xor_b32 v72, v72, v71
  v_lshlrev_b32 v72, 4, v72
  v_lshl_add_u32 v26, v70, 10, v72
  v_add_u32 v27, 7168, v26
  v_add_u32 v28, 14336, v26
  v_add_u32 v29, 21504, v26
  s_lshl_b32 m0, s56, 12
  s_lshr_b32 s64, s58, 1
  s_mul_i32 s64, s64, 896
  s_add_u32 s82, s64, 384
  s_and_b32 s65, s58, 1
  s_lshl_b32 s65, s65, 9
  s_add_u32 s83, s64, s65
  s_add_u32 s84, s83, 128
  s_add_u32 s85, s83, 256
  s_lshl_b32 s64, s58, 7
  s_add_u32 s65, s64, 1024
  s_add_u32 s66, s64, 2048
  s_cmp_eq_u32 s59, 0
  s_cselect_b32 s82, s65, s82
  s_cselect_b32 s83, s66, s83
  s_cselect_b32 s84, s64, s84
  s_mov_b32 s67, s82
  s_cmp_eq_u32 s56, 1
  s_cselect_b32 s67, s83, s67
  s_cmp_eq_u32 s56, 2
  s_cselect_b32 s67, s84, s67
  s_cmp_eq_u32 s56, 3
  s_cselect_b32 s67, s85, s67
  s_mov_b32 s11, 0x20000
  s_waitcnt lgkmcnt(0)
  s_cmp_eq_u32 s18, 0x80000
  s_cselect_b32 s16, s40, s48
  s_cselect_b32 s17, s41, s49
  s_xor_b32 s65, s59, 1
  s_or_b32 s65, s65, s74
  s_cbranch_scc1 L_nounit_1
  buffer_load_dwordx4 v26, s[16:19], s73 offen offset:0 lds
  buffer_load_dwordx4 v27, s[16:19], s73 offen offset:1024 lds
  buffer_load_dwordx4 v28, s[16:19], s73 offen offset:2048 lds
  buffer_load_dwordx4 v29, s[16:19], s73 offen offset:3072 lds
L_nounit_1:
  v_lshlrev_b32 v16, 1, v0
  s_mov_b64 s[20:21], s[46:47]
  s_mov_b32 s22, 0xe00
  s_mov_b32 s23, 0x20000
  s_cmp_eq_u32 s59, 0
  s_cbranch_scc1 L_nobias_2
  buffer_load_ushort v30, v16, s[20:23], s67 offen
L_nobias_2:
  s_mul_i32 s35, s56, 336
  s_add_u32 s35, s35, 147456
  v_lshl_add_u32 v2, v0, 2, s35
  v_mov_b32 v15, 0x40000000
  ds_write_b32 v2, v15
  v_mov_b32 v3, 0
  v_and_b32 v4, 3, v0
  v_mul_u32_u24 v4, 336, v4
  v_add_u32 v4, 147456, v4
  s_mul_i32 s64, s56, 336
  s_add_u32 s64, s64, 147456
  v_mov_b32 v5, s64
  v_lshlrev_b32 v1, 4, v0
  v_mov_b32 v40, 0
  v_mov_b32 v41, 0
  v_mov_b32 v42, 0
  v_mov_b32 v43, 0
  s_mov_b64 s[12:13], s[54:55]
  s_mov_b32 s14, 0x10000000
  s_mov_b32 s15, 0x20000
  s_mov_b64 s[28:29], s[52:53]
  s_mov_b32 s30, 0x100
  s_mov_b32 s31, 0x20000
  s_lshr_b32 s64, s2, 3
  s_xor_b32 s64, s64, 3
  s_xor_b32 s65, s56, 2
  s_or_b32 s72, s64, s65
  s_cbranch_scc1 L_noinit_3
  s_and_b32 s64, s2, 7
  s_mul_i32 s64, s64, 3072
  buffer_store_dwordx4 v[40:43], v1, s[12:15], s64 offen offset:0 sc1
  buffer_store_dwordx4 v[40:43], v1, s[12:15], s64 offen offset:1024 sc1
  buffer_store_dwordx4 v[40:43], v1, s[12:15], s64 offen offset:2048 sc1
L_noinit_3:
  v_and_b32 v70, 31, v0
  v_lshrrev_b32 v71, 5, v0
  v_lshrrev_b32 v74, 4, v0
  v_bfe_u32 v72, v0, 1, 3
  v_xor_b32 v72, v72, v74
  v_lshlrev_b32 v72, 4, v72
  v_and_b32 v73, 15, v0
  v_lshl_add_u32 v72, v73, 7, v72
  s_lshl_b32 s64, s56, 12
  v_add_u32 v22, s64, v72
  v_xor_b32 v23, 64, v22
  v_bfe_u32 v72, v0, 2, 2
  v_lshlrev_b32 v72, 7, v72
  v_lshl_add_u32 v72, v74, 10, v72
  v_bfe_u32 v73, v0, 3, 2
  v_lshl_add_u32 v72, v73, 5, v72
  v_and_b32 v73, 3, v0
  v_lshl_add_u32 v14, v73, 3, v72
  v_lshrrev_b32 v72, 3, v70
  v_lshlrev_b32 v72, 1, v72
  v_bfe_u32 v73, v70, 1, 1
  v_add_u32 v72, v72, v73
  v_bfe_u32 v73, v70, 2, 1
  v_xor_b32 v73, v73, v71
  v_lshl_add_u32 v72, v73, 4, v72
  v_and_b32 v73, 1, v70
  v_lshlrev_b32 v73, 4, v73
  v_mov_b32 v74, 0x3f80
  v_lshlrev_b32 v73, v73, v74
  v_cmp_eq_u32 vcc, 0, v72
  v_mov_b32 v56, 0
  s_nop 0
  v_cndmask_b32 v32, 0, v73, vcc
  v_cmp_eq_u32 vcc, 1, v72
  v_mov_b32 v57, 0
  s_nop 0
  v_cndmask_b32 v33, 0, v73, vcc
  v_cmp_eq_u32 vcc, 2, v72
  v_mov_b32 v58, 0
  s_nop 0
  v_cndmask_b32 v34, 0, v73, vcc
  v_cmp_eq_u32 vcc, 3, v72
  v_mov_b32 v59, 0
  s_nop 0
  v_cndmask_b32 v35, 0, v73, vcc
  v_cmp_eq_u32 vcc, 4, v72
  s_nop 1
  v_cndmask_b32 v36, 0, v73, vcc
  v_cmp_eq_u32 vcc, 5, v72
  s_nop 1
  v_cndmask_b32 v37, 0, v73, vcc
  v_cmp_eq_u32 vcc, 6, v72
  s_nop 1
  v_cndmask_b32 v38, 0, v73, vcc
  v_cmp_eq_u32 vcc, 7, v72
  s_nop 1
  v_cndmask_b32 v39, 0, v73, vcc
  s_mov_b32 s87, 0x3f803f80
  s_lshl_b32 s64, s57, 1
  s_lshr_b32 s65, s56, 1
  s_add_u32 s64, s64, s65
  s_lshr_b32 s65, s58, 1
  s_and_b32 s66, s58, 1
  s_and_b32 s67, s56, 1
  s_lshl_b32 s64, s64, 2
  s_add_u32 s64, s64, s65
  s_lshl_b32 s71, s64, 7
  s_mul_i32 s64, s64, 72
  s_lshl_b32 s67, s67, 2
  s_add_u32 s65, s66, s67
  s_lshl_b32 s66, s65, 1
  s_add_u32 s66, s66, 56
  s_cmp_eq_u32 s59, 0
  s_cselect_b32 s65, s66, s65
  s_add_u32 s64, s64, s65
  s_lshl_b32 s64, s64, 10
  s_add_u32 s70, s64, 4194304
  s_add_u32 s98, s54, s71
  s_addc_u32 s99, s55, 0
  s_mov_b64 s[4:5], s[36:37]
  s_mov_b32 s6, 0x200000
  s_mov_b32 s7, 0x20000
  s_cmp_lg_u32 s59, 0
  s_cbranch_scc1 L_noab_4
  s_lshr_b32 s64, s58, 1
  s_mul_i32 s64, s64, 896
  s_add_u32 s68, s64, 384
  s_sub_u32 s64, s85, 256
  s_mov_b32 s69, s85
  s_add_u32 s65, s64, 128
  s_cmp_eq_u32 s56, 1
  s_cselect_b32 s68, s64, s68
  s_cselect_b32 s69, s65, s69
  s_cmp_eq_u32 s56, 2
  s_cselect_b32 s68, s82, s68
  s_cselect_b32 s69, s82, s69
  s_cmp_eq_u32 s56, 3
  s_cselect_b32 s68, s83, s68
  s_cselect_b32 s69, s84, s69
  s_cmp_lt_u32 s56, 2
  s_cselect_b32 s8, s44, s38
  s_cselect_b32 s9, s45, s39
  s_cselect_b32 s64, 7, 6
  s_lshl_b32 s10, s64, 18
  s_lshl_b32 s64, s64, 9
  v_and_b32 v18, 31, v0
  v_lshl_add_u32 v18, s57, 5, v18
  v_mul_lo_u32 v18, v18, s64
  s_sub_u32 s69, s69, s68
  v_lshrrev_b32 v17, 5, v0
  v_mul_lo_u32 v17, v17, s69
  v_add3_u32 v18, v18, v17, s68
  s_and_b32 s64, s58, 1
  s_lshl_b32 s64, s64, 4
  s_lshl_b32 s64, 0xffff, s64
  s_cmp_eq_u32 s56, 0
  s_cselect_b32 s64, s64, -1
  s_bitcmp1_b32 10, s56
  s_cselect_b32 s64, s64, 1
  s_bitcmp1_b32 0, s56
  s_cselect_b32 s65, -1, 0
  s_lshl_b32 m0, s56, 12
  s_mov_b64 exec, s[64:65]
  buffer_load_dword v19, v18, s[8:11], 0 offen
  s_mov_b64 exec, -1
L_noab_4:
  s_waitcnt lgkmcnt(0)
  s_barrier
  s_xor_b32 s65, s59, 1
  s_or_b32 s65, s65, s74
  s_cbranch_scc1 L_noraw_5
  s_mov_b32 m0, s35
  s_nop 0
  buffer_load_dword v15, s[4:7], 0 offen offset:76 lds
L_noraw_5:
  s_mov_b64 s[24:25], s[50:51]
  s_mov_b32 s26, 0x200000
  s_mov_b32 s27, 0x20000
  s_and_b32 s64, s2, 7
  s_lshr_b32 s65, s2, 3
  s_lshl_b32 s60, s64, 2
  s_lshr_b32 s66, s65, 3
  s_add_u32 s60, s60, s66
  s_lshl_b32 s66, s66, 1
  s_add_u32 s65, s65, s66
  s_and_b32 s61, s65, 7
  s_mov_b32 s86, 0
  ds_read_b32 v6, v5 offset:1420
  s_waitcnt lgkmcnt(0)
  v_cmp_ne_u32 vcc, 0, v6
  s_cbranch_vccz L_lr_7
L_lp_6:
  s_add_u32 s86, s86, 1
  s_cmp_gt_u32 s86, 1048576
  s_cbranch_scc1 L_lr_7
  ds_read_b32 v6, v5 offset:1420
  s_waitcnt lgkmcnt(0)
  v_cmp_ne_u32 vcc, 0, v6
  s_cbranch_vccnz L_lp_6
L_lr_7:
  ds_read_b128 v[128:131], v22 offset:16384
  ds_read_b128 v[132:135], v22 offset:18432
  ds_read_b128 v[136:139], v23 offset:16384
  ds_read_b128 v[140:143], v23 offset:18432
  s_cmp_eq_u32 s59, 0
  s_cbranch_scc1 L_nobias_8
  s_lshl_b32 s64, s56, 8
  s_add_u32 s64, s64, 150144
  v_lshl_add_u32 v31, v0, 2, s64
  s_waitcnt vmcnt(0)
  v_lshlrev_b32 v30, 16, v30
  v_mul_f32 v30, 0x3fb8aa3b, v30
  ds_write_b32 v31, v30
L_nobias_8:
  ds_read_b32 v6, v5 offset:1416
  s_waitcnt lgkmcnt(4)
  v_dot2c_f32_bf16 v56, s87, v128
  v_dot2c_f32_bf16 v58, v128, v128
  s_waitcnt lgkmcnt(3)
  v_dot2c_f32_bf16 v57, s87, v132
  v_dot2c_f32_bf16 v59, v132, v132
  v_dot2c_f32_bf16 v56, s87, v129
  v_dot2c_f32_bf16 v58, v129, v129
  v_dot2c_f32_bf16 v57, s87, v133
  v_dot2c_f32_bf16 v59, v133, v133
  v_dot2c_f32_bf16 v56, s87, v130
  v_dot2c_f32_bf16 v58, v130, v130
  v_dot2c_f32_bf16 v57, s87, v134
  v_dot2c_f32_bf16 v59, v134, v134
  v_dot2c_f32_bf16 v56, s87, v131
  v_dot2c_f32_bf16 v58, v131, v131
  v_dot2c_f32_bf16 v57, s87, v135
  v_dot2c_f32_bf16 v59, v135, v135
  s_waitcnt lgkmcnt(0)
  v_cmp_ne_u32 vcc, 0, v6
  s_cbranch_vccz L_lr_10
L_lp_9:
  s_add_u32 s86, s86, 1
  s_cmp_gt_u32 s86, 1048576
  s_cbranch_scc1 L_lr_10
  ds_read_b32 v6, v5 offset:1416
  s_waitcnt lgkmcnt(0)
  v_cmp_ne_u32 vcc, 0, v6
  s_cbranch_vccnz L_lp_9
L_lr_10:
  ds_read_b128 v[144:147], v22 offset:32768
  ds_read_b128 v[148:151], v22 offset:34816
  ds_read_b128 v[152:155], v23 offset:32768
  ds_read_b128 v[156:159], v23 offset:34816
  s_cmp_lg_u32 s72, 0
  s_cbranch_scc1 L_noinit_11
  v_mov_b32 v44, 1
  s_waitcnt vmcnt(0)
  s_mov_b64 exec, 1
  buffer_atomic_add v44, v40, s[28:31], 0 offen sc1
  s_mov_b64 exec, -1
L_noinit_11:
  v_dot2c_f32_bf16 v56, s87, v136
  v_dot2c_f32_bf16 v58, v136, v136
  v_dot2c_f32_bf16 v57, s87, v140
  v_dot2c_f32_bf16 v59, v140, v140
  v_dot2c_f32_bf16 v56, s87, v137
  v_dot2c_f32_bf16 v58, v137, v137
  v_dot2c_f32_bf16 v57, s87, v141
  v_dot2c_f32_bf16 v59, v141, v141
  v_dot2c_f32_bf16 v56, s87, v138
  v_dot2c_f32_bf16 v58, v138, v138
  v_dot2c_f32_bf16 v57, s87, v142
  v_dot2c_f32_bf16 v59, v142, v142
  v_dot2c_f32_bf16 v56, s87, v139
  v_dot2c_f32_bf16 v58, v139, v139
  v_dot2c_f32_bf16 v57, s87, v143
  v_dot2c_f32_bf16 v59, v143, v143
  ds_read_b32 v6, v5 offset:1412
  s_waitcnt lgkmcnt(4)
  v_dot2c_f32_bf16 v56, s87, v144
  v_dot2c_f32_bf16 v58, v144, v144
  s_waitcnt lgkmcnt(3)
  v_dot2c_f32_bf16 v57, s87, v148
  v_dot2c_f32_bf16 v59, v148, v148
  v_dot2c_f32_bf16 v56, s87, v145
  v_dot2c_f32_bf16 v58, v145, v145
  v_dot2c_f32_bf16 v57, s87, v149
  v_dot2c_f32_bf16 v59, v149, v149
  v_dot2c_f32_bf16 v56, s87, v146
  v_dot2c_f32_bf16 v58, v146, v146
  v_dot2c_f32_bf16 v57, s87, v150
  v_dot2c_f32_bf16 v59, v150, v150
  v_dot2c_f32_bf16 v56, s87, v147
  v_dot2c_f32_bf16 v58, v147, v147
  v_dot2c_f32_bf16 v57, s87, v151
  v_dot2c_f32_bf16 v59, v151, v151
  s_waitcnt lgkmcnt(0)
  v_cmp_ne_u32 vcc, 0, v6
  s_cbranch_vccz L_lr_13
L_lp_12:
  s_add_u32 s86, s86, 1
  s_cmp_gt_u32 s86, 1048576
  s_cbranch_scc1 L_lr_13
  ds_read_b32 v6, v5 offset:1412
  s_waitcnt lgkmcnt(0)
  v_cmp_ne_u32 vcc, 0, v6
  s_cbranch_vccnz L_lp_12
L_lr_13:
  ds_read_b128 v[160:163], v22 offset:49152
  ds_read_b128 v[164:167], v22 offset:51200
  ds_read_b128 v[168:171], v23 offset:49152
  ds_read_b128 v[172:175], v23 offset:51200
  v_add_u32 v22, 0x10000, v22
  v_add_u32 v23, 0x10000, v23
  v_dot2c_f32_bf16 v56, s87, v152
  v_dot2c_f32_bf16 v58, v152, v152
  v_dot2c_f32_bf16 v57, s87, v156
  v_dot2c_f32_bf16 v59, v156, v156
  v_dot2c_f32_bf16 v56, s87, v153
  v_dot2c_f32_bf16 v58, v153, v153
  v_dot2c_f32_bf16 v57, s87, v157
  v_dot2c_f32_bf16 v59, v157, v157
  v_dot2c_f32_bf16 v56, s87, v154
  v_dot2c_f32_bf16 v58, v154, v154
  v_dot2c_f32_bf16 v57, s87, v158
  v_dot2c_f32_bf16 v59, v158, v158
  v_dot2c_f32_bf16 v56, s87, v155
  v_dot2c_f32_bf16 v58, v155, v155
  v_dot2c_f32_bf16 v57, s87, v159
  v_dot2c_f32_bf16 v59, v159, v159
  s_waitcnt lgkmcnt(0)
  s_mov_b32 m0, s35
  s_nop 0
  buffer_load_dword v15, s[4:7], 0 offen offset:72 lds
  ds_read_b32 v6, v5 offset:1408
  v_dot2c_f32_bf16 v56, s87, v160
  v_dot2c_f32_bf16 v58, v160, v160
  v_dot2c_f32_bf16 v57, s87, v164
  v_dot2c_f32_bf16 v59, v164, v164
  v_dot2c_f32_bf16 v56, s87, v161
  v_dot2c_f32_bf16 v58, v161, v161
  v_dot2c_f32_bf16 v57, s87, v165
  v_dot2c_f32_bf16 v59, v165, v165
  v_dot2c_f32_bf16 v56, s87, v162
  v_dot2c_f32_bf16 v58, v162, v162
  v_dot2c_f32_bf16 v57, s87, v166
  v_dot2c_f32_bf16 v59, v166, v166
  v_dot2c_f32_bf16 v56, s87, v163
  v_dot2c_f32_bf16 v58, v163, v163
  v_dot2c_f32_bf16 v57, s87, v167
  v_dot2c_f32_bf16 v59, v167, v167
  s_waitcnt lgkmcnt(0)
  v_cmp_ne_u32 vcc, 0, v6
  s_cbranch_vccz L_lr_15
L_lp_14:
  s_add_u32 s86, s86, 1
  s_cmp_gt_u32 s86, 1048576
  s_cbranch_scc1 L_lr_15
  ds_read_b32 v6, v5 offset:1408
  s_waitcnt lgkmcnt(0)
  v_cmp_ne_u32 vcc, 0, v6
  s_cbranch_vccnz L_lp_14
L_lr_15:
  ds_read_b128 v[176:179], v22 offset:0
  ds_read_b128 v[180:183], v22 offset:2048
  ds_read_b128 v[184:187], v23 offset:0
  ds_read_b128 v[188:191], v23 offset:2048
  v_dot2c_f32_bf16 v56, s87, v168
  v_dot2c_f32_bf16 v58, v168, v168
  v_dot2c_f32_bf16 v57, s87, v172
  v_dot2c_f32_bf16 v59, v172, v172
  v_dot2c_f32_bf16 v56, s87, v169
  v_dot2c_f32_bf16 v58, v169, v169
  v_dot2c_f32_bf16 v57, s87, v173
  v_dot2c_f32_bf16 v59, v173, v173
  v_dot2c_f32_bf16 v56, s87, v170
  v_dot2c_f32_bf16 v58, v170, v170
  v_dot2c_f32_bf16 v57, s87, v174
  v_dot2c_f32_bf16 v59, v174, v174
  v_dot2c_f32_bf16 v56, s87, v171
  v_dot2c_f32_bf16 v58, v171, v171
  v_dot2c_f32_bf16 v57, s87, v175
  v_dot2c_f32_bf16 v59, v175, v175
  ds_read_b32 v6, v5 offset:1404
  s_waitcnt lgkmcnt(4)
  v_dot2c_f32_bf16 v56, s87, v176
  v_dot2c_f32_bf16 v58, v176, v176
  s_waitcnt lgkmcnt(3)
  v_dot2c_f32_bf16 v57, s87, v180
  v_dot2c_f32_bf16 v59, v180, v180
  v_dot2c_f32_bf16 v56, s87, v177
  v_dot2c_f32_bf16 v58, v177, v177
  v_dot2c_f32_bf16 v57, s87, v181
  v_dot2c_f32_bf16 v59, v181, v181
  v_dot2c_f32_bf16 v56, s87, v178
  v_dot2c_f32_bf16 v58, v178, v178
  v_dot2c_f32_bf16 v57, s87, v182
  v_dot2c_f32_bf16 v59, v182, v182
  v_dot2c_f32_bf16 v56, s87, v179
  v_dot2c_f32_bf16 v58, v179, v179
  v_dot2c_f32_bf16 v57, s87, v183
  v_dot2c_f32_bf16 v59, v183, v183
  s_waitcnt lgkmcnt(0)
  v_cmp_ne_u32 vcc, 0, v6
  s_cbranch_vccz L_lr_17
L_lp_16:
  s_add_u32 s86, s86, 1
  s_cmp_gt_u32 s86, 1048576
  s_cbranch_scc1 L_lr_17
  ds_read_b32 v6, v5 offset:1404
  s_waitcnt lgkmcnt(0)
  v_cmp_ne_u32 vcc, 0, v6
  s_cbranch_vccnz L_lp_16
L_lr_17:
  ds_read_b128 v[192:195], v22 offset:16384
  ds_read_b128 v[196:199], v22 offset:18432
  ds_read_b128 v[200:203], v23 offset:16384
  ds_read_b128 v[204:207], v23 offset:18432
  v_dot2c_f32_bf16 v56, s87, v184
  v_dot2c_f32_bf16 v58, v184, v184
  v_dot2c_f32_bf16 v57, s87, v188
  v_dot2c_f32_bf16 v59, v188, v188
  v_dot2c_f32_bf16 v56, s87, v185
  v_dot2c_f32_bf16 v58, v185, v185
  v_dot2c_f32_bf16 v57, s87, v189
  v_dot2c_f32_bf16 v59, v189, v189
  v_dot2c_f32_bf16 v56, s87, v186
  v_dot2c_f32_bf16 v58, v186, v186
  v_dot2c_f32_bf16 v57, s87, v190
  v_dot2c_f32_bf16 v59, v190, v190
  v_dot2c_f32_bf16 v56, s87, v187
  v_dot2c_f32_bf16 v58, v187, v187
  v_dot2c_f32_bf16 v57, s87, v191
  v_dot2c_f32_bf16 v59, v191, v191
  s_waitcnt lgkmcnt(0)
  s_mov_b32 m0, s35
  s_nop 0
  buffer_load_dword v15, s[4:7], 0 offen offset:68 lds
  ds_read_b32 v6, v5 offset:1400
  v_dot2c_f32_bf16 v56, s87, v192
  v_dot2c_f32_bf16 v58, v192, v192
  v_dot2c_f32_bf16 v57, s87, v196
  v_dot2c_f32_bf16 v59, v196, v196
  v_dot2c_f32_bf16 v56, s87, v193
  v_dot2c_f32_bf16 v58, v193, v193
  v_dot2c_f32_bf16 v57, s87, v197
  v_dot2c_f32_bf16 v59, v197, v197
  v_dot2c_f32_bf16 v56, s87, v194
  v_dot2c_f32_bf16 v58, v194, v194
  v_dot2c_f32_bf16 v57, s87, v198
  v_dot2c_f32_bf16 v59, v198, v198
  v_dot2c_f32_bf16 v56, s87, v195
  v_dot2c_f32_bf16 v58, v195, v195
  v_dot2c_f32_bf16 v57, s87, v199
  v_dot2c_f32_bf16 v59, v199, v199
  s_waitcnt lgkmcnt(0)
  v_cmp_ne_u32 vcc, 0, v6
  s_cbranch_vccz L_lr_19
L_lp_18:
  s_add_u32 s86, s86, 1
  s_cmp_gt_u32 s86, 1048576
  s_cbranch_scc1 L_lr_19
  ds_read_b32 v6, v5 offset:1400
  s_waitcnt lgkmcnt(0)
  v_cmp_ne_u32 vcc, 0, v6
  s_cbranch_vccnz L_lp_18
L_lr_19:
  ds_read_b128 v[208:211], v22 offset:32768
  ds_read_b128 v[212:215], v22 offset:34816
  ds_read_b128 v[216:219], v23 offset:32768
  ds_read_b128 v[220:223], v23 offset:34816
  v_dot2c_f32_bf16 v56, s87, v200
  v_dot2c_f32_bf16 v58, v200, v200
  v_dot2c_f32_bf16 v57, s87, v204
  v_dot2c_f32_bf16 v59, v204, v204
  v_dot2c_f32_bf16 v56, s87, v201
  v_dot2c_f32_bf16 v58, v201, v201
  v_dot2c_f32_bf16 v57, s87, v205
  v_dot2c_f32_bf16 v59, v205, v205
  v_dot2c_f32_bf16 v56, s87, v202
  v_dot2c_f32_bf16 v58, v202, v202
  v_dot2c_f32_bf16 v57, s87, v206
  v_dot2c_f32_bf16 v59, v206, v206
  v_dot2c_f32_bf16 v56, s87, v203
  v_dot2c_f32_bf16 v58, v203, v203
  v_dot2c_f32_bf16 v57, s87, v207
  v_dot2c_f32_bf16 v59, v207, v207
  s_waitcnt lgkmcnt(3)
  v_dot2c_f32_bf16 v56, s87, v208
  v_dot2c_f32_bf16 v58, v208, v208
  s_waitcnt lgkmcnt(2)
  v_dot2c_f32_bf16 v57, s87, v212
  v_dot2c_f32_bf16 v59, v212, v212
  v_dot2c_f32_bf16 v56, s87, v209
  v_dot2c_f32_bf16 v58, v209, v209
  v_dot2c_f32_bf16 v57, s87, v213
  v_dot2c_f32_bf16 v59, v213, v213
  v_dot2c_f32_bf16 v56, s87, v210
  v_dot2c_f32_bf16 v58, v210, v210
  v_dot2c_f32_bf16 v57, s87, v214
  v_dot2c_f32_bf16 v59, v214, v214
  v_dot2c_f32_bf16 v56, s87, v211
  v_dot2c_f32_bf16 v58, v211, v211
  v_dot2c_f32_bf16 v57, s87, v215
  v_dot2c_f32_bf16 v59, v215, v215
  ds_read_b32 v6, v5 offset:1396
  s_waitcnt lgkmcnt(2)
  v_dot2c_f32_bf16 v56, s87, v216
  v_dot2c_f32_bf16 v58, v216, v216
  s_waitcnt lgkmcnt(1)
  v_dot2c_f32_bf16 v57, s87, v220
  v_dot2c_f32_bf16 v59, v220, v220
  v_dot2c_f32_bf16 v56, s87, v217
  v_dot2c_f32_bf16 v58, v217, v217
  v_dot2c_f32_bf16 v57, s87, v221
  v_dot2c_f32_bf16 v59, v221, v221
  v_dot2c_f32_bf16 v56, s87, v218
  v_dot2c_f32_bf16 v58, v218, v218
  v_dot2c_f32_bf16 v57, s87, v222
  v_dot2c_f32_bf16 v59, v222, v222
  v_dot2c_f32_bf16 v56, s87, v219
  v_dot2c_f32_bf16 v58, v219, v219
  v_dot2c_f32_bf16 v57, s87, v223
  v_dot2c_f32_bf16 v59, v223, v223
  s_waitcnt lgkmcnt(0)
  v_cmp_ne_u32 vcc, 0, v6
  s_cbranch_vccz L_lr_21
L_lp_20:
  s_add_u32 s86, s86, 1
  s_cmp_gt_u32 s86, 1048576
  s_cbranch_scc1 L_lr_21
  ds_read_b32 v6, v5 offset:1396
  s_waitcnt lgkmcnt(0)
  v_cmp_ne_u32 vcc, 0, v6
  s_cbranch_vccnz L_lp_20
L_lr_21:
  ds_read_b128 v[224:227], v22 offset:49152
  ds_read_b128 v[228:231], v22 offset:51200
  ds_read_b128 v[232:235], v23 offset:49152
  ds_read_b128 v[236:239], v23 offset:51200
  v_add_u32 v22, 0x10000, v22
  v_add_u32 v23, 0x10000, v23
  s_waitcnt lgkmcnt(0)
  s_mov_b32 m0, s35
  s_nop 0
  buffer_load_dword v15, s[4:7], 0 offen offset:64 lds
  v_dot2c_f32_bf16 v56, s87, v224
  v_dot2c_f32_bf16 v58, v224, v224
  v_dot2c_f32_bf16 v57, s87, v228
  v_dot2c_f32_bf16 v59, v228, v228
  v_dot2c_f32_bf16 v56, s87, v225
  v_dot2c_f32_bf16 v58, v225, v225
  v_dot2c_f32_bf16 v57, s87, v229
  v_dot2c_f32_bf16 v59, v229, v229
  v_dot2c_f32_bf16 v56, s87, v226
  v_dot2c_f32_bf16 v58, v226, v226
  v_dot2c_f32_bf16 v57, s87, v230
  v_dot2c_f32_bf16 v59, v230, v230
  v_dot2c_f32_bf16 v56, s87, v227
  v_dot2c_f32_bf16 v58, v227, v227
  v_dot2c_f32_bf16 v57, s87, v231
  v_dot2c_f32_bf16 v59, v231, v231
  ds_read_b32 v6, v5 offset:1392
  v_dot2c_f32_bf16 v56, s87, v232
  v_dot2c_f32_bf16 v58, v232, v232
  v_dot2c_f32_bf16 v57, s87, v236
  v_dot2c_f32_bf16 v59, v236, v236
  v_dot2c_f32_bf16 v56, s87, v233
  v_dot2c_f32_bf16 v58, v233, v233
  v_dot2c_f32_bf16 v57, s87, v237
  v_dot2c_f32_bf16 v59, v237, v237
  v_dot2c_f32_bf16 v56, s87, v234
  v_dot2c_f32_bf16 v58, v234, v234
  v_dot2c_f32_bf16 v57, s87, v238
  v_dot2c_f32_bf16 v59, v238, v238
  v_dot2c_f32_bf16 v56, s87, v235
  v_dot2c_f32_bf16 v58, v235, v235
  v_dot2c_f32_bf16 v57, s87, v239
  v_dot2c_f32_bf16 v59, v239, v239
  s_waitcnt lgkmcnt(0)
  v_cmp_ne_u32 vcc, 0, v6
  s_cbranch_vccz L_lr_23
L_lp_22:
  s_add_u32 s86, s86, 1
  s_cmp_gt_u32 s86, 1048576
  s_cbranch_scc1 L_lr_23
  ds_read_b32 v6, v5 offset:1392
  s_waitcnt lgkmcnt(0)
  v_cmp_ne_u32 vcc, 0, v6
  s_cbranch_vccnz L_lp_22
L_lr_23:
  ds_read_b128 v[240:243], v22 offset:0
  ds_read_b128 v[244:247], v22 offset:2048
  ds_read_b128 v[248:251], v23 offset:0
  s_waitcnt vmcnt(3)
  ds_read_b128 v[252:255], v23 offset:2048
  s_waitcnt lgkmcnt(3)
  v_dot2c_f32_bf16 v56, s87, v240
  s_waitcnt lgkmcnt(2)
  v_dot2c_f32_bf16 v57, s87, v244
  v_dot2c_f32_bf16 v56, s87, v241
  v_dot2c_f32_bf16 v57, s87, v245
  v_dot2c_f32_bf16 v56, s87, v242
  v_dot2c_f32_bf16 v57, s87, v246
  v_dot2c_f32_bf16 v56, s87, v243
  v_dot2c_f32_bf16 v57, s87, v247
  s_waitcnt lgkmcnt(1)
  v_dot2c_f32_bf16 v56, s87, v248
  s_waitcnt lgkmcnt(0)
  v_dot2c_f32_bf16 v57, s87, v252
  v_dot2c_f32_bf16 v56, s87, v249
  v_dot2c_f32_bf16 v57, s87, v253
  v_dot2c_f32_bf16 v56, s87, v250
  v_dot2c_f32_bf16 v57, s87, v254
  v_dot2c_f32_bf16 v56, s87, v251
  v_dot2c_f32_bf16 v57, s87, v255
  v_dot2c_f32_bf16 v58, v240, v240
  v_dot2c_f32_bf16 v59, v244, v244
  v_dot2c_f32_bf16 v58, v241, v241
  v_permlane32_swap_b32 v56, v57
  v_add_f32 v56, v56, v57
  v_mov_b32 v57, v56
  v_dot2c_f32_bf16 v59, v245, v245
  v_dot2c_f32_bf16 v58, v242, v242
  v_dot2c_f32_bf16 v59, v246, v246
  v_permlane16_swap_b32 v56, v57
  v_add_f32 v56, v56, v57
  v_mul_f32 v40, 0xbb000000, v56
  v_mul_f32 v48, 0xbb000000, v56
  v_mul_f32 v56, 0xbb000000, v56
  v_dot2c_f32_bf16 v58, v243, v243
  v_dot2c_f32_bf16 v59, v247, v247
  v_dot2c_f32_bf16 v58, v248, v248
  v_permlane32_swap_b32 v40, v48
  v_dot2c_f32_bf16 v59, v252, v252
  v_dot2c_f32_bf16 v58, v249, v249
  v_dot2c_f32_bf16 v59, v253, v253
  v_dot2c_f32_bf16 v58, v250, v250
  v_dot2c_f32_bf16 v59, v254, v254
  v_dot2c_f32_bf16 v58, v251, v251
  v_dot2c_f32_bf16 v59, v255, v255
  v_mov_b32 v41, v40
  v_mov_b32 v42, v40
  v_mov_b32 v43, v40
  v_mov_b32 v44, v40
  v_mov_b32 v45, v40
  v_mov_b32 v46, v40
  v_mov_b32 v47, v40
  v_mov_b32 v49, v48
  v_mov_b32 v50, v48
  v_mov_b32 v51, v48
  v_mov_b32 v52, v48
  v_mov_b32 v53, v48
  v_mov_b32 v54, v48
  v_mov_b32 v55, v48
  s_nop 1
  v_mfma_f32_32x32x16_bf16 v[16:31], v[32:35], v[128:131], v[40:55]
  v_permlane32_swap_b32 v58, v59
  v_add_f32 v58, v58, v59
  v_mov_b32 v59, v58
  v_mfma_f32_32x32x16_bf16 v[16:31], v[36:39], v[132:135], v[16:31]
  s_nop 0
  v_permlane16_swap_b32 v58, v59
  v_add_f32 v58, v58, v59
  v_mul_f32 v58, 0x3b000000, v58
  v_fma_f32 v58, -v56, v56, v58
  v_mfma_f32_32x32x16_bf16 v[96:111], v[32:35], v[136:139], v[40:55]
  v_max_f32 v58, 0, v58
  v_add_f32 v58, 0x3727c5ac, v58
  v_rsq_f32 v59, v58
  v_mfma_f32_32x32x16_bf16 v[96:111], v[36:39], v[140:143], v[96:111]
  v_mul_f32 v12, 0x3fb8aa3b, v59
  v_mul_f32 v13, 0x3fb8aa3b, v59
  v_mfma_f32_32x32x16_bf16 v[112:127], v[32:35], v[144:147], v[40:55]
  v_cvt_pk_bf16_f32 v128, v16, v17
  v_cvt_pk_bf16_f32 v129, v18, v19
  v_cvt_pk_bf16_f32 v130, v20, v21
  v_cvt_pk_bf16_f32 v131, v22, v23
  v_mfma_f32_32x32x16_bf16 v[112:127], v[36:39], v[148:151], v[112:127]
  v_cvt_pk_bf16_f32 v132, v24, v25
  v_cvt_pk_bf16_f32 v133, v26, v27
  v_cvt_pk_bf16_f32 v134, v28, v29
  v_cvt_pk_bf16_f32 v135, v30, v31
  v_mfma_f32_32x32x16_bf16 v[16:31], v[32:35], v[152:155], v[40:55]
  v_cvt_pk_bf16_f32 v136, v96, v97
  v_cvt_pk_bf16_f32 v137, v98, v99
  v_cvt_pk_bf16_f32 v138, v100, v101
  v_cvt_pk_bf16_f32 v139, v102, v103
  v_mfma_f32_32x32x16_bf16 v[16:31], v[36:39], v[156:159], v[16:31]
  v_cvt_pk_bf16_f32 v140, v104, v105
  v_cvt_pk_bf16_f32 v141, v106, v107
  v_cvt_pk_bf16_f32 v142, v108, v109
  v_cvt_pk_bf16_f32 v143, v110, v111
  v_mfma_f32_32x32x16_bf16 v[96:111], v[32:35], v[160:163], v[40:55]
  v_cvt_pk_bf16_f32 v144, v112, v113
  v_cvt_pk_bf16_f32 v145, v114, v115
  v_cvt_pk_bf16_f32 v146, v116, v117
  v_cvt_pk_bf16_f32 v147, v118, v119
  v_permlane32_swap_b32 v12, v13
  v_mfma_f32_32x32x16_bf16 v[96:111], v[36:39], v[164:167], v[96:111]
  v_cvt_pk_bf16_f32 v148, v120, v121
  v_cvt_pk_bf16_f32 v149, v122, v123
  v_cvt_pk_bf16_f32 v150, v124, v125
  v_cvt_pk_bf16_f32 v151, v126, v127
  v_mfma_f32_32x32x16_bf16 v[112:127], v[32:35], v[168:171], v[40:55]
  v_cvt_pk_bf16_f32 v152, v16, v17
  v_cvt_pk_bf16_f32 v153, v18, v19
  v_cvt_pk_bf16_f32 v154, v20, v21
  v_cvt_pk_bf16_f32 v155, v22, v23
  v_mfma_f32_32x32x16_bf16 v[112:127], v[36:39], v[172:175], v[112:127]
  v_cvt_pk_bf16_f32 v156, v24, v25
  v_cvt_pk_bf16_f32 v157, v26, v27
  v_cvt_pk_bf16_f32 v158, v28, v29
  v_cvt_pk_bf16_f32 v159, v30, v31
  v_mfma_f32_32x32x16_bf16 v[16:31], v[32:35], v[176:179], v[40:55]
  v_cvt_pk_bf16_f32 v160, v96, v97
  v_cvt_pk_bf16_f32 v161, v98, v99
  v_cvt_pk_bf16_f32 v162, v100, v101
  v_cvt_pk_bf16_f32 v163, v102, v103
  v_mfma_f32_32x32x16_bf16 v[16:31], v[36:39], v[180:183], v[16:31]
  v_cvt_pk_bf16_f32 v164, v104, v105
  v_cvt_pk_bf16_f32 v165, v106, v107
  v_cvt_pk_bf16_f32 v166, v108, v109
  v_cvt_pk_bf16_f32 v167, v110, v111
  v_mfma_f32_32x32x16_bf16 v[96:111], v[32:35], v[184:187], v[40:55]
  v_cvt_pk_bf16_f32 v168, v112, v113
  v_cvt_pk_bf16_f32 v169, v114, v115
  v_cvt_pk_bf16_f32 v170, v116, v117
  v_cvt_pk_bf16_f32 v171, v118, v119
  v_mfma_f32_32x32x16_bf16 v[96:111], v[36:39], v[188:191], v[96:111]
  v_cvt_pk_bf16_f32 v172, v120, v121
  v_cvt_pk_bf16_f32 v173, v122, v123
  v_cvt_pk_bf16_f32 v174, v124, v125
  v_cvt_pk_bf16_f32 v175, v126, v127
  v_mfma_f32_32x32x16_bf16 v[112:127], v[32:35], v[192:195], v[40:55]
  v_cvt_pk_bf16_f32 v176, v16, v17
  v_cvt_pk_bf16_f32 v177, v18, v19
  v_cvt_pk_bf16_f32 v178, v20, v21
  v_cvt_pk_bf16_f32 v179, v22, v23
  v_mfma_f32_32x32x16_bf16 v[112:127], v[36:39], v[196:199], v[112:127]
  v_cvt_pk_bf16_f32 v180, v24, v25
  v_cvt_pk_bf16_f32 v181, v26, v27
  v_cvt_pk_bf16_f32 v182, v28, v29
  v_cvt_pk_bf16_f32 v183, v30, v31
  v_mfma_f32_32x32x16_bf16 v[16:31], v[32:35], v[200:203], v[40:55]
  v_cvt_pk_bf16_f32 v184, v96, v97
  v_cvt_pk_bf16_f32 v185, v98, v99
  v_cvt_pk_bf16_f32 v186, v100, v101
  v_cvt_pk_bf16_f32 v187, v102, v103
  v_mfma_f32_32x32x16_bf16 v[16:31], v[36:39], v[204:207], v[16:31]
  v_cvt_pk_bf16_f32 v188, v104, v105
  v_cvt_pk_bf16_f32 v189, v106, v107
  v_cvt_pk_bf16_f32 v190, v108, v109
  v_cvt_pk_bf16_f32 v191, v110, v111
  v_mfma_f32_32x32x16_bf16 v[96:111], v[32:35], v[208:211], v[40:55]
  v_cvt_pk_bf16_f32 v192, v112, v113
  v_cvt_pk_bf16_f32 v193, v114, v115
  v_cvt_pk_bf16_f32 v194, v116, v117
  v_cvt_pk_bf16_f32 v195, v118, v119
  ds_read_b32 v6, v4 offset:1388
  v_mfma_f32_32x32x16_bf16 v[96:111], v[36:39], v[212:215], v[96:111]
  v_cvt_pk_bf16_f32 v196, v120, v121
  v_cvt_pk_bf16_f32 v197, v122, v123
  v_cvt_pk_bf16_f32 v198, v124, v125
  v_cvt_pk_bf16_f32 v199, v126, v127
  v_mfma_f32_32x32x16_bf16 v[112:127], v[32:35], v[216:219], v[40:55]
  v_cvt_pk_bf16_f32 v200, v16, v17
  v_cvt_pk_bf16_f32 v201, v18, v19
  v_cvt_pk_bf16_f32 v202, v20, v21
  v_cvt_pk_bf16_f32 v203, v22, v23
  v_mfma_f32_32x32x16_bf16 v[112:127], v[36:39], v[220:223], v[112:127]
  v_cvt_pk_bf16_f32 v204, v24, v25
  v_cvt_pk_bf16_f32 v205, v26, v27
  v_cvt_pk_bf16_f32 v206, v28, v29
  v_cvt_pk_bf16_f32 v207, v30, v31
  s_cmp_eq_u32 s59, 0
  s_cbranch_scc1 L_p1a
  s_and_b32 s64, s58, 1
  s_lshl_b32 s65, s64, 6
  s_add_u32 s73, s65, 0
  v_mfma_f32_32x32x16_bf16 v[16:31], v[32:35], v[224:227], v[40:55]
  v_cvt_pk_bf16_f32 v208, v96, v97
  v_cvt_pk_bf16_f32 v209, v98, v99
  v_cvt_pk_bf16_f32 v210, v100, v101
  v_cvt_pk_bf16_f32 v211, v102, v103
  v_xor_b32 v8, s73, v14
  v_xor_b32 v9, 32, v8
  s_waitcnt lgkmcnt(0)
  v_cmp_ne_u32 vcc, 0, v6
  s_cbranch_vccz L_lr_25
L_lp_24:
  s_add_u32 s86, s86, 1
  s_cmp_gt_u32 s86, 1048576
  s_cbranch_scc1 L_lr_25
  ds_read_b32 v6, v4 offset:1388
  s_waitcnt lgkmcnt(0)
  v_cmp_ne_u32 vcc, 0, v6
  s_cbranch_vccnz L_lp_24
L_lr_25:
  v_mfma_f32_32x32x16_bf16 v[16:31], v[36:39], v[228:231], v[16:31]
  v_cvt_pk_bf16_f32 v212, v104, v105
  v_cvt_pk_bf16_f32 v213, v106, v107
  v_cvt_pk_bf16_f32 v214, v108, v109
  v_cvt_pk_bf16_f32 v215, v110, v111
  ds_read_b64_tr_b16 v[64:65], v8 offset:0
  ds_read_b64_tr_b16 v[66:67], v8 offset:512
  v_mfma_f32_32x32x16_bf16 v[96:111], v[32:35], v[232:235], v[40:55]
  v_cvt_pk_bf16_f32 v216, v112, v113
  v_cvt_pk_bf16_f32 v217, v114, v115
  v_cvt_pk_bf16_f32 v218, v116, v117
  v_cvt_pk_bf16_f32 v219, v118, v119
  ds_read_b64_tr_b16 v[68:69], v8 offset:4096
  ds_read_b64_tr_b16 v[70:71], v8 offset:4608
  v_mfma_f32_32x32x16_bf16 v[96:111], v[36:39], v[236:239], v[96:111]
  v_cvt_pk_bf16_f32 v220, v120, v121
  v_cvt_pk_bf16_f32 v221, v122, v123
  v_cvt_pk_bf16_f32 v222, v124, v125
  v_cvt_pk_bf16_f32 v223, v126, v127
  ds_read_b64_tr_b16 v[72:73], v9 offset:0
  ds_read_b64_tr_b16 v[74:75], v9 offset:512
  v_mfma_f32_32x32x16_bf16 v[112:127], v[32:35], v[240:243], v[40:55]
  v_cvt_pk_bf16_f32 v224, v16, v17
  v_cvt_pk_bf16_f32 v225, v18, v19
  v_cvt_pk_bf16_f32 v226, v20, v21
  v_cvt_pk_bf16_f32 v227, v22, v23
  ds_read_b64_tr_b16 v[76:77], v9 offset:4096
  ds_read_b64_tr_b16 v[78:79], v9 offset:4608
  v_mfma_f32_32x32x16_bf16 v[112:127], v[36:39], v[244:247], v[112:127]
  v_cvt_pk_bf16_f32 v228, v24, v25
  v_cvt_pk_bf16_f32 v229, v26, v27
  v_cvt_pk_bf16_f32 v230, v28, v29
  v_cvt_pk_bf16_f32 v231, v30, v31
  ds_read_b64_tr_b16 v[80:81], v8 offset:8192
  ds_read_b64_tr_b16 v[82:83], v8 offset:8704
  v_mfma_f32_32x32x16_bf16 v[16:31], v[32:35], v[248:251], v[40:55]
  v_cvt_pk_bf16_f32 v232, v96, v97
  v_cvt_pk_bf16_f32 v233, v98, v99
  v_cvt_pk_bf16_f32 v234, v100, v101
  v_cvt_pk_bf16_f32 v235, v102, v103
  ds_read_b64_tr_b16 v[84:85], v8 offset:12288
  ds_read_b64_tr_b16 v[86:87], v8 offset:12800
  v_mfma_f32_32x32x16_bf16 v[16:31], v[36:39], v[252:255], v[16:31]
  v_cvt_pk_bf16_f32 v236, v104, v105
  v_cvt_pk_bf16_f32 v237, v106, v107
  v_cvt_pk_bf16_f32 v238, v108, v109
  v_cvt_pk_bf16_f32 v239, v110, v111
  s_waitcnt lgkmcnt(4)
  v_mfma_f32_16x16x32_bf16 v[96:99], v[64:67], v[128:131], 0
  ds_read_b64_tr_b16 v[88:89], v9 offset:8192
  ds_read_b64_tr_b16 v[90:91], v9 offset:8704
  v_mfma_f32_16x16x32_bf16 v[96:99], v[68:71], v[136:139], v[96:99]
  v_cvt_pk_bf16_f32 v240, v112, v113
  v_mfma_f32_16x16x32_bf16 v[104:107], v[68:71], v[140:143], 0
  ds_read_b64_tr_b16 v[92:93], v9 offset:12288
  ds_read_b64_tr_b16 v[94:95], v9 offset:12800
  v_mfma_f32_16x16x32_bf16 v[104:107], v[64:67], v[132:135], v[104:107]
  v_cvt_pk_bf16_f32 v241, v114, v115
  v_cvt_pk_bf16_f32 v242, v116, v117
  v_cvt_pk_bf16_f32 v243, v118, v119
  v_mfma_f32_16x16x32_bf16 v[108:111], v[72:75], v[132:135], 0
  ds_read_b64_tr_b16 v[64:65], v8 offset:16384
  ds_read_b64_tr_b16 v[66:67], v8 offset:16896
  v_mfma_f32_16x16x32_bf16 v[108:111], v[76:79], v[140:143], v[108:111]
  v_cvt_pk_bf16_f32 v244, v120, v121
  v_cvt_pk_bf16_f32 v245, v122, v123
  v_mfma_f32_16x16x32_bf16 v[100:103], v[76:79], v[136:139], 0
  ds_read_b64_tr_b16 v[68:69], v8 offset:20480
  ds_read_b64_tr_b16 v[70:71], v8 offset:20992
  v_mfma_f32_16x16x32_bf16 v[100:103], v[72:75], v[128:131], v[100:103]
  v_cvt_pk_bf16_f32 v246, v124, v125
  v_cvt_pk_bf16_f32 v247, v126, v127
  v_cvt_pk_bf16_f32 v248, v16, v17
  s_waitcnt lgkmcnt(4)
  v_mfma_f32_16x16x32_bf16 v[96:99], v[80:83], v[144:147], v[96:99]
  ds_read_b64_tr_b16 v[72:73], v9 offset:16384
  ds_read_b64_tr_b16 v[74:75], v9 offset:16896
  v_mfma_f32_16x16x32_bf16 v[96:99], v[84:87], v[152:155], v[96:99]
  v_cvt_pk_bf16_f32 v249, v18, v19
  v_mfma_f32_16x16x32_bf16 v[104:107], v[84:87], v[156:159], v[104:107]
  ds_read_b64_tr_b16 v[76:77], v9 offset:20480
  ds_read_b64_tr_b16 v[78:79], v9 offset:20992
  v_mfma_f32_16x16x32_bf16 v[104:107], v[80:83], v[148:151], v[104:107]
  ds_read_b32 v6, v4 offset:1384
  v_cvt_pk_bf16_f32 v250, v20, v21
  v_mfma_f32_16x16x32_bf16 v[108:111], v[88:91], v[148:151], v[108:111]
  ds_read_b64_tr_b16 v[80:81], v8 offset:24576
  ds_read_b64_tr_b16 v[82:83], v8 offset:25088
  v_mfma_f32_16x16x32_bf16 v[108:111], v[92:95], v[156:159], v[108:111]
  v_cvt_pk_bf16_f32 v251, v22, v23
  v_cvt_pk_bf16_f32 v252, v24, v25
  v_cvt_pk_bf16_f32 v253, v26, v27
  v_mfma_f32_16x16x32_bf16 v[100:103], v[92:95], v[152:155], v[100:103]
  ds_read_b64_tr_b16 v[84:85], v8 offset:28672
  ds_read_b64_tr_b16 v[86:87], v8 offset:29184
  v_mfma_f32_16x16x32_bf16 v[100:103], v[88:91], v[144:147], v[100:103]
  v_cvt_pk_bf16_f32 v254, v28, v29
  v_cvt_pk_bf16_f32 v255, v30, v31
  s_waitcnt lgkmcnt(5)
  v_mfma_f32_16x16x32_bf16 v[96:99], v[64:67], v[160:163], v[96:99]
  ds_read_b64_tr_b16 v[88:89], v9 offset:24576
  ds_read_b64_tr_b16 v[90:91], v9 offset:25088
  v_mfma_f32_16x16x32_bf16 v[96:99], v[68:71], v[168:171], v[96:99]
  v_mfma_f32_16x16x32_bf16 v[104:107], v[68:71], v[172:175], v[104:107]
  ds_read_b64_tr_b16 v[92:93], v9 offset:28672
  ds_read_b64_tr_b16 v[94:95], v9 offset:29184
  v_mfma_f32_16x16x32_bf16 v[104:107], v[64:67], v[164:167], v[104:107]
  s_waitcnt lgkmcnt(8)
  v_cmp_ne_u32 vcc, 0, v6
  s_cbranch_vccnz L_lp_26
L_lr_27:
  v_mfma_f32_16x16x32_bf16 v[108:111], v[72:75], v[164:167], v[108:111]
  ds_read_b64_tr_b16 v[64:65], v8 offset:32768
  ds_read_b64_tr_b16 v[66:67], v8 offset:33280
  v_mfma_f32_16x16x32_bf16 v[108:111], v[76:79], v[172:175], v[108:111]
  v_and_b32 v15, 48, v0
  v_mfma_f32_16x16x32_bf16 v[100:103], v[76:79], v[168:171], v[100:103]
  ds_read_b64_tr_b16 v[68:69], v8 offset:36864
  ds_read_b64_tr_b16 v[70:71], v8 offset:37376
  v_mfma_f32_16x16x32_bf16 v[100:103], v[72:75], v[160:163], v[100:103]
  v_add_u32 v15, 150144, v15
  s_waitcnt lgkmcnt(4)
  v_mfma_f32_16x16x32_bf16 v[96:99], v[80:83], v[176:179], v[96:99]
  ds_read_b64_tr_b16 v[72:73], v9 offset:32768
  ds_read_b64_tr_b16 v[74:75], v9 offset:33280
  v_mfma_f32_16x16x32_bf16 v[96:99], v[84:87], v[184:187], v[96:99]
  v_mfma_f32_16x16x32_bf16 v[104:107], v[84:87], v[188:191], v[104:107]
  ds_read_b64_tr_b16 v[76:77], v9 offset:36864
  ds_read_b64_tr_b16 v[78:79], v9 offset:37376
  v_mfma_f32_16x16x32_bf16 v[104:107], v[80:83], v[180:183], v[104:107]
  v_lshl_add_u32 v5, s65, 1, v15
  v_mfma_f32_16x16x32_bf16 v[108:111], v[88:91], v[180:183], v[108:111]
  ds_read_b64_tr_b16 v[80:81], v8 offset:40960
  ds_read_b64_tr_b16 v[82:83], v8 offset:41472
  v_mfma_f32_16x16x32_bf16 v[108:111], v[92:95], v[188:191], v[108:111]
  v_xor_b32 v10, 65536, v14
  v_xor_b32 v11, 32, v10
  v_mfma_f32_16x16x32_bf16 v[100:103], v[92:95], v[184:187], v[100:103]
  ds_read_b64_tr_b16 v[84:85], v8 offset:45056
  ds_read_b64_tr_b16 v[86:87], v8 offset:45568
  v_mfma_f32_16x16x32_bf16 v[100:103], v[88:91], v[176:179], v[100:103]
  ds_read_b128 v[40:43], v5 offset:0
  s_waitcnt lgkmcnt(5)
  v_mfma_f32_16x16x32_bf16 v[96:99], v[64:67], v[192:195], v[96:99]
  ds_read_b64_tr_b16 v[88:89], v9 offset:40960
  ds_read_b64_tr_b16 v[90:91], v9 offset:41472
  v_mfma_f32_16x16x32_bf16 v[96:99], v[68:71], v[200:203], v[96:99]
  v_mfma_f32_16x16x32_bf16 v[104:107], v[68:71], v[204:207], v[104:107]
  ds_read_b64_tr_b16 v[92:93], v9 offset:45056
  ds_read_b64_tr_b16 v[94:95], v9 offset:45568
  v_mfma_f32_16x16x32_bf16 v[104:107], v[64:67], v[196:199], v[104:107]
  ds_read_b128 v[44:47], v5 offset:64
  v_mfma_f32_16x16x32_bf16 v[108:111], v[72:75], v[196:199], v[108:111]
  ds_read_b64_tr_b16 v[64:65], v8 offset:49152
  ds_read_b64_tr_b16 v[66:67], v8 offset:49664
  v_mfma_f32_16x16x32_bf16 v[108:111], v[76:79], v[204:207], v[108:111]
  s_lshl_b32 s68, s60, 6
  s_lshl_b32 s69, s56, 3
  v_mfma_f32_16x16x32_bf16 v[100:103], v[76:79], v[200:203], v[100:103]
  ds_read_b64_tr_b16 v[68:69], v8 offset:53248
  ds_read_b64_tr_b16 v[70:71], v8 offset:53760
  v_mfma_f32_16x16x32_bf16 v[100:103], v[72:75], v[192:195], v[100:103]
  s_add_u32 s68, s68, s69
  s_lshl_b32 s68, s68, 10
  s_waitcnt lgkmcnt(5)
  v_mfma_f32_16x16x32_bf16 v[96:99], v[80:83], v[208:211], v[96:99]
  ds_read_b64_tr_b16 v[72:73], v9 offset:49152
  ds_read_b64_tr_b16 v[74:75], v9 offset:49664
  v_mfma_f32_16x16x32_bf16 v[96:99], v[84:87], v[216:219], v[96:99]
  s_lshl_b32 s69, s61, 7
  v_mfma_f32_16x16x32_bf16 v[104:107], v[84:87], v[220:223], v[104:107]
  ds_read_b64_tr_b16 v[76:77], v9 offset:53248
  ds_read_b64_tr_b16 v[78:79], v9 offset:53760
  v_mfma_f32_16x16x32_bf16 v[104:107], v[80:83], v[212:215], v[104:107]
  ds_read_b32 v6, v4 offset:1380
  s_add_u32 s68, s68, s69
  v_mfma_f32_16x16x32_bf16 v[108:111], v[88:91], v[212:215], v[108:111]
  ds_read_b64_tr_b16 v[80:81], v8 offset:57344
  ds_read_b64_tr_b16 v[82:83], v8 offset:57856
  v_mfma_f32_16x16x32_bf16 v[108:111], v[92:95], v[220:223], v[108:111]
  s_xor_b32 s69, s68, 32768
  v_lshrrev_b32 v48, 3, v0
  v_mfma_f32_16x16x32_bf16 v[100:103], v[92:95], v[216:219], v[100:103]
  ds_read_b64_tr_b16 v[84:85], v8 offset:61440
  ds_read_b64_tr_b16 v[86:87], v8 offset:61952
  v_mfma_f32_16x16x32_bf16 v[100:103], v[88:91], v[208:211], v[100:103]
  v_and_b32 v56, 7, v0
  v_lshlrev_b32 v56, 4, v56
  s_waitcnt lgkmcnt(5)
  v_mfma_f32_16x16x32_bf16 v[96:99], v[64:67], v[224:227], v[96:99]
  ds_read_b64_tr_b16 v[88:89], v9 offset:57344
  ds_read_b64_tr_b16 v[90:91], v9 offset:57856
  v_mfma_f32_16x16x32_bf16 v[96:99], v[68:71], v[232:235], v[96:99]
  v_lshl_add_u32 v56, v48, 10, v56
  v_mfma_f32_16x16x32_bf16 v[104:107], v[68:71], v[236:239], v[104:107]
  ds_read_b64_tr_b16 v[92:93], v9 offset:61440
  ds_read_b64_tr_b16 v[94:95], v9 offset:61952
  v_mfma_f32_16x16x32_bf16 v[104:107], v[64:67], v[228:231], v[104:107]
  s_waitcnt lgkmcnt(8)
  v_cmp_ne_u32 vcc, 0, v6
  s_cbranch_vccnz L_lp_28
L_lr_29:
  v_mfma_f32_16x16x32_bf16 v[108:111], v[72:75], v[228:231], v[108:111]
  ds_read_b64_tr_b16 v[64:65], v10 offset:0
  ds_read_b64_tr_b16 v[66:67], v10 offset:512
  v_mfma_f32_16x16x32_bf16 v[108:111], v[76:79], v[236:239], v[108:111]
  buffer_load_dwordx4 v[48:51], v56, s[4:7], s68 offen
  buffer_load_dwordx4 v[52:55], v56, s[4:7], s69 offen
  v_mfma_f32_16x16x32_bf16 v[100:103], v[76:79], v[232:235], v[100:103]
  ds_read_b64_tr_b16 v[68:69], v10 offset:4096
  ds_read_b64_tr_b16 v[70:71], v10 offset:4608
  v_mfma_f32_16x16x32_bf16 v[100:103], v[72:75], v[224:227], v[100:103]
  s_waitcnt lgkmcnt(4)
  v_mfma_f32_16x16x32_bf16 v[96:99], v[80:83], v[240:243], v[96:99]
  ds_read_b64_tr_b16 v[72:73], v11 offset:0
  ds_read_b64_tr_b16 v[74:75], v11 offset:512
  v_mfma_f32_16x16x32_bf16 v[96:99], v[84:87], v[248:251], v[96:99]
  s_barrier
  v_mfma_f32_16x16x32_bf16 v[104:107], v[84:87], v[252:255], v[104:107]
  ds_read_b64_tr_b16 v[76:77], v11 offset:4096
  ds_read_b64_tr_b16 v[78:79], v11 offset:4608
  v_mfma_f32_16x16x32_bf16 v[104:107], v[80:83], v[244:247], v[104:107]
  v_mfma_f32_16x16x32_bf16 v[108:111], v[88:91], v[244:247], v[108:111]
  ds_read_b64_tr_b16 v[80:81], v10 offset:8192
  ds_read_b64_tr_b16 v[82:83], v10 offset:8704
  v_mfma_f32_16x16x32_bf16 v[108:111], v[92:95], v[252:255], v[108:111]
  v_mfma_f32_16x16x32_bf16 v[100:103], v[92:95], v[248:251], v[100:103]
  ds_read_b64_tr_b16 v[84:85], v10 offset:12288
  ds_read_b64_tr_b16 v[86:87], v10 offset:12800
  v_mfma_f32_16x16x32_bf16 v[100:103], v[88:91], v[240:243], v[100:103]
  s_waitcnt lgkmcnt(4)
  v_mfma_f32_16x16x32_bf16 v[112:115], v[64:67], v[128:131], 0
  ds_read_b64_tr_b16 v[88:89], v11 offset:8192
  ds_read_b64_tr_b16 v[90:91], v11 offset:8704
  v_mfma_f32_16x16x32_bf16 v[112:115], v[68:71], v[136:139], v[112:115]
  v_mfma_f32_16x16x32_bf16 v[120:123], v[68:71], v[140:143], 0
  ds_read_b64_tr_b16 v[92:93], v11 offset:12288
  ds_read_b64_tr_b16 v[94:95], v11 offset:12800
  v_mfma_f32_16x16x32_bf16 v[120:123], v[64:67], v[132:135], v[120:123]
  v_fma_f32 v16, v96, v12, v40
  v_fma_f32 v17, v97, v12, v41
  v_fma_f32 v18, v98, v12, v42
  v_fma_f32 v19, v99, v12, v43
  v_mfma_f32_16x16x32_bf16 v[124:127], v[72:75], v[132:135], 0
  ds_read_b64_tr_b16 v[64:65], v10 offset:16384
  ds_read_b64_tr_b16 v[66:67], v10 offset:16896
  v_mfma_f32_16x16x32_bf16 v[124:127], v[76:79], v[140:143], v[124:127]
  v_exp_f32 v24, v16
  v_exp_f32 v25, v17
  v_exp_f32 v26, v18
  v_mfma_f32_16x16x32_bf16 v[116:119], v[76:79], v[136:139], 0
  ds_read_b64_tr_b16 v[68:69], v10 offset:20480
  ds_read_b64_tr_b16 v[70:71], v10 offset:20992
  v_mfma_f32_16x16x32_bf16 v[116:119], v[72:75], v[128:131], v[116:119]
  v_exp_f32 v27, v19
  v_fma_f32 v28, v24, -0.5, -1.0
  v_fma_f32 v29, v25, -0.5, -1.0
  s_waitcnt lgkmcnt(4)
  v_mfma_f32_16x16x32_bf16 v[112:115], v[80:83], v[144:147], v[112:115]
  ds_read_b64_tr_b16 v[72:73], v11 offset:16384
  ds_read_b64_tr_b16 v[74:75], v11 offset:16896
  v_mfma_f32_16x16x32_bf16 v[112:115], v[84:87], v[152:155], v[112:115]
  v_fma_f32 v30, v26, -0.5, -1.0
  v_fma_f32 v31, v27, -0.5, -1.0
  v_fma_f32 v28, v24, v28, -1.0
  v_fma_f32 v29, v25, v29, -1.0
  v_mfma_f32_16x16x32_bf16 v[120:123], v[84:87], v[156:159], v[120:123]
  ds_read_b64_tr_b16 v[76:77], v11 offset:20480
  ds_read_b64_tr_b16 v[78:79], v11 offset:20992
  v_mfma_f32_16x16x32_bf16 v[120:123], v[80:83], v[148:151], v[120:123]
  ds_read_b32 v6, v4 offset:1376
  v_fma_f32 v30, v26, v30, -1.0
  v_fma_f32 v31, v27, v31, -1.0
  v_rcp_f32 v28, v28
  v_mfma_f32_16x16x32_bf16 v[124:127], v[88:91], v[148:151], v[124:127]
  ds_read_b64_tr_b16 v[80:81], v10 offset:24576
  ds_read_b64_tr_b16 v[82:83], v10 offset:25088
  v_mfma_f32_16x16x32_bf16 v[124:127], v[92:95], v[156:159], v[124:127]
  v_rcp_f32 v29, v29
  v_rcp_f32 v30, v30
  v_mfma_f32_16x16x32_bf16 v[116:119], v[92:95], v[152:155], v[116:119]
  ds_read_b64_tr_b16 v[84:85], v10 offset:28672
  ds_read_b64_tr_b16 v[86:87], v10 offset:29184
  v_mfma_f32_16x16x32_bf16 v[116:119], v[88:91], v[144:147], v[116:119]
  v_rcp_f32 v31, v31
  v_fmac_f32 v16, v16, v28
  v_fmac_f32 v17, v17, v29
  v_fmac_f32 v18, v18, v30
  s_waitcnt lgkmcnt(5)
  v_mfma_f32_16x16x32_bf16 v[112:115], v[64:67], v[160:163], v[112:115]
  ds_read_b64_tr_b16 v[88:89], v11 offset:24576
  ds_read_b64_tr_b16 v[90:91], v11 offset:25088
  v_mfma_f32_16x16x32_bf16 v[112:115], v[68:71], v[168:171], v[112:115]
  v_fmac_f32 v19, v19, v31
  v_cvt_pk_bf16_f32 v32, v16, v17
  v_cvt_pk_bf16_f32 v33, v18, v19
  v_fma_f32 v20, v100, v12, v44
  v_mfma_f32_16x16x32_bf16 v[120:123], v[68:71], v[172:175], v[120:123]
  ds_read_b64_tr_b16 v[92:93], v11 offset:28672
  ds_read_b64_tr_b16 v[94:95], v11 offset:29184
  v_mfma_f32_16x16x32_bf16 v[120:123], v[64:67], v[164:167], v[120:123]
  s_waitcnt lgkmcnt(8)
  v_cmp_ne_u32 vcc, 0, v6
  s_cbranch_vccnz L_lp_30
L_lr_31:
  v_fma_f32 v21, v101, v12, v45
  v_fma_f32 v22, v102, v12, v46
  v_fma_f32 v23, v103, v12, v47
  v_mfma_f32_16x16x32_bf16 v[124:127], v[72:75], v[164:167], v[124:127]
  ds_read_b64_tr_b16 v[64:65], v10 offset:32768
  ds_read_b64_tr_b16 v[66:67], v10 offset:33280
  v_mfma_f32_16x16x32_bf16 v[124:127], v[76:79], v[172:175], v[124:127]
  v_exp_f32 v24, v20
  v_exp_f32 v25, v21
  v_mfma_f32_16x16x32_bf16 v[116:119], v[76:79], v[168:171], v[116:119]
  ds_read_b64_tr_b16 v[68:69], v10 offset:36864
  ds_read_b64_tr_b16 v[70:71], v10 offset:37376
  v_mfma_f32_16x16x32_bf16 v[116:119], v[72:75], v[160:163], v[116:119]
  v_exp_f32 v26, v22
  v_exp_f32 v27, v23
  v_fma_f32 v28, v24, -0.5, -1.0
  v_fma_f32 v29, v25, -0.5, -1.0
  s_waitcnt lgkmcnt(4)
  v_mfma_f32_16x16x32_bf16 v[112:115], v[80:83], v[176:179], v[112:115]
  ds_read_b64_tr_b16 v[72:73], v11 offset:32768
  ds_read_b64_tr_b16 v[74:75], v11 offset:33280
  v_mfma_f32_16x16x32_bf16 v[112:115], v[84:87], v[184:187], v[112:115]
  v_fma_f32 v30, v26, -0.5, -1.0
  v_fma_f32 v31, v27, -0.5, -1.0
  v_fma_f32 v28, v24, v28, -1.0
  v_mfma_f32_16x16x32_bf16 v[120:123], v[84:87], v[188:191], v[120:123]
  ds_read_b64_tr_b16 v[76:77], v11 offset:36864
  ds_read_b64_tr_b16 v[78:79], v11 offset:37376
  v_mfma_f32_16x16x32_bf16 v[120:123], v[80:83], v[180:183], v[120:123]
  v_fma_f32 v29, v25, v29, -1.0
  v_fma_f32 v30, v26, v30, -1.0
  v_fma_f32 v31, v27, v31, -1.0
  v_rcp_f32 v28, v28
  v_mfma_f32_16x16x32_bf16 v[124:127], v[88:91], v[180:183], v[124:127]
  ds_read_b64_tr_b16 v[80:81], v10 offset:40960
  ds_read_b64_tr_b16 v[82:83], v10 offset:41472
  v_mfma_f32_16x16x32_bf16 v[124:127], v[92:95], v[188:191], v[124:127]
  v_xor_b32 v8, 65600, v14
  v_xor_b32 v9, 32, v8
  v_rcp_f32 v29, v29
  v_mfma_f32_16x16x32_bf16 v[116:119], v[92:95], v[184:187], v[116:119]
  ds_read_b64_tr_b16 v[84:85], v10 offset:45056
  ds_read_b64_tr_b16 v[86:87], v10 offset:45568
  v_mfma_f32_16x16x32_bf16 v[116:119], v[88:91], v[176:179], v[116:119]
  v_rcp_f32 v30, v30
  v_rcp_f32 v31, v31
  v_fmac_f32 v20, v20, v28
  v_fmac_f32 v21, v21, v29
  s_waitcnt lgkmcnt(4)
  v_mfma_f32_16x16x32_bf16 v[112:115], v[64:67], v[192:195], v[112:115]
  ds_read_b64_tr_b16 v[88:89], v11 offset:40960
  ds_read_b64_tr_b16 v[90:91], v11 offset:41472
  v_mfma_f32_16x16x32_bf16 v[112:115], v[68:71], v[200:203], v[112:115]
  v_fmac_f32 v22, v22, v30
  v_fmac_f32 v23, v23, v31
  v_cvt_pk_bf16_f32 v34, v20, v21
  v_cvt_pk_bf16_f32 v35, v22, v23
  v_mfma_f32_16x16x32_bf16 v[120:123], v[68:71], v[204:207], v[120:123]
  ds_read_b64_tr_b16 v[92:93], v11 offset:45056
  ds_read_b64_tr_b16 v[94:95], v11 offset:45568
  v_mfma_f32_16x16x32_bf16 v[120:123], v[64:67], v[196:199], v[120:123]
  buffer_store_dwordx4 v[32:35], v1, s[12:15], s70 offen offset:0 sc1
  v_fma_f32 v16, v104, v13, v40
  v_fma_f32 v17, v105, v13, v41
  v_fma_f32 v18, v106, v13, v42
  v_mfma_f32_16x16x32_bf16 v[124:127], v[72:75], v[196:199], v[124:127]
  ds_read_b64_tr_b16 v[64:65], v10 offset:49152
  ds_read_b64_tr_b16 v[66:67], v10 offset:49664
  v_mfma_f32_16x16x32_bf16 v[124:127], v[76:79], v[204:207], v[124:127]
  v_fma_f32 v19, v107, v13, v43
  ds_read_b128 v[40:43], v15 offset:256
  v_exp_f32 v24, v16
  v_exp_f32 v25, v17
  v_mfma_f32_16x16x32_bf16 v[116:119], v[76:79], v[200:203], v[116:119]
  ds_read_b64_tr_b16 v[68:69], v10 offset:53248
  ds_read_b64_tr_b16 v[70:71], v10 offset:53760
  v_mfma_f32_16x16x32_bf16 v[116:119], v[72:75], v[192:195], v[116:119]
  v_exp_f32 v26, v18
  v_exp_f32 v27, v19
  s_waitcnt lgkmcnt(5)
  v_mfma_f32_16x16x32_bf16 v[112:115], v[80:83], v[208:211], v[112:115]
  ds_read_b64_tr_b16 v[72:73], v11 offset:49152
  ds_read_b64_tr_b16 v[74:75], v11 offset:49664
  v_mfma_f32_16x16x32_bf16 v[112:115], v[84:87], v[216:219], v[112:115]
  v_fma_f32 v28, v24, -0.5, -1.0
  v_fma_f32 v29, v25, -0.5, -1.0
  v_fma_f32 v30, v26, -0.5, -1.0
  v_fma_f32 v31, v27, -0.5, -1.0
  v_mfma_f32_16x16x32_bf16 v[120:123], v[84:87], v[220:223], v[120:123]
  ds_read_b64_tr_b16 v[76:77], v11 offset:53248
  ds_read_b64_tr_b16 v[78:79], v11 offset:53760
  v_mfma_f32_16x16x32_bf16 v[120:123], v[80:83], v[212:215], v[120:123]
  v_fma_f32 v28, v24, v28, -1.0
  v_fma_f32 v29, v25, v29, -1.0
  v_fma_f32 v30, v26, v30, -1.0
  v_fma_f32 v31, v27, v31, -1.0
  v_mfma_f32_16x16x32_bf16 v[124:127], v[88:91], v[212:215], v[124:127]
  ds_read_b64_tr_b16 v[80:81], v10 offset:57344
  ds_read_b64_tr_b16 v[82:83], v10 offset:57856
  v_mfma_f32_16x16x32_bf16 v[124:127], v[92:95], v[220:223], v[124:127]
  v_rcp_f32 v28, v28
  v_rcp_f32 v29, v29
  v_rcp_f32 v30, v30
  v_mfma_f32_16x16x32_bf16 v[116:119], v[92:95], v[216:219], v[116:119]
  ds_read_b64_tr_b16 v[84:85], v10 offset:61440
  ds_read_b64_tr_b16 v[86:87], v10 offset:61952
  v_mfma_f32_16x16x32_bf16 v[116:119], v[88:91], v[208:211], v[116:119]
  v_rcp_f32 v31, v31
  v_fmac_f32 v16, v16, v28
  v_fmac_f32 v17, v17, v29
  s_waitcnt lgkmcnt(4)
  v_mfma_f32_16x16x32_bf16 v[112:115], v[64:67], v[224:227], v[112:115]
  ds_read_b64_tr_b16 v[88:89], v11 offset:57344
  ds_read_b64_tr_b16 v[90:91], v11 offset:57856
  v_mfma_f32_16x16x32_bf16 v[112:115], v[68:71], v[232:235], v[112:115]
  v_fmac_f32 v18, v18, v30
  v_fmac_f32 v19, v19, v31
  v_cvt_pk_bf16_f32 v36, v16, v17
  v_cvt_pk_bf16_f32 v37, v18, v19
  v_mfma_f32_16x16x32_bf16 v[120:123], v[68:71], v[236:239], v[120:123]
  ds_read_b64_tr_b16 v[92:93], v11 offset:61440
  ds_read_b64_tr_b16 v[94:95], v11 offset:61952
  v_mfma_f32_16x16x32_bf16 v[120:123], v[64:67], v[228:231], v[120:123]
  v_fma_f32 v20, v108, v13, v44
  v_fma_f32 v21, v109, v13, v45
  v_fma_f32 v22, v110, v13, v46
  v_fma_f32 v23, v111, v13, v47
  ds_read_b128 v[44:47], v15 offset:320
  v_mfma_f32_16x16x32_bf16 v[124:127], v[72:75], v[228:231], v[124:127]
  ds_read_b64_tr_b16 v[64:65], v8 offset:0
  ds_read_b64_tr_b16 v[66:67], v8 offset:512
  v_mfma_f32_16x16x32_bf16 v[124:127], v[76:79], v[236:239], v[124:127]
  v_exp_f32 v24, v20
  v_exp_f32 v25, v21
  v_mfma_f32_16x16x32_bf16 v[116:119], v[76:79], v[232:235], v[116:119]
  ds_read_b64_tr_b16 v[68:69], v8 offset:4096
  ds_read_b64_tr_b16 v[70:71], v8 offset:4608
  v_mfma_f32_16x16x32_bf16 v[116:119], v[72:75], v[224:227], v[116:119]
  v_exp_f32 v26, v22
  v_exp_f32 v27, v23
  v_fma_f32 v28, v24, -0.5, -1.0
  s_waitcnt lgkmcnt(5)
  v_mfma_f32_16x16x32_bf16 v[112:115], v[80:83], v[240:243], v[112:115]
  ds_read_b64_tr_b16 v[72:73], v9 offset:0
  ds_read_b64_tr_b16 v[74:75], v9 offset:512
  v_mfma_f32_16x16x32_bf16 v[112:115], v[84:87], v[248:251], v[112:115]
  v_fma_f32 v29, v25, -0.5, -1.0
  v_fma_f32 v30, v26, -0.5, -1.0
  v_fma_f32 v31, v27, -0.5, -1.0
  v_fma_f32 v28, v24, v28, -1.0
  v_mfma_f32_16x16x32_bf16 v[120:123], v[84:87], v[252:255], v[120:123]
  ds_read_b64_tr_b16 v[76:77], v9 offset:4096
  ds_read_b64_tr_b16 v[78:79], v9 offset:4608
  v_mfma_f32_16x16x32_bf16 v[120:123], v[80:83], v[244:247], v[120:123]
  v_fma_f32 v29, v25, v29, -1.0
  v_fma_f32 v30, v26, v30, -1.0
  v_fma_f32 v31, v27, v31, -1.0
  v_rcp_f32 v28, v28
  v_mfma_f32_16x16x32_bf16 v[124:127], v[88:91], v[244:247], v[124:127]
  ds_read_b64_tr_b16 v[80:81], v8 offset:8192
  ds_read_b64_tr_b16 v[82:83], v8 offset:8704
  v_mfma_f32_16x16x32_bf16 v[124:127], v[92:95], v[252:255], v[124:127]
  v_rcp_f32 v29, v29
  v_rcp_f32 v30, v30
  v_mfma_f32_16x16x32_bf16 v[116:119], v[92:95], v[248:251], v[116:119]
  ds_read_b64_tr_b16 v[84:85], v8 offset:12288
  ds_read_b64_tr_b16 v[86:87], v8 offset:12800
  v_mfma_f32_16x16x32_bf16 v[116:119], v[88:91], v[240:243], v[116:119]
  v_rcp_f32 v31, v31
  v_fmac_f32 v20, v20, v28
  v_fmac_f32 v21, v21, v29
  v_fmac_f32 v22, v22, v30
  s_waitcnt lgkmcnt(4)
  v_mfma_f32_16x16x32_bf16 v[96:99], v[64:67], v[128:131], 0
  ds_read_b64_tr_b16 v[88:89], v9 offset:8192
  ds_read_b64_tr_b16 v[90:91], v9 offset:8704
  v_mfma_f32_16x16x32_bf16 v[96:99], v[68:71], v[136:139], v[96:99]
  v_fmac_f32 v23, v23, v31
  v_cvt_pk_bf16_f32 v38, v20, v21
  v_cvt_pk_bf16_f32 v39, v22, v23
  buffer_store_dwordx4 v[36:39], v1, s[12:15], s70 offen offset:2048 sc1
  v_mfma_f32_16x16x32_bf16 v[104:107], v[68:71], v[140:143], 0
  ds_read_b64_tr_b16 v[92:93], v9 offset:12288
  ds_read_b64_tr_b16 v[94:95], v9 offset:12800
  v_mfma_f32_16x16x32_bf16 v[104:107], v[64:67], v[132:135], v[104:107]
  v_fma_f32 v16, v112, v12, v40
  v_fma_f32 v17, v113, v12, v41
  v_fma_f32 v18, v114, v12, v42
  v_fma_f32 v19, v115, v12, v43
  v_mfma_f32_16x16x32_bf16 v[108:111], v[72:75], v[132:135], 0
  ds_read_b64_tr_b16 v[64:65], v8 offset:16384
  ds_read_b64_tr_b16 v[66:67], v8 offset:16896
  v_mfma_f32_16x16x32_bf16 v[108:111], v[76:79], v[140:143], v[108:111]
  v_exp_f32 v24, v16
  v_exp_f32 v25, v17
  v_exp_f32 v26, v18
  v_mfma_f32_16x16x32_bf16 v[100:103], v[76:79], v[136:139], 0
  ds_read_b64_tr_b16 v[68:69], v8 offset:20480
  ds_read_b64_tr_b16 v[70:71], v8 offset:20992
  v_mfma_f32_16x16x32_bf16 v[100:103], v[72:75], v[128:131], v[100:103]
  v_exp_f32 v27, v19
  v_fma_f32 v28, v24, -0.5, -1.0
  v_fma_f32 v29, v25, -0.5, -1.0
  v_fma_f32 v30, v26, -0.5, -1.0
  s_waitcnt lgkmcnt(4)
  v_mfma_f32_16x16x32_bf16 v[96:99], v[80:83], v[144:147], v[96:99]
  ds_read_b64_tr_b16 v[72:73], v9 offset:16384
  ds_read_b64_tr_b16 v[74:75], v9 offset:16896
  v_mfma_f32_16x16x32_bf16 v[96:99], v[84:87], v[152:155], v[96:99]
  v_fma_f32 v31, v27, -0.5, -1.0
  v_fma_f32 v28, v24, v28, -1.0
  v_fma_f32 v29, v25, v29, -1.0
  v_fma_f32 v30, v26, v30, -1.0
  v_mfma_f32_16x16x32_bf16 v[104:107], v[84:87], v[156:159], v[104:107]
  ds_read_b64_tr_b16 v[76:77], v9 offset:20480
  ds_read_b64_tr_b16 v[78:79], v9 offset:20992
  v_mfma_f32_16x16x32_bf16 v[104:107], v[80:83], v[148:151], v[104:107]
  v_fma_f32 v31, v27, v31, -1.0
  v_rcp_f32 v28, v28
  v_rcp_f32 v29, v29
  v_mfma_f32_16x16x32_bf16 v[108:111], v[88:91], v[148:151], v[108:111]
  ds_read_b64_tr_b16 v[80:81], v8 offset:24576
  ds_read_b64_tr_b16 v[82:83], v8 offset:25088
  v_mfma_f32_16x16x32_bf16 v[108:111], v[92:95], v[156:159], v[108:111]
  v_rcp_f32 v30, v30
  v_rcp_f32 v31, v31
  v_mfma_f32_16x16x32_bf16 v[100:103], v[92:95], v[152:155], v[100:103]
  ds_read_b64_tr_b16 v[84:85], v8 offset:28672
  ds_read_b64_tr_b16 v[86:87], v8 offset:29184
  v_mfma_f32_16x16x32_bf16 v[100:103], v[88:91], v[144:147], v[100:103]
  v_fmac_f32 v16, v16, v28
  v_fmac_f32 v17, v17, v29
  v_fmac_f32 v18, v18, v30
  v_fmac_f32 v19, v19, v31
  v_cvt_pk_bf16_f32 v32, v16, v17
  s_waitcnt lgkmcnt(4)
  v_mfma_f32_16x16x32_bf16 v[96:99], v[64:67], v[160:163], v[96:99]
  ds_read_b64_tr_b16 v[88:89], v9 offset:24576
  ds_read_b64_tr_b16 v[90:91], v9 offset:25088
  v_mfma_f32_16x16x32_bf16 v[96:99], v[68:71], v[168:171], v[96:99]
  v_cvt_pk_bf16_f32 v33, v18, v19
  s_add_u32 s70, s70, 8192
  v_fma_f32 v20, v116, v12, v44
  v_fma_f32 v21, v117, v12, v45
  v_mfma_f32_16x16x32_bf16 v[104:107], v[68:71], v[172:175], v[104:107]
  ds_read_b64_tr_b16 v[92:93], v9 offset:28672
  ds_read_b64_tr_b16 v[94:95], v9 offset:29184
  v_mfma_f32_16x16x32_bf16 v[104:107], v[64:67], v[164:167], v[104:107]
  v_fma_f32 v22, v118, v12, v46
  v_fma_f32 v23, v119, v12, v47
  v_exp_f32 v24, v20
  v_exp_f32 v25, v21
  v_mfma_f32_16x16x32_bf16 v[108:111], v[72:75], v[164:167], v[108:111]
  ds_read_b64_tr_b16 v[64:65], v8 offset:32768
  ds_read_b64_tr_b16 v[66:67], v8 offset:33280
  v_mfma_f32_16x16x32_bf16 v[108:111], v[76:79], v[172:175], v[108:111]
  v_exp_f32 v26, v22
  v_exp_f32 v27, v23
  v_mfma_f32_16x16x32_bf16 v[100:103], v[76:79], v[168:171], v[100:103]
  ds_read_b64_tr_b16 v[68:69], v8 offset:36864
  ds_read_b64_tr_b16 v[70:71], v8 offset:37376
  v_mfma_f32_16x16x32_bf16 v[100:103], v[72:75], v[160:163], v[100:103]
  v_fma_f32 v28, v24, -0.5, -1.0
  v_fma_f32 v29, v25, -0.5, -1.0
  v_fma_f32 v30, v26, -0.5, -1.0
  v_fma_f32 v31, v27, -0.5, -1.0
  v_fma_f32 v28, v24, v28, -1.0
  s_waitcnt lgkmcnt(4)
  v_mfma_f32_16x16x32_bf16 v[96:99], v[80:83], v[176:179], v[96:99]
  ds_read_b64_tr_b16 v[72:73], v9 offset:32768
  ds_read_b64_tr_b16 v[74:75], v9 offset:33280
  v_mfma_f32_16x16x32_bf16 v[96:99], v[84:87], v[184:187], v[96:99]
  v_fma_f32 v29, v25, v29, -1.0
  v_fma_f32 v30, v26, v30, -1.0
  v_fma_f32 v31, v27, v31, -1.0
  v_mfma_f32_16x16x32_bf16 v[104:107], v[84:87], v[188:191], v[104:107]
  ds_read_b64_tr_b16 v[76:77], v9 offset:36864
  ds_read_b64_tr_b16 v[78:79], v9 offset:37376
  v_mfma_f32_16x16x32_bf16 v[104:107], v[80:83], v[180:183], v[104:107]
  v_rcp_f32 v28, v28
  v_rcp_f32 v29, v29
  v_rcp_f32 v30, v30
  v_mfma_f32_16x16x32_bf16 v[108:111], v[88:91], v[180:183], v[108:111]
  ds_read_b64_tr_b16 v[80:81], v8 offset:40960
  ds_read_b64_tr_b16 v[82:83], v8 offset:41472
  v_mfma_f32_16x16x32_bf16 v[108:111], v[92:95], v[188:191], v[108:111]
  v_xor_b32 v10, 0, v14
  v_xor_b32 v11, 32, v10
  v_rcp_f32 v31, v31
  v_fmac_f32 v20, v20, v28
  v_mfma_f32_16x16x32_bf16 v[100:103], v[92:95], v[184:187], v[100:103]
  ds_read_b64_tr_b16 v[84:85], v8 offset:45056
  ds_read_b64_tr_b16 v[86:87], v8 offset:45568
  v_mfma_f32_16x16x32_bf16 v[100:103], v[88:91], v[176:179], v[100:103]
  v_fmac_f32 v21, v21, v29
  v_fmac_f32 v22, v22, v30
  v_fmac_f32 v23, v23, v31
  v_cvt_pk_bf16_f32 v34, v20, v21
  v_cvt_pk_bf16_f32 v35, v22, v23
  s_waitcnt lgkmcnt(4)
  v_mfma_f32_16x16x32_bf16 v[96:99], v[64:67], v[192:195], v[96:99]
  ds_read_b64_tr_b16 v[88:89], v9 offset:40960
  ds_read_b64_tr_b16 v[90:91], v9 offset:41472
  v_mfma_f32_16x16x32_bf16 v[96:99], v[68:71], v[200:203], v[96:99]
  buffer_store_dwordx4 v[32:35], v1, s[12:15], s70 offen offset:0 sc1
  v_fma_f32 v16, v120, v13, v40
  v_fma_f32 v17, v121, v13, v41
  v_fma_f32 v18, v122, v13, v42
  v_mfma_f32_16x16x32_bf16 v[104:107], v[68:71], v[204:207], v[104:107]
  ds_read_b64_tr_b16 v[92:93], v9 offset:45056
  ds_read_b64_tr_b16 v[94:95], v9 offset:45568
  v_mfma_f32_16x16x32_bf16 v[104:107], v[64:67], v[196:199], v[104:107]
  v_fma_f32 v19, v123, v13, v43
  ds_read_b128 v[40:43], v15 offset:384
  v_exp_f32 v24, v16
  v_mfma_f32_16x16x32_bf16 v[108:111], v[72:75], v[196:199], v[108:111]
  ds_read_b64_tr_b16 v[64:65], v8 offset:49152
  ds_read_b64_tr_b16 v[66:67], v8 offset:49664
  v_mfma_f32_16x16x32_bf16 v[108:111], v[76:79], v[204:207], v[108:111]
  v_exp_f32 v25, v17
  v_exp_f32 v26, v18
  v_exp_f32 v27, v19
  v_mfma_f32_16x16x32_bf16 v[100:103], v[76:79], v[200:203], v[100:103]
  ds_read_b64_tr_b16 v[68:69], v8 offset:53248
  ds_read_b64_tr_b16 v[70:71], v8 offset:53760
  v_mfma_f32_16x16x32_bf16 v[100:103], v[72:75], v[192:195], v[100:103]
  v_fma_f32 v28, v24, -0.5, -1.0
  v_fma_f32 v29, v25, -0.5, -1.0
  v_fma_f32 v30, v26, -0.5, -1.0
  v_fma_f32 v31, v27, -0.5, -1.0
  s_waitcnt lgkmcnt(5)
  v_mfma_f32_16x16x32_bf16 v[96:99], v[80:83], v[208:211], v[96:99]
  ds_read_b64_tr_b16 v[72:73], v9 offset:49152
  ds_read_b64_tr_b16 v[74:75], v9 offset:49664
  v_mfma_f32_16x16x32_bf16 v[96:99], v[84:87], v[216:219], v[96:99]
  v_fma_f32 v28, v24, v28, -1.0
  v_fma_f32 v29, v25, v29, -1.0
  v_fma_f32 v30, v26, v30, -1.0
  v_fma_f32 v31, v27, v31, -1.0
  v_mfma_f32_16x16x32_bf16 v[104:107], v[84:87], v[220:223], v[104:107]
  ds_read_b64_tr_b16 v[76:77], v9 offset:53248
  ds_read_b64_tr_b16 v[78:79], v9 offset:53760
  v_mfma_f32_16x16x32_bf16 v[104:107], v[80:83], v[212:215], v[104:107]
  ds_read_b32 v6, v4 offset:1368
  v_rcp_f32 v28, v28
  v_rcp_f32 v29, v29
  v_mfma_f32_16x16x32_bf16 v[108:111], v[88:91], v[212:215], v[108:111]
  ds_read_b64_tr_b16 v[80:81], v8 offset:57344
  ds_read_b64_tr_b16 v[82:83], v8 offset:57856
  v_mfma_f32_16x16x32_bf16 v[108:111], v[92:95], v[220:223], v[108:111]
  v_rcp_f32 v30, v30
  v_rcp_f32 v31, v31
  v_fmac_f32 v16, v16, v28
  v_mfma_f32_16x16x32_bf16 v[100:103], v[92:95], v[216:219], v[100:103]
  ds_read_b64_tr_b16 v[84:85], v8 offset:61440
  ds_read_b64_tr_b16 v[86:87], v8 offset:61952
  v_mfma_f32_16x16x32_bf16 v[100:103], v[88:91], v[208:211], v[100:103]
  v_fmac_f32 v17, v17, v29
  v_fmac_f32 v18, v18, v30
  v_fmac_f32 v19, v19, v31
  v_cvt_pk_bf16_f32 v36, v16, v17
  v_cvt_pk_bf16_f32 v37, v18, v19
  s_waitcnt lgkmcnt(5)
  v_mfma_f32_16x16x32_bf16 v[96:99], v[64:67], v[224:227], v[96:99]
  ds_read_b64_tr_b16 v[88:89], v9 offset:57344
  ds_read_b64_tr_b16 v[90:91], v9 offset:57856
  v_mfma_f32_16x16x32_bf16 v[96:99], v[68:71], v[232:235], v[96:99]
  v_fma_f32 v20, v124, v13, v44
  v_fma_f32 v21, v125, v13, v45
  v_fma_f32 v22, v126, v13, v46
  v_fma_f32 v23, v127, v13, v47
  v_mfma_f32_16x16x32_bf16 v[104:107], v[68:71], v[236:239], v[104:107]
  ds_read_b64_tr_b16 v[92:93], v9 offset:61440
  ds_read_b64_tr_b16 v[94:95], v9 offset:61952
  v_mfma_f32_16x16x32_bf16 v[104:107], v[64:67], v[228:231], v[104:107]
  s_waitcnt lgkmcnt(8)
  v_cmp_ne_u32 vcc, 0, v6
  s_cbranch_vccnz L_lp_32
L_lr_33:
  ds_write_b32 v2, v3 offset:56
  ds_read_b128 v[44:47], v15 offset:448
  v_mfma_f32_16x16x32_bf16 v[108:111], v[72:75], v[228:231], v[108:111]
  ds_read_b64_tr_b16 v[64:65], v10 offset:0
  ds_read_b64_tr_b16 v[66:67], v10 offset:512
  v_mfma_f32_16x16x32_bf16 v[108:111], v[76:79], v[236:239], v[108:111]
  v_exp_f32 v24, v20
  v_exp_f32 v25, v21
  v_exp_f32 v26, v22
  v_mfma_f32_16x16x32_bf16 v[100:103], v[76:79], v[232:235], v[100:103]
  ds_read_b64_tr_b16 v[68:69], v10 offset:4096
  ds_read_b64_tr_b16 v[70:71], v10 offset:4608
  v_mfma_f32_16x16x32_bf16 v[100:103], v[72:75], v[224:227], v[100:103]
  v_exp_f32 v27, v23
  v_fma_f32 v28, v24, -0.5, -1.0
  v_fma_f32 v29, v25, -0.5, -1.0
  s_waitcnt lgkmcnt(6)
  v_mfma_f32_16x16x32_bf16 v[96:99], v[80:83], v[240:243], v[96:99]
  ds_read_b64_tr_b16 v[72:73], v11 offset:0
  ds_read_b64_tr_b16 v[74:75], v11 offset:512
  v_mfma_f32_16x16x32_bf16 v[96:99], v[84:87], v[248:251], v[96:99]
  v_fma_f32 v30, v26, -0.5, -1.0
  v_fma_f32 v31, v27, -0.5, -1.0
  v_fma_f32 v28, v24, v28, -1.0
  v_fma_f32 v29, v25, v29, -1.0
  v_mfma_f32_16x16x32_bf16 v[104:107], v[84:87], v[252:255], v[104:107]
  ds_read_b64_tr_b16 v[76:77], v11 offset:4096
  ds_read_b64_tr_b16 v[78:79], v11 offset:4608
  v_mfma_f32_16x16x32_bf16 v[104:107], v[80:83], v[244:247], v[104:107]
  v_fma_f32 v30, v26, v30, -1.0
  v_fma_f32 v31, v27, v31, -1.0
  v_rcp_f32 v28, v28
  v_rcp_f32 v29, v29
  v_mfma_f32_16x16x32_bf16 v[108:111], v[88:91], v[244:247], v[108:111]
  ds_read_b64_tr_b16 v[80:81], v10 offset:8192
  ds_read_b64_tr_b16 v[82:83], v10 offset:8704
  v_mfma_f32_16x16x32_bf16 v[108:111], v[92:95], v[252:255], v[108:111]
  v_rcp_f32 v30, v30
  v_rcp_f32 v31, v31
  v_mfma_f32_16x16x32_bf16 v[100:103], v[92:95], v[248:251], v[100:103]
  ds_read_b64_tr_b16 v[84:85], v10 offset:12288
  ds_read_b64_tr_b16 v[86:87], v10 offset:12800
  v_mfma_f32_16x16x32_bf16 v[100:103], v[88:91], v[240:243], v[100:103]
  v_fmac_f32 v20, v20, v28
  v_fmac_f32 v21, v21, v29
  v_fmac_f32 v22, v22, v30
  v_fmac_f32 v23, v23, v31
  v_cvt_pk_bf16_f32 v38, v20, v21
  s_waitcnt lgkmcnt(4)
  v_mfma_f32_16x16x32_bf16 v[112:115], v[64:67], v[128:131], 0
  ds_read_b64_tr_b16 v[88:89], v11 offset:8192
  ds_read_b64_tr_b16 v[90:91], v11 offset:8704
  v_mfma_f32_16x16x32_bf16 v[112:115], v[68:71], v[136:139], v[112:115]
  v_cvt_pk_bf16_f32 v39, v22, v23
  s_mov_b32 s3, 0x1
  s_waitcnt vmcnt(1)
  s_atomic_add s3, s[98:99], 0
  buffer_store_dwordx4 v[36:39], v1, s[12:15], s70 offen offset:2048 sc1
  v_mfma_f32_16x16x32_bf16 v[120:123], v[68:71], v[140:143], 0
  ds_read_b64_tr_b16 v[92:93], v11 offset:12288
  ds_read_b64_tr_b16 v[94:95], v11 offset:12800
  v_mfma_f32_16x16x32_bf16 v[120:123], v[64:67], v[132:135], v[120:123]
  v_fma_f32 v16, v96, v12, v40
  v_fma_f32 v17, v97, v12, v41
  v_fma_f32 v18, v98, v12, v42
  v_fma_f32 v19, v99, v12, v43
  v_mfma_f32_16x16x32_bf16 v[124:127], v[72:75], v[132:135], 0
  ds_read_b64_tr_b16 v[64:65], v10 offset:16384
  ds_read_b64_tr_b16 v[66:67], v10 offset:16896
  v_mfma_f32_16x16x32_bf16 v[124:127], v[76:79], v[140:143], v[124:127]
  v_exp_f32 v24, v16
  v_exp_f32 v25, v17
  v_exp_f32 v26, v18
  v_mfma_f32_16x16x32_bf16 v[116:119], v[76:79], v[136:139], 0
  ds_read_b64_tr_b16 v[68:69], v10 offset:20480
  ds_read_b64_tr_b16 v[70:71], v10 offset:20992
  v_mfma_f32_16x16x32_bf16 v[116:119], v[72:75], v[128:131], v[116:119]
  v_exp_f32 v27, v19
  v_fma_f32 v28, v24, -0.5, -1.0
  v_fma_f32 v29, v25, -0.5, -1.0
  s_waitcnt lgkmcnt(4)
  v_mfma_f32_16x16x32_bf16 v[112:115], v[80:83], v[144:147], v[112:115]
  ds_read_b64_tr_b16 v[72:73], v11 offset:16384
  ds_read_b64_tr_b16 v[74:75], v11 offset:16896
  v_mfma_f32_16x16x32_bf16 v[112:115], v[84:87], v[152:155], v[112:115]
  v_fma_f32 v30, v26, -0.5, -1.0
  v_fma_f32 v31, v27, -0.5, -1.0
  v_fma_f32 v28, v24, v28, -1.0
  v_fma_f32 v29, v25, v29, -1.0
  v_mfma_f32_16x16x32_bf16 v[120:123], v[84:87], v[156:159], v[120:123]
  ds_read_b64_tr_b16 v[76:77], v11 offset:20480
  ds_read_b64_tr_b16 v[78:79], v11 offset:20992
  v_mfma_f32_16x16x32_bf16 v[120:123], v[80:83], v[148:151], v[120:123]
  v_fma_f32 v30, v26, v30, -1.0
  v_fma_f32 v31, v27, v31, -1.0
  v_rcp_f32 v28, v28
  v_mfma_f32_16x16x32_bf16 v[124:127], v[88:91], v[148:151], v[124:127]
  ds_read_b64_tr_b16 v[80:81], v10 offset:24576
  ds_read_b64_tr_b16 v[82:83], v10 offset:25088
  v_mfma_f32_16x16x32_bf16 v[124:127], v[92:95], v[156:159], v[124:127]
  v_rcp_f32 v29, v29
  v_rcp_f32 v30, v30
  v_rcp_f32 v31, v31
  v_mfma_f32_16x16x32_bf16 v[116:119], v[92:95], v[152:155], v[116:119]
  ds_read_b64_tr_b16 v[84:85], v10 offset:28672
  ds_read_b64_tr_b16 v[86:87], v10 offset:29184
  v_mfma_f32_16x16x32_bf16 v[116:119], v[88:91], v[144:147], v[116:119]
  v_fmac_f32 v16, v16, v28
  v_fmac_f32 v17, v17, v29
  v_fmac_f32 v18, v18, v30
  v_fmac_f32 v19, v19, v31
  s_waitcnt lgkmcnt(4)
  v_mfma_f32_16x16x32_bf16 v[112:115], v[64:67], v[160:163], v[112:115]
  ds_read_b64_tr_b16 v[88:89], v11 offset:24576
  ds_read_b64_tr_b16 v[90:91], v11 offset:25088
  v_mfma_f32_16x16x32_bf16 v[112:115], v[68:71], v[168:171], v[112:115]
  v_cvt_pk_bf16_f32 v32, v16, v17
  v_cvt_pk_bf16_f32 v33, v18, v19
  s_add_u32 s70, s70, 8192
  v_fma_f32 v20, v100, v12, v44
  v_mfma_f32_16x16x32_bf16 v[120:123], v[68:71], v[172:175], v[120:123]
  ds_read_b64_tr_b16 v[92:93], v11 offset:28672
  ds_read_b64_tr_b16 v[94:95], v11 offset:29184
  v_mfma_f32_16x16x32_bf16 v[120:123], v[64:67], v[164:167], v[120:123]
  v_fma_f32 v21, v101, v12, v45
  v_fma_f32 v22, v102, v12, v46
  v_fma_f32 v23, v103, v12, v47
  v_exp_f32 v24, v20
  v_mfma_f32_16x16x32_bf16 v[124:127], v[72:75], v[164:167], v[124:127]
  ds_read_b64_tr_b16 v[64:65], v10 offset:32768
  ds_read_b64_tr_b16 v[66:67], v10 offset:33280
  v_mfma_f32_16x16x32_bf16 v[124:127], v[76:79], v[172:175], v[124:127]
  v_exp_f32 v25, v21
  v_exp_f32 v26, v22
  v_mfma_f32_16x16x32_bf16 v[116:119], v[76:79], v[168:171], v[116:119]
  ds_read_b64_tr_b16 v[68:69], v10 offset:36864
  ds_read_b64_tr_b16 v[70:71], v10 offset:37376
  v_mfma_f32_16x16x32_bf16 v[116:119], v[72:75], v[160:163], v[116:119]
  v_exp_f32 v27, v23
  v_fma_f32 v28, v24, -0.5, -1.0
  v_fma_f32 v29, v25, -0.5, -1.0
  v_fma_f32 v30, v26, -0.5, -1.0
  v_fma_f32 v31, v27, -0.5, -1.0
  s_waitcnt lgkmcnt(4)
  v_mfma_f32_16x16x32_bf16 v[112:115], v[80:83], v[176:179], v[112:115]
  ds_read_b64_tr_b16 v[72:73], v11 offset:32768
  ds_read_b64_tr_b16 v[74:75], v11 offset:33280
  v_mfma_f32_16x16x32_bf16 v[112:115], v[84:87], v[184:187], v[112:115]
  v_fma_f32 v28, v24, v28, -1.0
  v_fma_f32 v29, v25, v29, -1.0
  v_fma_f32 v30, v26, v30, -1.0
  v_mfma_f32_16x16x32_bf16 v[120:123], v[84:87], v[188:191], v[120:123]
  ds_read_b64_tr_b16 v[76:77], v11 offset:36864
  ds_read_b64_tr_b16 v[78:79], v11 offset:37376
  v_mfma_f32_16x16x32_bf16 v[120:123], v[80:83], v[180:183], v[120:123]
  v_fma_f32 v31, v27, v31, -1.0
  v_rcp_f32 v28, v28
  v_rcp_f32 v29, v29
  v_mfma_f32_16x16x32_bf16 v[124:127], v[88:91], v[180:183], v[124:127]
  ds_read_b64_tr_b16 v[80:81], v10 offset:40960
  ds_read_b64_tr_b16 v[82:83], v10 offset:41472
  v_mfma_f32_16x16x32_bf16 v[124:127], v[92:95], v[188:191], v[124:127]
  v_xor_b32 v8, 64, v14
  v_xor_b32 v9, 32, v8
  v_rcp_f32 v30, v30
  v_mfma_f32_16x16x32_bf16 v[116:119], v[92:95], v[184:187], v[116:119]
  ds_read_b64_tr_b16 v[84:85], v10 offset:45056
  ds_read_b64_tr_b16 v[86:87], v10 offset:45568
  v_mfma_f32_16x16x32_bf16 v[116:119], v[88:91], v[176:179], v[116:119]
  v_rcp_f32 v31, v31
  v_fmac_f32 v20, v20, v28
  v_fmac_f32 v21, v21, v29
  v_fmac_f32 v22, v22, v30
  v_fmac_f32 v23, v23, v31
  s_waitcnt lgkmcnt(4)
  v_mfma_f32_16x16x32_bf16 v[112:115], v[64:67], v[192:195], v[112:115]
  ds_read_b64_tr_b16 v[88:89], v11 offset:40960
  ds_read_b64_tr_b16 v[90:91], v11 offset:41472
  v_mfma_f32_16x16x32_bf16 v[112:115], v[68:71], v[200:203], v[112:115]
  v_cvt_pk_bf16_f32 v34, v20, v21
  v_cvt_pk_bf16_f32 v35, v22, v23
  buffer_store_dwordx4 v[32:35], v1, s[12:15], s70 offen offset:0 sc1
  v_fma_f32 v16, v104, v13, v40
  v_mfma_f32_16x16x32_bf16 v[120:123], v[68:71], v[204:207], v[120:123]
  ds_read_b64_tr_b16 v[92:93], v11 offset:45056
  ds_read_b64_tr_b16 v[94:95], v11 offset:45568
  v_mfma_f32_16x16x32_bf16 v[120:123], v[64:67], v[196:199], v[120:123]
  v_fma_f32 v17, v105, v13, v41
  v_fma_f32 v18, v106, v13, v42
  v_fma_f32 v19, v107, v13, v43
  ds_read_b128 v[40:43], v15 offset:512
  v_mfma_f32_16x16x32_bf16 v[124:127], v[72:75], v[196:199], v[124:127]
  ds_read_b64_tr_b16 v[64:65], v10 offset:49152
  ds_read_b64_tr_b16 v[66:67], v10 offset:49664
  v_mfma_f32_16x16x32_bf16 v[124:127], v[76:79], v[204:207], v[124:127]
  v_exp_f32 v24, v16
  v_exp_f32 v25, v17
  v_exp_f32 v26, v18
  v_mfma_f32_16x16x32_bf16 v[116:119], v[76:79], v[200:203], v[116:119]
  ds_read_b64_tr_b16 v[68:69], v10 offset:53248
  ds_read_b64_tr_b16 v[70:71], v10 offset:53760
  v_mfma_f32_16x16x32_bf16 v[116:119], v[72:75], v[192:195], v[116:119]
  v_exp_f32 v27, v19
  v_fma_f32 v28, v24, -0.5, -1.0
  v_fma_f32 v29, v25, -0.5, -1.0
  s_waitcnt lgkmcnt(5)
  v_mfma_f32_16x16x32_bf16 v[112:115], v[80:83], v[208:211], v[112:115]
  ds_read_b64_tr_b16 v[72:73], v11 offset:49152
  ds_read_b64_tr_b16 v[74:75], v11 offset:49664
  v_mfma_f32_16x16x32_bf16 v[112:115], v[84:87], v[216:219], v[112:115]
  v_fma_f32 v30, v26, -0.5, -1.0
  v_fma_f32 v31, v27, -0.5, -1.0
  v_fma_f32 v28, v24, v28, -1.0
  v_fma_f32 v29, v25, v29, -1.0
  v_mfma_f32_16x16x32_bf16 v[120:123], v[84:87], v[220:223], v[120:123]
  ds_read_b64_tr_b16 v[76:77], v11 offset:53248
  ds_read_b64_tr_b16 v[78:79], v11 offset:53760
  v_mfma_f32_16x16x32_bf16 v[120:123], v[80:83], v[212:215], v[120:123]
  v_fma_f32 v30, v26, v30, -1.0
  v_fma_f32 v31, v27, v31, -1.0
  v_rcp_f32 v28, v28
  v_mfma_f32_16x16x32_bf16 v[124:127], v[88:91], v[212:215], v[124:127]
  ds_read_b64_tr_b16 v[80:81], v10 offset:57344
  ds_read_b64_tr_b16 v[82:83], v10 offset:57856
  v_mfma_f32_16x16x32_bf16 v[124:127], v[92:95], v[220:223], v[124:127]
  v_rcp_f32 v29, v29
  v_rcp_f32 v30, v30
  v_rcp_f32 v31, v31
  v_mfma_f32_16x16x32_bf16 v[116:119], v[92:95], v[216:219], v[116:119]
  ds_read_b64_tr_b16 v[84:85], v10 offset:61440
  ds_read_b64_tr_b16 v[86:87], v10 offset:61952
  v_mfma_f32_16x16x32_bf16 v[116:119], v[88:91], v[208:211], v[116:119]
  v_fmac_f32 v16, v16, v28
  v_fmac_f32 v17, v17, v29
  v_fmac_f32 v18, v18, v30
  v_fmac_f32 v19, v19, v31
  s_waitcnt lgkmcnt(4)
  v_mfma_f32_16x16x32_bf16 v[112:115], v[64:67], v[224:227], v[112:115]
  ds_read_b64_tr_b16 v[88:89], v11 offset:57344
  ds_read_b64_tr_b16 v[90:91], v11 offset:57856
  v_mfma_f32_16x16x32_bf16 v[112:115], v[68:71], v[232:235], v[112:115]
  v_cvt_pk_bf16_f32 v36, v16, v17
  v_cvt_pk_bf16_f32 v37, v18, v19
  v_fma_f32 v20, v108, v13, v44
  v_fma_f32 v21, v109, v13, v45
  v_mfma_f32_16x16x32_bf16 v[120:123], v[68:71], v[236:239], v[120:123]
  ds_read_b64_tr_b16 v[92:93], v11 offset:61440
  ds_read_b64_tr_b16 v[94:95], v11 offset:61952
  v_mfma_f32_16x16x32_bf16 v[120:123], v[64:67], v[228:231], v[120:123]
  v_fma_f32 v22, v110, v13, v46
  v_fma_f32 v23, v111, v13, v47
  ds_read_b128 v[44:47], v15 offset:576
  v_exp_f32 v24, v20
  v_mfma_f32_16x16x32_bf16 v[124:127], v[72:75], v[228:231], v[124:127]
  ds_read_b64_tr_b16 v[64:65], v8 offset:0
  ds_read_b64_tr_b16 v[66:67], v8 offset:512
  v_mfma_f32_16x16x32_bf16 v[124:127], v[76:79], v[236:239], v[124:127]
  v_exp_f32 v25, v21
  v_exp_f32 v26, v22
  v_mfma_f32_16x16x32_bf16 v[116:119], v[76:79], v[232:235], v[116:119]
  ds_read_b64_tr_b16 v[68:69], v8 offset:4096
  ds_read_b64_tr_b16 v[70:71], v8 offset:4608
  v_mfma_f32_16x16x32_bf16 v[116:119], v[72:75], v[224:227], v[116:119]
  v_exp_f32 v27, v23
  v_fma_f32 v28, v24, -0.5, -1.0
  v_fma_f32 v29, v25, -0.5, -1.0
  v_fma_f32 v30, v26, -0.5, -1.0
  s_waitcnt lgkmcnt(5)
  v_mfma_f32_16x16x32_bf16 v[112:115], v[80:83], v[240:243], v[112:115]
  ds_read_b64_tr_b16 v[72:73], v9 offset:0
  ds_read_b64_tr_b16 v[74:75], v9 offset:512
  v_mfma_f32_16x16x32_bf16 v[112:115], v[84:87], v[248:251], v[112:115]
  v_fma_f32 v31, v27, -0.5, -1.0
  v_fma_f32 v28, v24, v28, -1.0
  v_fma_f32 v29, v25, v29, -1.0
  v_fma_f32 v30, v26, v30, -1.0
  v_mfma_f32_16x16x32_bf16 v[120:123], v[84:87], v[252:255], v[120:123]
  ds_read_b64_tr_b16 v[76:77], v9 offset:4096
  ds_read_b64_tr_b16 v[78:79], v9 offset:4608
  v_mfma_f32_16x16x32_bf16 v[120:123], v[80:83], v[244:247], v[120:123]
  v_fma_f32 v31, v27, v31, -1.0
  v_rcp_f32 v28, v28
  v_rcp_f32 v29, v29
  v_mfma_f32_16x16x32_bf16 v[124:127], v[88:91], v[244:247], v[124:127]
  ds_read_b64_tr_b16 v[80:81], v8 offset:8192
  ds_read_b64_tr_b16 v[82:83], v8 offset:8704
  v_mfma_f32_16x16x32_bf16 v[124:127], v[92:95], v[252:255], v[124:127]
  v_rcp_f32 v30, v30
  v_rcp_f32 v31, v31
  v_mfma_f32_16x16x32_bf16 v[116:119], v[92:95], v[248:251], v[116:119]
  ds_read_b64_tr_b16 v[84:85], v8 offset:12288
  ds_read_b64_tr_b16 v[86:87], v8 offset:12800
  v_mfma_f32_16x16x32_bf16 v[116:119], v[88:91], v[240:243], v[116:119]
  v_fmac_f32 v20, v20, v28
  v_fmac_f32 v21, v21, v29
  v_fmac_f32 v22, v22, v30
  v_fmac_f32 v23, v23, v31
  v_cvt_pk_bf16_f32 v38, v20, v21
  s_waitcnt lgkmcnt(4)
  v_mfma_f32_16x16x32_bf16 v[96:99], v[64:67], v[128:131], 0
  ds_read_b64_tr_b16 v[88:89], v9 offset:8192
  ds_read_b64_tr_b16 v[90:91], v9 offset:8704
  v_mfma_f32_16x16x32_bf16 v[96:99], v[68:71], v[136:139], v[96:99]
  v_cvt_pk_bf16_f32 v39, v22, v23
  s_mov_b32 s3, 0x10
  s_waitcnt vmcnt(1)
  s_atomic_add s3, s[98:99], 0
  buffer_store_dwordx4 v[36:39], v1, s[12:15], s70 offen offset:2048 sc1
  v_mfma_f32_16x16x32_bf16 v[104:107], v[68:71], v[140:143], 0
  ds_read_b64_tr_b16 v[92:93], v9 offset:12288
  ds_read_b64_tr_b16 v[94:95], v9 offset:12800
  v_mfma_f32_16x16x32_bf16 v[104:107], v[64:67], v[132:135], v[104:107]
  v_fma_f32 v16, v112, v12, v40
  v_fma_f32 v17, v113, v12, v41
  v_fma_f32 v18, v114, v12, v42
  v_fma_f32 v19, v115, v12, v43
  v_mfma_f32_16x16x32_bf16 v[108:111], v[72:75], v[132:135], 0
  ds_read_b64_tr_b16 v[64:65], v8 offset:16384
  ds_read_b64_tr_b16 v[66:67], v8 offset:16896
  v_mfma_f32_16x16x32_bf16 v[108:111], v[76:79], v[140:143], v[108:111]
  v_exp_f32 v24, v16
  v_exp_f32 v25, v17
  v_exp_f32 v26, v18
  v_mfma_f32_16x16x32_bf16 v[100:103], v[76:79], v[136:139], 0
  ds_read_b64_tr_b16 v[68:69], v8 offset:20480
  ds_read_b64_tr_b16 v[70:71], v8 offset:20992
  v_mfma_f32_16x16x32_bf16 v[100:103], v[72:75], v[128:131], v[100:103]
  v_exp_f32 v27, v19
  v_fma_f32 v28, v24, -0.5, -1.0
  v_fma_f32 v29, v25, -0.5, -1.0
  v_fma_f32 v30, v26, -0.5, -1.0
  s_waitcnt lgkmcnt(4)
  v_mfma_f32_16x16x32_bf16 v[96:99], v[80:83], v[144:147], v[96:99]
  ds_read_b64_tr_b16 v[72:73], v9 offset:16384
  ds_read_b64_tr_b16 v[74:75], v9 offset:16896
  v_mfma_f32_16x16x32_bf16 v[96:99], v[84:87], v[152:155], v[96:99]
  v_fma_f32 v31, v27, -0.5, -1.0
  v_fma_f32 v28, v24, v28, -1.0
  v_fma_f32 v29, v25, v29, -1.0
  v_fma_f32 v30, v26, v30, -1.0
  v_mfma_f32_16x16x32_bf16 v[104:107], v[84:87], v[156:159], v[104:107]
  ds_read_b64_tr_b16 v[76:77], v9 offset:20480
  ds_read_b64_tr_b16 v[78:79], v9 offset:20992
  v_mfma_f32_16x16x32_bf16 v[104:107], v[80:83], v[148:151], v[104:107]
  v_fma_f32 v31, v27, v31, -1.0
  v_rcp_f32 v28, v28
  v_rcp_f32 v29, v29
  v_mfma_f32_16x16x32_bf16 v[108:111], v[88:91], v[148:151], v[108:111]
  ds_read_b64_tr_b16 v[80:81], v8 offset:24576
  ds_read_b64_tr_b16 v[82:83], v8 offset:25088
  v_mfma_f32_16x16x32_bf16 v[108:111], v[92:95], v[156:159], v[108:111]
  v_rcp_f32 v30, v30
  v_rcp_f32 v31, v31
  v_mfma_f32_16x16x32_bf16 v[100:103], v[92:95], v[152:155], v[100:103]
  ds_read_b64_tr_b16 v[84:85], v8 offset:28672
  ds_read_b64_tr_b16 v[86:87], v8 offset:29184
  v_mfma_f32_16x16x32_bf16 v[100:103], v[88:91], v[144:147], v[100:103]
  v_fmac_f32 v16, v16, v28
  v_fmac_f32 v17, v17, v29
  v_fmac_f32 v18, v18, v30
  v_fmac_f32 v19, v19, v31
  v_cvt_pk_bf16_f32 v32, v16, v17
  s_waitcnt lgkmcnt(4)
  v_mfma_f32_16x16x32_bf16 v[96:99], v[64:67], v[160:163], v[96:99]
  ds_read_b64_tr_b16 v[88:89], v9 offset:24576
  ds_read_b64_tr_b16 v[90:91], v9 offset:25088
  v_mfma_f32_16x16x32_bf16 v[96:99], v[68:71], v[168:171], v[96:99]
  v_cvt_pk_bf16_f32 v33, v18, v19
  s_add_u32 s70, s70, 8192
  v_fma_f32 v20, v116, v12, v44
  v_fma_f32 v21, v117, v12, v45
  v_mfma_f32_16x16x32_bf16 v[104:107], v[68:71], v[172:175], v[104:107]
  ds_read_b64_tr_b16 v[92:93], v9 offset:28672
  ds_read_b64_tr_b16 v[94:95], v9 offset:29184
  v_mfma_f32_16x16x32_bf16 v[104:107], v[64:67], v[164:167], v[104:107]
  v_fma_f32 v22, v118, v12, v46
  v_fma_f32 v23, v119, v12, v47
  v_exp_f32 v24, v20
  v_exp_f32 v25, v21
  v_mfma_f32_16x16x32_bf16 v[108:111], v[72:75], v[164:167], v[108:111]
  ds_read_b64_tr_b16 v[64:65], v8 offset:32768
  ds_read_b64_tr_b16 v[66:67], v8 offset:33280
  v_mfma_f32_16x16x32_bf16 v[108:111], v[76:79], v[172:175], v[108:111]
  v_exp_f32 v26, v22
  v_exp_f32 v27, v23
  v_mfma_f32_16x16x32_bf16 v[100:103], v[76:79], v[168:171], v[100:103]
  ds_read_b64_tr_b16 v[68:69], v8 offset:36864
  ds_read_b64_tr_b16 v[70:71], v8 offset:37376
  v_mfma_f32_16x16x32_bf16 v[100:103], v[72:75], v[160:163], v[100:103]
  v_fma_f32 v28, v24, -0.5, -1.0
  v_fma_f32 v29, v25, -0.5, -1.0
  v_fma_f32 v30, v26, -0.5, -1.0
  v_fma_f32 v31, v27, -0.5, -1.0
  v_fma_f32 v28, v24, v28, -1.0
  s_waitcnt lgkmcnt(4)
  v_mfma_f32_16x16x32_bf16 v[96:99], v[80:83], v[176:179], v[96:99]
  ds_read_b64_tr_b16 v[72:73], v9 offset:32768
  ds_read_b64_tr_b16 v[74:75], v9 offset:33280
  v_mfma_f32_16x16x32_bf16 v[96:99], v[84:87], v[184:187], v[96:99]
  v_fma_f32 v29, v25, v29, -1.0
  v_fma_f32 v30, v26, v30, -1.0
  v_fma_f32 v31, v27, v31, -1.0
  v_mfma_f32_16x16x32_bf16 v[104:107], v[84:87], v[188:191], v[104:107]
  ds_read_b64_tr_b16 v[76:77], v9 offset:36864
  ds_read_b64_tr_b16 v[78:79], v9 offset:37376
  v_mfma_f32_16x16x32_bf16 v[104:107], v[80:83], v[180:183], v[104:107]
  v_rcp_f32 v28, v28
  v_rcp_f32 v29, v29
  v_rcp_f32 v30, v30
  v_mfma_f32_16x16x32_bf16 v[108:111], v[88:91], v[180:183], v[108:111]
  ds_read_b64_tr_b16 v[80:81], v8 offset:40960
  ds_read_b64_tr_b16 v[82:83], v8 offset:41472
  v_mfma_f32_16x16x32_bf16 v[108:111], v[92:95], v[188:191], v[108:111]
  v_xor_b32 v10, 65536, v14
  v_xor_b32 v11, 32, v10
  v_rcp_f32 v31, v31
  v_fmac_f32 v20, v20, v28
  v_mfma_f32_16x16x32_bf16 v[100:103], v[92:95], v[184:187], v[100:103]
  ds_read_b64_tr_b16 v[84:85], v8 offset:45056
  ds_read_b64_tr_b16 v[86:87], v8 offset:45568
  v_mfma_f32_16x16x32_bf16 v[100:103], v[88:91], v[176:179], v[100:103]
  v_fmac_f32 v21, v21, v29
  v_fmac_f32 v22, v22, v30
  v_fmac_f32 v23, v23, v31
  v_cvt_pk_bf16_f32 v34, v20, v21
  v_cvt_pk_bf16_f32 v35, v22, v23
  s_waitcnt lgkmcnt(4)
  v_mfma_f32_16x16x32_bf16 v[96:99], v[64:67], v[192:195], v[96:99]
  ds_read_b64_tr_b16 v[88:89], v9 offset:40960
  ds_read_b64_tr_b16 v[90:91], v9 offset:41472
  v_mfma_f32_16x16x32_bf16 v[96:99], v[68:71], v[200:203], v[96:99]
  buffer_store_dwordx4 v[32:35], v1, s[12:15], s70 offen offset:0 sc1
  v_fma_f32 v16, v120, v13, v40
  v_fma_f32 v17, v121, v13, v41
  v_fma_f32 v18, v122, v13, v42
  v_mfma_f32_16x16x32_bf16 v[104:107], v[68:71], v[204:207], v[104:107]
  ds_read_b64_tr_b16 v[92:93], v9 offset:45056
  ds_read_b64_tr_b16 v[94:95], v9 offset:45568
  v_mfma_f32_16x16x32_bf16 v[104:107], v[64:67], v[196:199], v[104:107]
  v_fma_f32 v19, v123, v13, v43
  ds_read_b128 v[40:43], v15 offset:640
  v_exp_f32 v24, v16
  v_mfma_f32_16x16x32_bf16 v[108:111], v[72:75], v[196:199], v[108:111]
  ds_read_b64_tr_b16 v[64:65], v8 offset:49152
  ds_read_b64_tr_b16 v[66:67], v8 offset:49664
  v_mfma_f32_16x16x32_bf16 v[108:111], v[76:79], v[204:207], v[108:111]
  v_exp_f32 v25, v17
  v_exp_f32 v26, v18
  v_exp_f32 v27, v19
  v_mfma_f32_16x16x32_bf16 v[100:103], v[76:79], v[200:203], v[100:103]
  ds_read_b64_tr_b16 v[68:69], v8 offset:53248
  ds_read_b64_tr_b16 v[70:71], v8 offset:53760
  v_mfma_f32_16x16x32_bf16 v[100:103], v[72:75], v[192:195], v[100:103]
  v_fma_f32 v28, v24, -0.5, -1.0
  v_fma_f32 v29, v25, -0.5, -1.0
  v_fma_f32 v30, v26, -0.5, -1.0
  v_fma_f32 v31, v27, -0.5, -1.0
  s_waitcnt lgkmcnt(5)
  v_mfma_f32_16x16x32_bf16 v[96:99], v[80:83], v[208:211], v[96:99]
  ds_read_b64_tr_b16 v[72:73], v9 offset:49152
  ds_read_b64_tr_b16 v[74:75], v9 offset:49664
  v_mfma_f32_16x16x32_bf16 v[96:99], v[84:87], v[216:219], v[96:99]
  v_fma_f32 v28, v24, v28, -1.0
  v_fma_f32 v29, v25, v29, -1.0
  v_fma_f32 v30, v26, v30, -1.0
  v_fma_f32 v31, v27, v31, -1.0
  v_mfma_f32_16x16x32_bf16 v[104:107], v[84:87], v[220:223], v[104:107]
  ds_read_b64_tr_b16 v[76:77], v9 offset:53248
  ds_read_b64_tr_b16 v[78:79], v9 offset:53760
  v_mfma_f32_16x16x32_bf16 v[104:107], v[80:83], v[212:215], v[104:107]
  ds_read_b32 v6, v4 offset:1360
  v_rcp_f32 v28, v28
  v_rcp_f32 v29, v29
  v_mfma_f32_16x16x32_bf16 v[108:111], v[88:91], v[212:215], v[108:111]
  ds_read_b64_tr_b16 v[80:81], v8 offset:57344
  ds_read_b64_tr_b16 v[82:83], v8 offset:57856
  v_mfma_f32_16x16x32_bf16 v[108:111], v[92:95], v[220:223], v[108:111]
  v_rcp_f32 v30, v30
  v_rcp_f32 v31, v31
  v_fmac_f32 v16, v16, v28
  v_mfma_f32_16x16x32_bf16 v[100:103], v[92:95], v[216:219], v[100:103]
  ds_read_b64_tr_b16 v[84:85], v8 offset:61440
  ds_read_b64_tr_b16 v[86:87], v8 offset:61952
  v_mfma_f32_16x16x32_bf16 v[100:103], v[88:91], v[208:211], v[100:103]
  v_fmac_f32 v17, v17, v29
  v_fmac_f32 v18, v18, v30
  v_fmac_f32 v19, v19, v31
  v_cvt_pk_bf16_f32 v36, v16, v17
  v_cvt_pk_bf16_f32 v37, v18, v19
  s_waitcnt lgkmcnt(5)
  v_mfma_f32_16x16x32_bf16 v[96:99], v[64:67], v[224:227], v[96:99]
  ds_read_b64_tr_b16 v[88:89], v9 offset:57344
  ds_read_b64_tr_b16 v[90:91], v9 offset:57856
  v_mfma_f32_16x16x32_bf16 v[96:99], v[68:71], v[232:235], v[96:99]
  v_fma_f32 v20, v124, v13, v44
  v_fma_f32 v21, v125, v13, v45
  v_fma_f32 v22, v126, v13, v46
  v_fma_f32 v23, v127, v13, v47
  v_mfma_f32_16x16x32_bf16 v[104:107], v[68:71], v[236:239], v[104:107]
  ds_read_b64_tr_b16 v[92:93], v9 offset:61440
  ds_read_b64_tr_b16 v[94:95], v9 offset:61952
  v_mfma_f32_16x16x32_bf16 v[104:107], v[64:67], v[228:231], v[104:107]
  s_waitcnt lgkmcnt(8)
  v_cmp_ne_u32 vcc, 0, v6
  s_cbranch_vccnz L_lp_34
L_lr_35:
  ds_write_b32 v2, v3 offset:52
  ds_read_b128 v[44:47], v15 offset:704
  v_mfma_f32_16x16x32_bf16 v[108:111], v[72:75], v[228:231], v[108:111]
  ds_read_b64_tr_b16 v[64:65], v10 offset:0
  ds_read_b64_tr_b16 v[66:67], v10 offset:512
  v_mfma_f32_16x16x32_bf16 v[108:111], v[76:79], v[236:239], v[108:111]
  v_exp_f32 v24, v20
  v_exp_f32 v25, v21
  v_exp_f32 v26, v22
  v_mfma_f32_16x16x32_bf16 v[100:103], v[76:79], v[232:235], v[100:103]
  ds_read_b64_tr_b16 v[68:69], v10 offset:4096
  ds_read_b64_tr_b16 v[70:71], v10 offset:4608
  v_mfma_f32_16x16x32_bf16 v[100:103], v[72:75], v[224:227], v[100:103]
  v_exp_f32 v27, v23
  v_fma_f32 v28, v24, -0.5, -1.0
  v_fma_f32 v29, v25, -0.5, -1.0
  s_waitcnt lgkmcnt(6)
  v_mfma_f32_16x16x32_bf16 v[96:99], v[80:83], v[240:243], v[96:99]
  ds_read_b64_tr_b16 v[72:73], v11 offset:0
  ds_read_b64_tr_b16 v[74:75], v11 offset:512
  v_mfma_f32_16x16x32_bf16 v[96:99], v[84:87], v[248:251], v[96:99]
  v_fma_f32 v30, v26, -0.5, -1.0
  v_fma_f32 v31, v27, -0.5, -1.0
  v_fma_f32 v28, v24, v28, -1.0
  v_fma_f32 v29, v25, v29, -1.0
  v_mfma_f32_16x16x32_bf16 v[104:107], v[84:87], v[252:255], v[104:107]
  ds_read_b64_tr_b16 v[76:77], v11 offset:4096
  ds_read_b64_tr_b16 v[78:79], v11 offset:4608
  v_mfma_f32_16x16x32_bf16 v[104:107], v[80:83], v[244:247], v[104:107]
  v_fma_f32 v30, v26, v30, -1.0
  v_fma_f32 v31, v27, v31, -1.0
  v_rcp_f32 v28, v28
  v_rcp_f32 v29, v29
  v_mfma_f32_16x16x32_bf16 v[108:111], v[88:91], v[244:247], v[108:111]
  ds_read_b64_tr_b16 v[80:81], v10 offset:8192
  ds_read_b64_tr_b16 v[82:83], v10 offset:8704
  v_mfma_f32_16x16x32_bf16 v[108:111], v[92:95], v[252:255], v[108:111]
  v_rcp_f32 v30, v30
  v_rcp_f32 v31, v31
  v_mfma_f32_16x16x32_bf16 v[100:103], v[92:95], v[248:251], v[100:103]
  ds_read_b64_tr_b16 v[84:85], v10 offset:12288
  ds_read_b64_tr_b16 v[86:87], v10 offset:12800
  v_mfma_f32_16x16x32_bf16 v[100:103], v[88:91], v[240:243], v[100:103]
  v_fmac_f32 v20, v20, v28
  v_fmac_f32 v21, v21, v29
  v_fmac_f32 v22, v22, v30
  v_fmac_f32 v23, v23, v31
  v_cvt_pk_bf16_f32 v38, v20, v21
  s_waitcnt lgkmcnt(4)
  v_mfma_f32_16x16x32_bf16 v[112:115], v[64:67], v[128:131], 0
  ds_read_b64_tr_b16 v[88:89], v11 offset:8192
  ds_read_b64_tr_b16 v[90:91], v11 offset:8704
  v_mfma_f32_16x16x32_bf16 v[112:115], v[68:71], v[136:139], v[112:115]
  v_cvt_pk_bf16_f32 v39, v22, v23
  s_mov_b32 s3, 0x100
  s_waitcnt vmcnt(1)
  s_atomic_add s3, s[98:99], 0
  buffer_store_dwordx4 v[36:39], v1, s[12:15], s70 offen offset:2048 sc1
  v_mfma_f32_16x16x32_bf16 v[120:123], v[68:71], v[140:143], 0
  ds_read_b64_tr_b16 v[92:93], v11 offset:12288
  ds_read_b64_tr_b16 v[94:95], v11 offset:12800
  v_mfma_f32_16x16x32_bf16 v[120:123], v[64:67], v[132:135], v[120:123]
  v_fma_f32 v16, v96, v12, v40
  v_fma_f32 v17, v97, v12, v41
  v_fma_f32 v18, v98, v12, v42
  v_fma_f32 v19, v99, v12, v43
  v_mfma_f32_16x16x32_bf16 v[124:127], v[72:75], v[132:135], 0
  ds_read_b64_tr_b16 v[64:65], v10 offset:16384
  ds_read_b64_tr_b16 v[66:67], v10 offset:16896
  v_mfma_f32_16x16x32_bf16 v[124:127], v[76:79], v[140:143], v[124:127]
  v_exp_f32 v24, v16
  v_exp_f32 v25, v17
  v_exp_f32 v26, v18
  v_mfma_f32_16x16x32_bf16 v[116:119], v[76:79], v[136:139], 0
  ds_read_b64_tr_b16 v[68:69], v10 offset:20480
  ds_read_b64_tr_b16 v[70:71], v10 offset:20992
  v_mfma_f32_16x16x32_bf16 v[116:119], v[72:75], v[128:131], v[116:119]
  v_exp_f32 v27, v19
  v_fma_f32 v28, v24, -0.5, -1.0
  v_fma_f32 v29, v25, -0.5, -1.0
  s_waitcnt lgkmcnt(4)
  v_mfma_f32_16x16x32_bf16 v[112:115], v[80:83], v[144:147], v[112:115]
  ds_read_b64_tr_b16 v[72:73], v11 offset:16384
  ds_read_b64_tr_b16 v[74:75], v11 offset:16896
  v_mfma_f32_16x16x32_bf16 v[112:115], v[84:87], v[152:155], v[112:115]
  v_fma_f32 v30, v26, -0.5, -1.0
  v_fma_f32 v31, v27, -0.5, -1.0
  v_fma_f32 v28, v24, v28, -1.0
  v_fma_f32 v29, v25, v29, -1.0
  v_mfma_f32_16x16x32_bf16 v[120:123], v[84:87], v[156:159], v[120:123]
  ds_read_b64_tr_b16 v[76:77], v11 offset:20480
  ds_read_b64_tr_b16 v[78:79], v11 offset:20992
  v_mfma_f32_16x16x32_bf16 v[120:123], v[80:83], v[148:151], v[120:123]
  v_fma_f32 v30, v26, v30, -1.0
  v_fma_f32 v31, v27, v31, -1.0
  v_rcp_f32 v28, v28
  v_mfma_f32_16x16x32_bf16 v[124:127], v[88:91], v[148:151], v[124:127]
  ds_read_b64_tr_b16 v[80:81], v10 offset:24576
  ds_read_b64_tr_b16 v[82:83], v10 offset:25088
  v_mfma_f32_16x16x32_bf16 v[124:127], v[92:95], v[156:159], v[124:127]
  v_rcp_f32 v29, v29
  v_rcp_f32 v30, v30
  v_rcp_f32 v31, v31
  v_mfma_f32_16x16x32_bf16 v[116:119], v[92:95], v[152:155], v[116:119]
  ds_read_b64_tr_b16 v[84:85], v10 offset:28672
  ds_read_b64_tr_b16 v[86:87], v10 offset:29184
  v_mfma_f32_16x16x32_bf16 v[116:119], v[88:91], v[144:147], v[116:119]
  v_fmac_f32 v16, v16, v28
  v_fmac_f32 v17, v17, v29
  v_fmac_f32 v18, v18, v30
  v_fmac_f32 v19, v19, v31
  s_waitcnt lgkmcnt(4)
  v_mfma_f32_16x16x32_bf16 v[112:115], v[64:67], v[160:163], v[112:115]
  ds_read_b64_tr_b16 v[88:89], v11 offset:24576
  ds_read_b64_tr_b16 v[90:91], v11 offset:25088
  v_mfma_f32_16x16x32_bf16 v[112:115], v[68:71], v[168:171], v[112:115]
  v_cvt_pk_bf16_f32 v32, v16, v17
  v_cvt_pk_bf16_f32 v33, v18, v19
  s_add_u32 s70, s70, 8192
  v_fma_f32 v20, v100, v12, v44
  v_mfma_f32_16x16x32_bf16 v[120:123], v[68:71], v[172:175], v[120:123]
  ds_read_b64_tr_b16 v[92:93], v11 offset:28672
  ds_read_b64_tr_b16 v[94:95], v11 offset:29184
  v_mfma_f32_16x16x32_bf16 v[120:123], v[64:67], v[164:167], v[120:123]
  v_fma_f32 v21, v101, v12, v45
  v_fma_f32 v22, v102, v12, v46
  v_fma_f32 v23, v103, v12, v47
  v_exp_f32 v24, v20
  v_mfma_f32_16x16x32_bf16 v[124:127], v[72:75], v[164:167], v[124:127]
  ds_read_b64_tr_b16 v[64:65], v10 offset:32768
  ds_read_b64_tr_b16 v[66:67], v10 offset:33280
  v_mfma_f32_16x16x32_bf16 v[124:127], v[76:79], v[172:175], v[124:127]
  v_exp_f32 v25, v21
  v_exp_f32 v26, v22
  v_mfma_f32_16x16x32_bf16 v[116:119], v[76:79], v[168:171], v[116:119]
  ds_read_b64_tr_b16 v[68:69], v10 offset:36864
  ds_read_b64_tr_b16 v[70:71], v10 offset:37376
  v_mfma_f32_16x16x32_bf16 v[116:119], v[72:75], v[160:163], v[116:119]
  v_exp_f32 v27, v23
  v_fma_f32 v28, v24, -0.5, -1.0
  v_fma_f32 v29, v25, -0.5, -1.0
  v_fma_f32 v30, v26, -0.5, -1.0
  v_fma_f32 v31, v27, -0.5, -1.0
  s_waitcnt lgkmcnt(4)
  v_mfma_f32_16x16x32_bf16 v[112:115], v[80:83], v[176:179], v[112:115]
  ds_read_b64_tr_b16 v[72:73], v11 offset:32768
  ds_read_b64_tr_b16 v[74:75], v11 offset:33280
  v_mfma_f32_16x16x32_bf16 v[112:115], v[84:87], v[184:187], v[112:115]
  v_fma_f32 v28, v24, v28, -1.0
  v_fma_f32 v29, v25, v29, -1.0
  v_fma_f32 v30, v26, v30, -1.0
  v_mfma_f32_16x16x32_bf16 v[120:123], v[84:87], v[188:191], v[120:123]
  ds_read_b64_tr_b16 v[76:77], v11 offset:36864
  ds_read_b64_tr_b16 v[78:79], v11 offset:37376
  v_mfma_f32_16x16x32_bf16 v[120:123], v[80:83], v[180:183], v[120:123]
  v_fma_f32 v31, v27, v31, -1.0
  v_rcp_f32 v28, v28
  v_rcp_f32 v29, v29
  v_mfma_f32_16x16x32_bf16 v[124:127], v[88:91], v[180:183], v[124:127]
  ds_read_b64_tr_b16 v[80:81], v10 offset:40960
  ds_read_b64_tr_b16 v[82:83], v10 offset:41472
  v_mfma_f32_16x16x32_bf16 v[124:127], v[92:95], v[188:191], v[124:127]
  v_xor_b32 v8, 65600, v14
  v_xor_b32 v9, 32, v8
  v_rcp_f32 v30, v30
  v_mfma_f32_16x16x32_bf16 v[116:119], v[92:95], v[184:187], v[116:119]
  ds_read_b64_tr_b16 v[84:85], v10 offset:45056
  ds_read_b64_tr_b16 v[86:87], v10 offset:45568
  v_mfma_f32_16x16x32_bf16 v[116:119], v[88:91], v[176:179], v[116:119]
  v_rcp_f32 v31, v31
  v_fmac_f32 v20, v20, v28
  v_fmac_f32 v21, v21, v29
  v_fmac_f32 v22, v22, v30
  v_fmac_f32 v23, v23, v31
  s_waitcnt lgkmcnt(4)
  v_mfma_f32_16x16x32_bf16 v[112:115], v[64:67], v[192:195], v[112:115]
  ds_read_b64_tr_b16 v[88:89], v11 offset:40960
  ds_read_b64_tr_b16 v[90:91], v11 offset:41472
  v_mfma_f32_16x16x32_bf16 v[112:115], v[68:71], v[200:203], v[112:115]
  v_cvt_pk_bf16_f32 v34, v20, v21
  v_cvt_pk_bf16_f32 v35, v22, v23
  buffer_store_dwordx4 v[32:35], v1, s[12:15], s70 offen offset:0 sc1
  v_fma_f32 v16, v104, v13, v40
  v_mfma_f32_16x16x32_bf16 v[120:123], v[68:71], v[204:207], v[120:123]
  ds_read_b64_tr_b16 v[92:93], v11 offset:45056
  ds_read_b64_tr_b16 v[94:95], v11 offset:45568
  v_mfma_f32_16x16x32_bf16 v[120:123], v[64:67], v[196:199], v[120:123]
  v_fma_f32 v17, v105, v13, v41
  v_fma_f32 v18, v106, v13, v42
  v_fma_f32 v19, v107, v13, v43
  ds_read_b128 v[40:43], v15 offset:768
  v_mfma_f32_16x16x32_bf16 v[124:127], v[72:75], v[196:199], v[124:127]
  ds_read_b64_tr_b16 v[64:65], v10 offset:49152
  ds_read_b64_tr_b16 v[66:67], v10 offset:49664
  v_mfma_f32_16x16x32_bf16 v[124:127], v[76:79], v[204:207], v[124:127]
  v_exp_f32 v24, v16
  v_exp_f32 v25, v17
  v_exp_f32 v26, v18
  v_mfma_f32_16x16x32_bf16 v[116:119], v[76:79], v[200:203], v[116:119]
  ds_read_b64_tr_b16 v[68:69], v10 offset:53248
  ds_read_b64_tr_b16 v[70:71], v10 offset:53760
  v_mfma_f32_16x16x32_bf16 v[116:119], v[72:75], v[192:195], v[116:119]
  v_exp_f32 v27, v19
  v_fma_f32 v28, v24, -0.5, -1.0
  v_fma_f32 v29, v25, -0.5, -1.0
  s_waitcnt lgkmcnt(5)
  v_mfma_f32_16x16x32_bf16 v[112:115], v[80:83], v[208:211], v[112:115]
  ds_read_b64_tr_b16 v[72:73], v11 offset:49152
  ds_read_b64_tr_b16 v[74:75], v11 offset:49664
  v_mfma_f32_16x16x32_bf16 v[112:115], v[84:87], v[216:219], v[112:115]
  v_fma_f32 v30, v26, -0.5, -1.0
  v_fma_f32 v31, v27, -0.5, -1.0
  v_fma_f32 v28, v24, v28, -1.0
  v_fma_f32 v29, v25, v29, -1.0
  v_mfma_f32_16x16x32_bf16 v[120:123], v[84:87], v[220:223], v[120:123]
  ds_read_b64_tr_b16 v[76:77], v11 offset:53248
  ds_read_b64_tr_b16 v[78:79], v11 offset:53760
  v_mfma_f32_16x16x32_bf16 v[120:123], v[80:83], v[212:215], v[120:123]
  v_fma_f32 v30, v26, v30, -1.0
  v_fma_f32 v31, v27, v31, -1.0
  v_rcp_f32 v28, v28
  v_mfma_f32_16x16x32_bf16 v[124:127], v[88:91], v[212:215], v[124:127]
  ds_read_b64_tr_b16 v[80:81], v10 offset:57344
  ds_read_b64_tr_b16 v[82:83], v10 offset:57856
  v_mfma_f32_16x16x32_bf16 v[124:127], v[92:95], v[220:223], v[124:127]
  v_rcp_f32 v29, v29
  v_rcp_f32 v30, v30
  v_rcp_f32 v31, v31
  v_mfma_f32_16x16x32_bf16 v[116:119], v[92:95], v[216:219], v[116:119]
  ds_read_b64_tr_b16 v[84:85], v10 offset:61440
  ds_read_b64_tr_b16 v[86:87], v10 offset:61952
  v_mfma_f32_16x16x32_bf16 v[116:119], v[88:91], v[208:211], v[116:119]
  v_fmac_f32 v16, v16, v28
  v_fmac_f32 v17, v17, v29
  v_fmac_f32 v18, v18, v30
  v_fmac_f32 v19, v19, v31
  s_waitcnt lgkmcnt(4)
  v_mfma_f32_16x16x32_bf16 v[112:115], v[64:67], v[224:227], v[112:115]
  ds_read_b64_tr_b16 v[88:89], v11 offset:57344
  ds_read_b64_tr_b16 v[90:91], v11 offset:57856
  v_mfma_f32_16x16x32_bf16 v[112:115], v[68:71], v[232:235], v[112:115]
  v_cvt_pk_bf16_f32 v36, v16, v17
  v_cvt_pk_bf16_f32 v37, v18, v19
  v_fma_f32 v20, v108, v13, v44
  v_fma_f32 v21, v109, v13, v45
  v_mfma_f32_16x16x32_bf16 v[120:123], v[68:71], v[236:239], v[120:123]
  ds_read_b64_tr_b16 v[92:93], v11 offset:61440
  ds_read_b64_tr_b16 v[94:95], v11 offset:61952
  v_mfma_f32_16x16x32_bf16 v[120:123], v[64:67], v[228:231], v[120:123]
  v_fma_f32 v22, v110, v13, v46
  v_fma_f32 v23, v111, v13, v47
  ds_read_b128 v[44:47], v15 offset:832
  v_exp_f32 v24, v20
  v_mfma_f32_16x16x32_bf16 v[124:127], v[72:75], v[228:231], v[124:127]
  ds_read_b64_tr_b16 v[64:65], v8 offset:0
  ds_read_b64_tr_b16 v[66:67], v8 offset:512
  v_mfma_f32_16x16x32_bf16 v[124:127], v[76:79], v[236:239], v[124:127]
  v_exp_f32 v25, v21
  v_exp_f32 v26, v22
  v_mfma_f32_16x16x32_bf16 v[116:119], v[76:79], v[232:235], v[116:119]
  ds_read_b64_tr_b16 v[68:69], v8 offset:4096
  ds_read_b64_tr_b16 v[70:71], v8 offset:4608
  v_mfma_f32_16x16x32_bf16 v[116:119], v[72:75], v[224:227], v[116:119]
  v_exp_f32 v27, v23
  v_fma_f32 v28, v24, -0.5, -1.0
  v_fma_f32 v29, v25, -0.5, -1.0
  v_fma_f32 v30, v26, -0.5, -1.0
  s_waitcnt lgkmcnt(5)
  v_mfma_f32_16x16x32_bf16 v[112:115], v[80:83], v[240:243], v[112:115]
  ds_read_b64_tr_b16 v[72:73], v9 offset:0
  ds_read_b64_tr_b16 v[74:75], v9 offset:512
  v_mfma_f32_16x16x32_bf16 v[112:115], v[84:87], v[248:251], v[112:115]
  v_fma_f32 v31, v27, -0.5, -1.0
  v_fma_f32 v28, v24, v28, -1.0
  v_fma_f32 v29, v25, v29, -1.0
  v_fma_f32 v30, v26, v30, -1.0
  v_mfma_f32_16x16x32_bf16 v[120:123], v[84:87], v[252:255], v[120:123]
  ds_read_b64_tr_b16 v[76:77], v9 offset:4096
  ds_read_b64_tr_b16 v[78:79], v9 offset:4608
  v_mfma_f32_16x16x32_bf16 v[120:123], v[80:83], v[244:247], v[120:123]
  v_fma_f32 v31, v27, v31, -1.0
  v_rcp_f32 v28, v28
  v_rcp_f32 v29, v29
  v_mfma_f32_16x16x32_bf16 v[124:127], v[88:91], v[244:247], v[124:127]
  ds_read_b64_tr_b16 v[80:81], v8 offset:8192
  ds_read_b64_tr_b16 v[82:83], v8 offset:8704
  v_mfma_f32_16x16x32_bf16 v[124:127], v[92:95], v[252:255], v[124:127]
  v_rcp_f32 v30, v30
  v_rcp_f32 v31, v31
  v_mfma_f32_16x16x32_bf16 v[116:119], v[92:95], v[248:251], v[116:119]
  ds_read_b64_tr_b16 v[84:85], v8 offset:12288
  ds_read_b64_tr_b16 v[86:87], v8 offset:12800
  v_mfma_f32_16x16x32_bf16 v[116:119], v[88:91], v[240:243], v[116:119]
  v_fmac_f32 v20, v20, v28
  v_fmac_f32 v21, v21, v29
  v_fmac_f32 v22, v22, v30
  v_fmac_f32 v23, v23, v31
  v_cvt_pk_bf16_f32 v38, v20, v21
  s_waitcnt lgkmcnt(4)
  v_mfma_f32_16x16x32_bf16 v[96:99], v[64:67], v[128:131], 0
  ds_read_b64_tr_b16 v[88:89], v9 offset:8192
  ds_read_b64_tr_b16 v[90:91], v9 offset:8704
  v_mfma_f32_16x16x32_bf16 v[96:99], v[68:71], v[136:139], v[96:99]
  v_cvt_pk_bf16_f32 v39, v22, v23
  s_mov_b32 s3, 0x1000
  s_waitcnt vmcnt(1)
  s_atomic_add s3, s[98:99], 0
  buffer_store_dwordx4 v[36:39], v1, s[12:15], s70 offen offset:2048 sc1
  v_mfma_f32_16x16x32_bf16 v[104:107], v[68:71], v[140:143], 0
  ds_read_b64_tr_b16 v[92:93], v9 offset:12288
  ds_read_b64_tr_b16 v[94:95], v9 offset:12800
  v_mfma_f32_16x16x32_bf16 v[104:107], v[64:67], v[132:135], v[104:107]
  v_fma_f32 v16, v112, v12, v40
  v_fma_f32 v17, v113, v12, v41
  v_fma_f32 v18, v114, v12, v42
  v_fma_f32 v19, v115, v12, v43
  v_mfma_f32_16x16x32_bf16 v[108:111], v[72:75], v[132:135], 0
  ds_read_b64_tr_b16 v[64:65], v8 offset:16384
  ds_read_b64_tr_b16 v[66:67], v8 offset:16896
  v_mfma_f32_16x16x32_bf16 v[108:111], v[76:79], v[140:143], v[108:111]
  v_exp_f32 v24, v16
  v_exp_f32 v25, v17
  v_mfma_f32_16x16x32_bf16 v[100:103], v[76:79], v[136:139], 0
  ds_read_b64_tr_b16 v[68:69], v8 offset:20480
  ds_read_b64_tr_b16 v[70:71], v8 offset:20992
  v_mfma_f32_16x16x32_bf16 v[100:103], v[72:75], v[128:131], v[100:103]
  v_exp_f32 v26, v18
  v_exp_f32 v27, v19
  v_fma_f32 v28, v24, -0.5, -1.0
  s_waitcnt lgkmcnt(4)
  v_mfma_f32_16x16x32_bf16 v[96:99], v[80:83], v[144:147], v[96:99]
  ds_read_b64_tr_b16 v[72:73], v9 offset:16384
  ds_read_b64_tr_b16 v[74:75], v9 offset:16896
  v_mfma_f32_16x16x32_bf16 v[96:99], v[84:87], v[152:155], v[96:99]
  v_fma_f32 v29, v25, -0.5, -1.0
  v_fma_f32 v30, v26, -0.5, -1.0
  v_fma_f32 v31, v27, -0.5, -1.0
  v_fma_f32 v28, v24, v28, -1.0
  v_mfma_f32_16x16x32_bf16 v[104:107], v[84:87], v[156:159], v[104:107]
  ds_read_b64_tr_b16 v[76:77], v9 offset:20480
  ds_read_b64_tr_b16 v[78:79], v9 offset:20992
  v_mfma_f32_16x16x32_bf16 v[104:107], v[80:83], v[148:151], v[104:107]
  v_fma_f32 v29, v25, v29, -1.0
  v_fma_f32 v30, v26, v30, -1.0
  v_fma_f32 v31, v27, v31, -1.0
  v_rcp_f32 v28, v28
  v_mfma_f32_16x16x32_bf16 v[108:111], v[88:91], v[148:151], v[108:111]
  ds_read_b64_tr_b16 v[80:81], v8 offset:24576
  ds_read_b64_tr_b16 v[82:83], v8 offset:25088
  v_mfma_f32_16x16x32_bf16 v[108:111], v[92:95], v[156:159], v[108:111]
  v_rcp_f32 v29, v29
  v_rcp_f32 v30, v30
  v_mfma_f32_16x16x32_bf16 v[100:103], v[92:95], v[152:155], v[100:103]
  ds_read_b64_tr_b16 v[84:85], v8 offset:28672
  ds_read_b64_tr_b16 v[86:87], v8 offset:29184
  v_mfma_f32_16x16x32_bf16 v[100:103], v[88:91], v[144:147], v[100:103]
  v_rcp_f32 v31, v31
  v_fmac_f32 v16, v16, v28
  v_fmac_f32 v17, v17, v29
  s_waitcnt lgkmcnt(4)
  v_mfma_f32_16x16x32_bf16 v[96:99], v[64:67], v[160:163], v[96:99]
  ds_read_b64_tr_b16 v[88:89], v9 offset:24576
  ds_read_b64_tr_b16 v[90:91], v9 offset:25088
  v_mfma_f32_16x16x32_bf16 v[96:99], v[68:71], v[168:171], v[96:99]
  v_fmac_f32 v18, v18, v30
  v_fmac_f32 v19, v19, v31
  v_cvt_pk_bf16_f32 v32, v16, v17
  v_cvt_pk_bf16_f32 v33, v18, v19
  v_mfma_f32_16x16x32_bf16 v[104:107], v[68:71], v[172:175], v[104:107]
  ds_read_b64_tr_b16 v[92:93], v9 offset:28672
  ds_read_b64_tr_b16 v[94:95], v9 offset:29184
  v_mfma_f32_16x16x32_bf16 v[104:107], v[64:67], v[164:167], v[104:107]
  s_add_u32 s70, s70, 8192
  v_fma_f32 v20, v116, v12, v44
  v_fma_f32 v21, v117, v12, v45
  v_fma_f32 v22, v118, v12, v46
  v_mfma_f32_16x16x32_bf16 v[108:111], v[72:75], v[164:167], v[108:111]
  ds_read_b64_tr_b16 v[64:65], v8 offset:32768
  ds_read_b64_tr_b16 v[66:67], v8 offset:33280
  v_mfma_f32_16x16x32_bf16 v[108:111], v[76:79], v[172:175], v[108:111]
  v_fma_f32 v23, v119, v12, v47
  v_exp_f32 v24, v20
  v_exp_f32 v25, v21
  v_mfma_f32_16x16x32_bf16 v[100:103], v[76:79], v[168:171], v[100:103]
  ds_read_b64_tr_b16 v[68:69], v8 offset:36864
  ds_read_b64_tr_b16 v[70:71], v8 offset:37376
  v_mfma_f32_16x16x32_bf16 v[100:103], v[72:75], v[160:163], v[100:103]
  v_exp_f32 v26, v22
  v_exp_f32 v27, v23
  s_waitcnt lgkmcnt(4)
  v_mfma_f32_16x16x32_bf16 v[96:99], v[80:83], v[176:179], v[96:99]
  ds_read_b64_tr_b16 v[72:73], v9 offset:32768
  ds_read_b64_tr_b16 v[74:75], v9 offset:33280
  v_mfma_f32_16x16x32_bf16 v[96:99], v[84:87], v[184:187], v[96:99]
  v_fma_f32 v28, v24, -0.5, -1.0
  v_fma_f32 v29, v25, -0.5, -1.0
  v_fma_f32 v30, v26, -0.5, -1.0
  v_mfma_f32_16x16x32_bf16 v[104:107], v[84:87], v[188:191], v[104:107]
  ds_read_b64_tr_b16 v[76:77], v9 offset:36864
  ds_read_b64_tr_b16 v[78:79], v9 offset:37376
  v_mfma_f32_16x16x32_bf16 v[104:107], v[80:83], v[180:183], v[104:107]
  v_fma_f32 v31, v27, -0.5, -1.0
  v_fma_f32 v28, v24, v28, -1.0
  v_fma_f32 v29, v25, v29, -1.0
  v_fma_f32 v30, v26, v30, -1.0
  v_fma_f32 v31, v27, v31, -1.0
  v_mfma_f32_16x16x32_bf16 v[108:111], v[88:91], v[180:183], v[108:111]
  ds_read_b64_tr_b16 v[80:81], v8 offset:40960
  ds_read_b64_tr_b16 v[82:83], v8 offset:41472
  v_mfma_f32_16x16x32_bf16 v[108:111], v[92:95], v[188:191], v[108:111]
  v_rcp_f32 v28, v28
  v_rcp_f32 v29, v29
  v_mfma_f32_16x16x32_bf16 v[100:103], v[92:95], v[184:187], v[100:103]
  ds_read_b64_tr_b16 v[84:85], v8 offset:45056
  ds_read_b64_tr_b16 v[86:87], v8 offset:45568
  v_mfma_f32_16x16x32_bf16 v[100:103], v[88:91], v[176:179], v[100:103]
  v_rcp_f32 v30, v30
  v_rcp_f32 v31, v31
  v_fmac_f32 v20, v20, v28
  s_waitcnt lgkmcnt(4)
  v_mfma_f32_16x16x32_bf16 v[96:99], v[64:67], v[192:195], v[96:99]
  ds_read_b64_tr_b16 v[88:89], v9 offset:40960
  ds_read_b64_tr_b16 v[90:91], v9 offset:41472
  v_mfma_f32_16x16x32_bf16 v[96:99], v[68:71], v[200:203], v[96:99]
  v_fmac_f32 v21, v21, v29
  v_fmac_f32 v22, v22, v30
  v_fmac_f32 v23, v23, v31
  v_mfma_f32_16x16x32_bf16 v[104:107], v[68:71], v[204:207], v[104:107]
  ds_read_b64_tr_b16 v[92:93], v9 offset:45056
  ds_read_b64_tr_b16 v[94:95], v9 offset:45568
  v_mfma_f32_16x16x32_bf16 v[104:107], v[64:67], v[196:199], v[104:107]
  v_cvt_pk_bf16_f32 v34, v20, v21
  v_cvt_pk_bf16_f32 v35, v22, v23
  buffer_store_dwordx4 v[32:35], v1, s[12:15], s70 offen offset:0 sc1
  v_fma_f32 v16, v120, v13, v40
  v_fma_f32 v17, v121, v13, v41
  v_mfma_f32_16x16x32_bf16 v[108:111], v[72:75], v[196:199], v[108:111]
  ds_read_b64_tr_b16 v[64:65], v8 offset:49152
  ds_read_b64_tr_b16 v[66:67], v8 offset:49664
  v_mfma_f32_16x16x32_bf16 v[108:111], v[76:79], v[204:207], v[108:111]
  v_fma_f32 v18, v122, v13, v42
  v_fma_f32 v19, v123, v13, v43
  ds_read_b128 v[40:43], v15 offset:896
  v_exp_f32 v24, v16
  v_mfma_f32_16x16x32_bf16 v[100:103], v[76:79], v[200:203], v[100:103]
  ds_read_b64_tr_b16 v[68:69], v8 offset:53248
  ds_read_b64_tr_b16 v[70:71], v8 offset:53760
  v_mfma_f32_16x16x32_bf16 v[100:103], v[72:75], v[192:195], v[100:103]
  v_exp_f32 v25, v17
  v_exp_f32 v26, v18
  s_waitcnt lgkmcnt(5)
  v_mfma_f32_16x16x32_bf16 v[96:99], v[80:83], v[208:211], v[96:99]
  ds_read_b64_tr_b16 v[72:73], v9 offset:49152
  ds_read_b64_tr_b16 v[74:75], v9 offset:49664
  v_mfma_f32_16x16x32_bf16 v[96:99], v[84:87], v[216:219], v[96:99]
  v_exp_f32 v27, v19
  v_fma_f32 v28, v24, -0.5, -1.0
  v_mfma_f32_16x16x32_bf16 v[104:107], v[84:87], v[220:223], v[104:107]
  ds_read_b64_tr_b16 v[76:77], v9 offset:53248
  ds_read_b64_tr_b16 v[78:79], v9 offset:53760
  v_mfma_f32_16x16x32_bf16 v[104:107], v[80:83], v[212:215], v[104:107]
  v_fma_f32 v29, v25, -0.5, -1.0
  v_fma_f32 v30, v26, -0.5, -1.0
  v_fma_f32 v31, v27, -0.5, -1.0
  v_fma_f32 v28, v24, v28, -1.0
  v_mfma_f32_16x16x32_bf16 v[108:111], v[88:91], v[212:215], v[108:111]
  ds_read_b64_tr_b16 v[80:81], v8 offset:57344
  ds_read_b64_tr_b16 v[82:83], v8 offset:57856
  v_mfma_f32_16x16x32_bf16 v[108:111], v[92:95], v[220:223], v[108:111]
  v_fma_f32 v29, v25, v29, -1.0
  v_fma_f32 v30, v26, v30, -1.0
  v_fma_f32 v31, v27, v31, -1.0
  v_rcp_f32 v28, v28
  v_mfma_f32_16x16x32_bf16 v[100:103], v[92:95], v[216:219], v[100:103]
  ds_read_b64_tr_b16 v[84:85], v8 offset:61440
  ds_read_b64_tr_b16 v[86:87], v8 offset:61952
  v_mfma_f32_16x16x32_bf16 v[100:103], v[88:91], v[208:211], v[100:103]
  v_rcp_f32 v29, v29
  v_rcp_f32 v30, v30
  s_waitcnt lgkmcnt(4)
  v_mfma_f32_16x16x32_bf16 v[96:99], v[64:67], v[224:227], v[96:99]
  ds_read_b64_tr_b16 v[88:89], v9 offset:57344
  ds_read_b64_tr_b16 v[90:91], v9 offset:57856
  v_mfma_f32_16x16x32_bf16 v[96:99], v[68:71], v[232:235], v[96:99]
  v_rcp_f32 v31, v31
  v_fmac_f32 v16, v16, v28
  v_fmac_f32 v17, v17, v29
  v_mfma_f32_16x16x32_bf16 v[104:107], v[68:71], v[236:239], v[104:107]
  ds_read_b64_tr_b16 v[92:93], v9 offset:61440
  ds_read_b64_tr_b16 v[94:95], v9 offset:61952
  v_mfma_f32_16x16x32_bf16 v[104:107], v[64:67], v[228:231], v[104:107]
  v_fmac_f32 v18, v18, v30
  v_fmac_f32 v19, v19, v31
  v_cvt_pk_bf16_f32 v36, v16, v17
  v_cvt_pk_bf16_f32 v37, v18, v19
  v_mfma_f32_16x16x32_bf16 v[108:111], v[72:75], v[228:231], v[108:111]
  v_mfma_f32_16x16x32_bf16 v[108:111], v[76:79], v[236:239], v[108:111]
  v_fma_f32 v20, v124, v13, v44
  v_fma_f32 v21, v125, v13, v45
  v_fma_f32 v22, v126, v13, v46
  v_fma_f32 v23, v127, v13, v47
  ds_read_b128 v[44:47], v15 offset:960
  v_exp_f32 v24, v20
  v_mfma_f32_16x16x32_bf16 v[100:103], v[76:79], v[232:235], v[100:103]
  v_mfma_f32_16x16x32_bf16 v[100:103], v[72:75], v[224:227], v[100:103]
  v_exp_f32 v25, v21
  v_exp_f32 v26, v22
  v_exp_f32 v27, v23
  s_waitcnt lgkmcnt(1)
  v_mfma_f32_16x16x32_bf16 v[96:99], v[80:83], v[240:243], v[96:99]
  v_mfma_f32_16x16x32_bf16 v[96:99], v[84:87], v[248:251], v[96:99]
  v_fma_f32 v28, v24, -0.5, -1.0
  v_fma_f32 v29, v25, -0.5, -1.0
  v_fma_f32 v30, v26, -0.5, -1.0
  v_fma_f32 v31, v27, -0.5, -1.0
  v_fma_f32 v28, v24, v28, -1.0
  v_fma_f32 v29, v25, v29, -1.0
  v_mfma_f32_16x16x32_bf16 v[104:107], v[84:87], v[252:255], v[104:107]
  v_mfma_f32_16x16x32_bf16 v[104:107], v[80:83], v[244:247], v[104:107]
  v_fma_f32 v30, v26, v30, -1.0
  v_fma_f32 v31, v27, v31, -1.0
  v_rcp_f32 v28, v28
  v_rcp_f32 v29, v29
  v_mfma_f32_16x16x32_bf16 v[108:111], v[88:91], v[244:247], v[108:111]
  v_mfma_f32_16x16x32_bf16 v[108:111], v[92:95], v[252:255], v[108:111]
  v_rcp_f32 v30, v30
  v_rcp_f32 v31, v31
  v_fmac_f32 v20, v20, v28
  v_fmac_f32 v21, v21, v29
  v_fmac_f32 v22, v22, v30
  v_mfma_f32_16x16x32_bf16 v[100:103], v[92:95], v[248:251], v[100:103]
  v_mfma_f32_16x16x32_bf16 v[100:103], v[88:91], v[240:243], v[100:103]
  v_fmac_f32 v23, v23, v31
  v_cvt_pk_bf16_f32 v38, v20, v21
  v_cvt_pk_bf16_f32 v39, v22, v23
  s_mov_b32 s3, 0x10000
  s_waitcnt vmcnt(1)
  s_atomic_add s3, s[98:99], 0
  buffer_store_dwordx4 v[36:39], v1, s[12:15], s70 offen offset:2048 sc1
  v_fma_f32 v16, v96, v12, v40
  v_fma_f32 v17, v97, v12, v41
  v_fma_f32 v18, v98, v12, v42
  v_fma_f32 v19, v99, v12, v43
  v_exp_f32 v24, v16
  v_exp_f32 v25, v17
  v_exp_f32 v26, v18
  v_exp_f32 v27, v19
  v_fma_f32 v28, v24, -0.5, -1.0
  v_fma_f32 v29, v25, -0.5, -1.0
  v_fma_f32 v30, v26, -0.5, -1.0
  v_fma_f32 v31, v27, -0.5, -1.0
  v_fma_f32 v28, v24, v28, -1.0
  v_fma_f32 v29, v25, v29, -1.0
  v_fma_f32 v30, v26, v30, -1.0
  v_fma_f32 v31, v27, v31, -1.0
  v_rcp_f32 v28, v28
  v_rcp_f32 v29, v29
  v_rcp_f32 v30, v30
  v_rcp_f32 v31, v31
  v_fmac_f32 v16, v16, v28
  v_fmac_f32 v17, v17, v29
  v_fmac_f32 v18, v18, v30
  v_fmac_f32 v19, v19, v31
  v_cvt_pk_bf16_f32 v32, v16, v17
  v_cvt_pk_bf16_f32 v33, v18, v19
  s_add_u32 s70, s70, 8192
  s_waitcnt lgkmcnt(0)
  v_fma_f32 v20, v100, v12, v44
  v_fma_f32 v21, v101, v12, v45
  v_fma_f32 v22, v102, v12, v46
  v_fma_f32 v23, v103, v12, v47
  v_exp_f32 v24, v20
  v_exp_f32 v25, v21
  v_exp_f32 v26, v22
  v_exp_f32 v27, v23
  v_fma_f32 v28, v24, -0.5, -1.0
  v_fma_f32 v29, v25, -0.5, -1.0
  v_fma_f32 v30, v26, -0.5, -1.0
  v_fma_f32 v31, v27, -0.5, -1.0
  v_fma_f32 v28, v24, v28, -1.0
  v_fma_f32 v29, v25, v29, -1.0
  v_fma_f32 v30, v26, v30, -1.0
  v_fma_f32 v31, v27, v31, -1.0
  v_rcp_f32 v28, v28
  v_rcp_f32 v29, v29
  v_rcp_f32 v30, v30
  v_rcp_f32 v31, v31
  v_fmac_f32 v20, v20, v28
  v_fmac_f32 v21, v21, v29
  v_fmac_f32 v22, v22, v30
  v_fmac_f32 v23, v23, v31
  v_cvt_pk_bf16_f32 v34, v20, v21
  v_cvt_pk_bf16_f32 v35, v22, v23
  buffer_store_dwordx4 v[32:35], v1, s[12:15], s70 offen offset:0 sc1
  v_fma_f32 v16, v104, v13, v40
  v_fma_f32 v17, v105, v13, v41
  v_fma_f32 v18, v106, v13, v42
  v_fma_f32 v19, v107, v13, v43
  v_exp_f32 v24, v16
  v_exp_f32 v25, v17
  v_exp_f32 v26, v18
  v_exp_f32 v27, v19
  v_fma_f32 v28, v24, -0.5, -1.0
  v_fma_f32 v29, v25, -0.5, -1.0
  v_fma_f32 v30, v26, -0.5, -1.0
  v_fma_f32 v31, v27, -0.5, -1.0
  v_fma_f32 v28, v24, v28, -1.0
  v_fma_f32 v29, v25, v29, -1.0
  v_fma_f32 v30, v26, v30, -1.0
  v_fma_f32 v31, v27, v31, -1.0
  v_rcp_f32 v28, v28
  v_rcp_f32 v29, v29
  v_rcp_f32 v30, v30
  v_rcp_f32 v31, v31
  v_fmac_f32 v16, v16, v28
  v_fmac_f32 v17, v17, v29
  v_fmac_f32 v18, v18, v30
  v_fmac_f32 v19, v19, v31
  v_cvt_pk_bf16_f32 v36, v16, v17
  v_cvt_pk_bf16_f32 v37, v18, v19
  v_fma_f32 v20, v108, v13, v44
  v_fma_f32 v21, v109, v13, v45
  v_fma_f32 v22, v110, v13, v46
  v_fma_f32 v23, v111, v13, v47
  v_exp_f32 v24, v20
  v_exp_f32 v25, v21
  v_exp_f32 v26, v22
  v_exp_f32 v27, v23
  v_fma_f32 v28, v24, -0.5, -1.0
  v_fma_f32 v29, v25, -0.5, -1.0
  v_fma_f32 v30, v26, -0.5, -1.0
  v_fma_f32 v31, v27, -0.5, -1.0
  v_fma_f32 v28, v24, v28, -1.0
  v_fma_f32 v29, v25, v29, -1.0
  v_fma_f32 v30, v26, v30, -1.0
  v_fma_f32 v31, v27, v31, -1.0
  v_rcp_f32 v28, v28
  v_rcp_f32 v29, v29
  v_rcp_f32 v30, v30
  v_rcp_f32 v31, v31
  v_fmac_f32 v20, v20, v28
  v_fmac_f32 v21, v21, v29
  v_fmac_f32 v22, v22, v30
  v_fmac_f32 v23, v23, v31
  v_cvt_pk_bf16_f32 v38, v20, v21
  v_cvt_pk_bf16_f32 v39, v22, v23
  s_mov_b32 s3, 0x100000
  s_waitcnt vmcnt(1)
  s_atomic_add s3, s[98:99], 0
  buffer_store_dwordx4 v[36:39], v1, s[12:15], s70 offen offset:2048 sc1
  s_mov_b32 s3, 0x1000000
  s_waitcnt vmcnt(0)
  s_atomic_add s3, s[98:99], 0
  s_nop 3
  s_branch L_p1_done
L_p1a:
  v_mfma_f32_32x32x16_bf16 v[16:31], v[32:35], v[224:227], v[40:55]
  v_cvt_pk_bf16_f32 v208, v96, v97
  v_cvt_pk_bf16_f32 v209, v98, v99
  v_cvt_pk_bf16_f32 v210, v100, v101
  v_cvt_pk_bf16_f32 v211, v102, v103
  v_xor_b32 v8, 0, v14
  v_xor_b32 v9, 32, v8
  s_waitcnt lgkmcnt(0)
  v_cmp_ne_u32 vcc, 0, v6
  s_cbranch_vccz L_lr_40
L_lp_39:
  s_add_u32 s86, s86, 1
  s_cmp_gt_u32 s86, 1048576
  s_cbranch_scc1 L_lr_40
  ds_read_b32 v6, v4 offset:1388
  s_waitcnt lgkmcnt(0)
  v_cmp_ne_u32 vcc, 0, v6
  s_cbranch_vccnz L_lp_39
L_lr_40:
  v_mfma_f32_32x32x16_bf16 v[16:31], v[36:39], v[228:231], v[16:31]
  v_cvt_pk_bf16_f32 v212, v104, v105
  v_cvt_pk_bf16_f32 v213, v106, v107
  v_cvt_pk_bf16_f32 v214, v108, v109
  v_cvt_pk_bf16_f32 v215, v110, v111
  ds_read_b64_tr_b16 v[64:65], v8 offset:0
  ds_read_b64_tr_b16 v[66:67], v8 offset:512
  v_mfma_f32_32x32x16_bf16 v[96:111], v[32:35], v[232:235], v[40:55]
  v_cvt_pk_bf16_f32 v216, v112, v113
  v_cvt_pk_bf16_f32 v217, v114, v115
  v_cvt_pk_bf16_f32 v218, v116, v117
  v_cvt_pk_bf16_f32 v219, v118, v119
  ds_read_b64_tr_b16 v[68:69], v8 offset:4096
  ds_read_b64_tr_b16 v[70:71], v8 offset:4608
  v_mfma_f32_32x32x16_bf16 v[96:111], v[36:39], v[236:239], v[96:111]
  v_cvt_pk_bf16_f32 v220, v120, v121
  v_cvt_pk_bf16_f32 v221, v122, v123
  v_cvt_pk_bf16_f32 v222, v124, v125
  v_cvt_pk_bf16_f32 v223, v126, v127
  ds_read_b64_tr_b16 v[72:73], v9 offset:0
  ds_read_b64_tr_b16 v[74:75], v9 offset:512
  v_mfma_f32_32x32x16_bf16 v[112:127], v[32:35], v[240:243], v[40:55]
  v_cvt_pk_bf16_f32 v224, v16, v17
  v_cvt_pk_bf16_f32 v225, v18, v19
  v_cvt_pk_bf16_f32 v226, v20, v21
  v_cvt_pk_bf16_f32 v227, v22, v23
  ds_read_b64_tr_b16 v[76:77], v9 offset:4096
  ds_read_b64_tr_b16 v[78:79], v9 offset:4608
  v_mfma_f32_32x32x16_bf16 v[112:127], v[36:39], v[244:247], v[112:127]
  v_cvt_pk_bf16_f32 v228, v24, v25
  v_cvt_pk_bf16_f32 v229, v26, v27
  v_cvt_pk_bf16_f32 v230, v28, v29
  v_cvt_pk_bf16_f32 v231, v30, v31
  ds_read_b64_tr_b16 v[80:81], v8 offset:8192
  ds_read_b64_tr_b16 v[82:83], v8 offset:8704
  v_mfma_f32_32x32x16_bf16 v[16:31], v[32:35], v[248:251], v[40:55]
  v_cvt_pk_bf16_f32 v232, v96, v97
  v_cvt_pk_bf16_f32 v233, v98, v99
  v_cvt_pk_bf16_f32 v234, v100, v101
  v_cvt_pk_bf16_f32 v235, v102, v103
  ds_read_b64_tr_b16 v[84:85], v8 offset:12288
  ds_read_b64_tr_b16 v[86:87], v8 offset:12800
  v_mfma_f32_32x32x16_bf16 v[16:31], v[36:39], v[252:255], v[16:31]
  v_cvt_pk_bf16_f32 v236, v104, v105
  v_cvt_pk_bf16_f32 v237, v106, v107
  v_cvt_pk_bf16_f32 v238, v108, v109
  v_cvt_pk_bf16_f32 v239, v110, v111
  s_waitcnt lgkmcnt(4)
  v_mfma_f32_16x16x32_bf16 v[96:99], v[128:131], v[64:67], 0
  ds_read_b64_tr_b16 v[88:89], v9 offset:8192
  ds_read_b64_tr_b16 v[90:91], v9 offset:8704
  v_mfma_f32_16x16x32_bf16 v[96:99], v[136:139], v[68:71], v[96:99]
  v_cvt_pk_bf16_f32 v240, v112, v113
  v_mfma_f32_16x16x32_bf16 v[100:103], v[140:143], v[68:71], 0
  ds_read_b64_tr_b16 v[92:93], v9 offset:12288
  ds_read_b64_tr_b16 v[94:95], v9 offset:12800
  v_mfma_f32_16x16x32_bf16 v[100:103], v[132:135], v[64:67], v[100:103]
  v_cvt_pk_bf16_f32 v241, v114, v115
  v_cvt_pk_bf16_f32 v242, v116, v117
  v_cvt_pk_bf16_f32 v243, v118, v119
  v_mfma_f32_16x16x32_bf16 v[108:111], v[132:135], v[72:75], 0
  ds_read_b64_tr_b16 v[64:65], v8 offset:16384
  ds_read_b64_tr_b16 v[66:67], v8 offset:16896
  v_mfma_f32_16x16x32_bf16 v[108:111], v[140:143], v[76:79], v[108:111]
  v_cvt_pk_bf16_f32 v244, v120, v121
  v_cvt_pk_bf16_f32 v245, v122, v123
  v_mfma_f32_16x16x32_bf16 v[104:107], v[136:139], v[76:79], 0
  ds_read_b64_tr_b16 v[68:69], v8 offset:20480
  ds_read_b64_tr_b16 v[70:71], v8 offset:20992
  v_mfma_f32_16x16x32_bf16 v[104:107], v[128:131], v[72:75], v[104:107]
  v_cvt_pk_bf16_f32 v246, v124, v125
  v_cvt_pk_bf16_f32 v247, v126, v127
  v_cvt_pk_bf16_f32 v248, v16, v17
  s_waitcnt lgkmcnt(4)
  v_mfma_f32_16x16x32_bf16 v[96:99], v[144:147], v[80:83], v[96:99]
  ds_read_b64_tr_b16 v[72:73], v9 offset:16384
  ds_read_b64_tr_b16 v[74:75], v9 offset:16896
  v_mfma_f32_16x16x32_bf16 v[96:99], v[152:155], v[84:87], v[96:99]
  v_cvt_pk_bf16_f32 v249, v18, v19
  v_mfma_f32_16x16x32_bf16 v[100:103], v[156:159], v[84:87], v[100:103]
  ds_read_b64_tr_b16 v[76:77], v9 offset:20480
  ds_read_b64_tr_b16 v[78:79], v9 offset:20992
  v_mfma_f32_16x16x32_bf16 v[100:103], v[148:151], v[80:83], v[100:103]
  ds_read_b32 v6, v4 offset:1384
  v_cvt_pk_bf16_f32 v250, v20, v21
  v_mfma_f32_16x16x32_bf16 v[108:111], v[148:151], v[88:91], v[108:111]
  ds_read_b64_tr_b16 v[80:81], v8 offset:24576
  ds_read_b64_tr_b16 v[82:83], v8 offset:25088
  v_mfma_f32_16x16x32_bf16 v[108:111], v[156:159], v[92:95], v[108:111]
  v_cvt_pk_bf16_f32 v251, v22, v23
  v_cvt_pk_bf16_f32 v252, v24, v25
  v_cvt_pk_bf16_f32 v253, v26, v27
  v_mfma_f32_16x16x32_bf16 v[104:107], v[152:155], v[92:95], v[104:107]
  ds_read_b64_tr_b16 v[84:85], v8 offset:28672
  ds_read_b64_tr_b16 v[86:87], v8 offset:29184
  v_mfma_f32_16x16x32_bf16 v[104:107], v[144:147], v[88:91], v[104:107]
  v_cvt_pk_bf16_f32 v254, v28, v29
  v_cvt_pk_bf16_f32 v255, v30, v31
  s_waitcnt lgkmcnt(5)
  v_mfma_f32_16x16x32_bf16 v[96:99], v[160:163], v[64:67], v[96:99]
  ds_read_b64_tr_b16 v[88:89], v9 offset:24576
  ds_read_b64_tr_b16 v[90:91], v9 offset:25088
  v_mfma_f32_16x16x32_bf16 v[96:99], v[168:171], v[68:71], v[96:99]
  s_mov_b32 s87, 0x3f317218
  s_mov_b32 s88, 0x358637bd
  v_mfma_f32_16x16x32_bf16 v[100:103], v[172:175], v[68:71], v[100:103]
  ds_read_b64_tr_b16 v[92:93], v9 offset:28672
  ds_read_b64_tr_b16 v[94:95], v9 offset:29184
  v_mfma_f32_16x16x32_bf16 v[100:103], v[164:167], v[64:67], v[100:103]
  s_waitcnt lgkmcnt(8)
  v_cmp_ne_u32 vcc, 0, v6
  s_cbranch_vccnz L_lp_41
L_lr_42:
  v_mfma_f32_16x16x32_bf16 v[108:111], v[164:167], v[72:75], v[108:111]
  ds_read_b64_tr_b16 v[64:65], v8 offset:32768
  ds_read_b64_tr_b16 v[66:67], v8 offset:33280
  v_mfma_f32_16x16x32_bf16 v[108:111], v[172:175], v[76:79], v[108:111]
  v_mov_b32 v24, 0x3f803f80
  v_mov_b32 v25, 0x3f803f80
  v_mov_b32 v26, 0x3f803f80
  v_mfma_f32_16x16x32_bf16 v[104:107], v[168:171], v[76:79], v[104:107]
  ds_read_b64_tr_b16 v[68:69], v8 offset:36864
  ds_read_b64_tr_b16 v[70:71], v8 offset:37376
  v_mfma_f32_16x16x32_bf16 v[104:107], v[160:163], v[72:75], v[104:107]
  v_mov_b32 v27, 0x3f803f80
  v_cvt_pk_bf16_f32 v32, v12, v3
  s_waitcnt lgkmcnt(4)
  v_mfma_f32_16x16x32_bf16 v[96:99], v[176:179], v[80:83], v[96:99]
  ds_read_b64_tr_b16 v[72:73], v9 offset:32768
  ds_read_b64_tr_b16 v[74:75], v9 offset:33280
  v_mfma_f32_16x16x32_bf16 v[96:99], v[184:187], v[84:87], v[96:99]
  v_lshlrev_b32 v36, 16, v32
  v_sub_f32 v36, v12, v36
  v_mfma_f32_16x16x32_bf16 v[100:103], v[188:191], v[84:87], v[100:103]
  ds_read_b64_tr_b16 v[76:77], v9 offset:36864
  ds_read_b64_tr_b16 v[78:79], v9 offset:37376
  v_mfma_f32_16x16x32_bf16 v[100:103], v[180:183], v[80:83], v[100:103]
  v_cvt_pk_bf16_f32 v36, v36, v3
  v_cvt_pk_bf16_f32 v34, v13, v3
  v_mfma_f32_16x16x32_bf16 v[108:111], v[180:183], v[88:91], v[108:111]
  ds_read_b64_tr_b16 v[80:81], v8 offset:40960
  ds_read_b64_tr_b16 v[82:83], v8 offset:41472
  v_mfma_f32_16x16x32_bf16 v[108:111], v[188:191], v[92:95], v[108:111]
  v_xor_b32 v10, 64, v14
  v_xor_b32 v11, 32, v10
  v_lshlrev_b32 v37, 16, v34
  v_mfma_f32_16x16x32_bf16 v[104:107], v[184:187], v[92:95], v[104:107]
  ds_read_b64_tr_b16 v[84:85], v8 offset:45056
  ds_read_b64_tr_b16 v[86:87], v8 offset:45568
  v_mfma_f32_16x16x32_bf16 v[104:107], v[176:179], v[88:91], v[104:107]
  v_sub_f32 v37, v13, v37
  v_cvt_pk_bf16_f32 v37, v37, v3
  s_waitcnt lgkmcnt(4)
  v_mfma_f32_16x16x32_bf16 v[96:99], v[192:195], v[64:67], v[96:99]
  ds_read_b64_tr_b16 v[88:89], v9 offset:40960
  ds_read_b64_tr_b16 v[90:91], v9 offset:41472
  v_mfma_f32_16x16x32_bf16 v[96:99], v[200:203], v[68:71], v[96:99]
  v_mfma_f32_16x16x32_bf16 v[100:103], v[204:207], v[68:71], v[100:103]
  ds_read_b64_tr_b16 v[92:93], v9 offset:45056
  ds_read_b64_tr_b16 v[94:95], v9 offset:45568
  v_mfma_f32_16x16x32_bf16 v[100:103], v[196:199], v[64:67], v[100:103]
  s_mov_b64 vcc, 0xffff
  v_cndmask_b32 v32, v36, v32, vcc
  v_cndmask_b32 v34, v37, v34, vcc
  s_mov_b32 vcc_lo, -1
  v_cndmask_b32 v32, 0, v32, vcc
  v_cndmask_b32 v34, 0, v34, vcc
  v_mfma_f32_16x16x32_bf16 v[108:111], v[196:199], v[72:75], v[108:111]
  ds_read_b64_tr_b16 v[64:65], v8 offset:49152
  ds_read_b64_tr_b16 v[66:67], v8 offset:49664
  v_mfma_f32_16x16x32_bf16 v[108:111], v[204:207], v[76:79], v[108:111]
  v_mov_b32 v33, 0
  v_mfma_f32_16x16x32_bf16 v[104:107], v[200:203], v[76:79], v[104:107]
  ds_read_b64_tr_b16 v[68:69], v8 offset:53248
  ds_read_b64_tr_b16 v[70:71], v8 offset:53760
  v_mfma_f32_16x16x32_bf16 v[104:107], v[192:195], v[72:75], v[104:107]
  v_mov_b32 v35, 0
  s_waitcnt lgkmcnt(4)
  v_mfma_f32_16x16x32_bf16 v[96:99], v[208:211], v[80:83], v[96:99]
  ds_read_b64_tr_b16 v[72:73], v9 offset:49152
  ds_read_b64_tr_b16 v[74:75], v9 offset:49664
  v_mfma_f32_16x16x32_bf16 v[96:99], v[216:219], v[84:87], v[96:99]
  v_mfma_f32_16x16x16_bf16 v[16:19], v[32:33], v[24:25], 0
  v_mfma_f32_16x16x32_bf16 v[100:103], v[220:223], v[84:87], v[100:103]
  ds_read_b64_tr_b16 v[76:77], v9 offset:53248
  ds_read_b64_tr_b16 v[78:79], v9 offset:53760
  v_mfma_f32_16x16x32_bf16 v[100:103], v[212:215], v[80:83], v[100:103]
  v_mfma_f32_16x16x16_bf16 v[20:23], v[34:35], v[24:25], 0
  v_mfma_f32_16x16x32_bf16 v[108:111], v[212:215], v[88:91], v[108:111]
  ds_read_b64_tr_b16 v[80:81], v8 offset:57344
  ds_read_b64_tr_b16 v[82:83], v8 offset:57856
  v_mfma_f32_16x16x32_bf16 v[108:111], v[220:223], v[92:95], v[108:111]
  s_lshl_b32 s64, s56, 12
  s_add_u32 s64, s64, 131072
  v_mfma_f32_16x16x32_bf16 v[104:107], v[216:219], v[92:95], v[104:107]
  ds_read_b64_tr_b16 v[84:85], v8 offset:61440
  ds_read_b64_tr_b16 v[86:87], v8 offset:61952
  v_mfma_f32_16x16x32_bf16 v[104:107], v[208:211], v[88:91], v[104:107]
  v_add_u32 v5, s64, v1
  s_add_u32 s78, s70, 4096
  s_lshl_b32 s73, s58, 2
  s_waitcnt lgkmcnt(4)
  v_mfma_f32_16x16x32_bf16 v[96:99], v[224:227], v[64:67], v[96:99]
  ds_read_b64_tr_b16 v[88:89], v9 offset:57344
  ds_read_b64_tr_b16 v[90:91], v9 offset:57856
  v_mfma_f32_16x16x32_bf16 v[96:99], v[232:235], v[68:71], v[96:99]
  s_add_u32 s73, s73, s56
  s_lshl_b32 s68, s60, 6
  v_mfma_f32_16x16x32_bf16 v[100:103], v[236:239], v[68:71], v[100:103]
  ds_read_b64_tr_b16 v[92:93], v9 offset:61440
  ds_read_b64_tr_b16 v[94:95], v9 offset:61952
  v_mfma_f32_16x16x32_bf16 v[100:103], v[228:231], v[64:67], v[100:103]
  s_lshl_b32 s75, s73, 7
  s_add_u32 s75, s75, 16384
  s_lshl_b32 s73, s73, 13
  s_lshl_b32 s69, s56, 3
  v_mfma_f32_16x16x32_bf16 v[108:111], v[228:231], v[72:75], v[108:111]
  ds_read_b64_tr_b16 v[64:65], v10 offset:0
  ds_read_b64_tr_b16 v[66:67], v10 offset:512
  v_mfma_f32_16x16x32_bf16 v[108:111], v[236:239], v[76:79], v[108:111]
  s_add_u32 s73, s73, 65536
  s_lshl_b32 s74, s58, 12
  s_add_u32 s68, s68, s69
  v_mfma_f32_16x16x32_bf16 v[104:107], v[232:235], v[76:79], v[104:107]
  ds_read_b64_tr_b16 v[68:69], v10 offset:4096
  ds_read_b64_tr_b16 v[70:71], v10 offset:4608
  v_mfma_f32_16x16x32_bf16 v[104:107], v[224:227], v[72:75], v[104:107]
  s_add_u32 s74, s74, 32768
  s_lshl_b32 s76, s57, 9
  s_add_u32 s76, s76, s73
  s_waitcnt lgkmcnt(4)
  v_mfma_f32_16x16x32_bf16 v[96:99], v[240:243], v[80:83], v[96:99]
  ds_read_b64_tr_b16 v[72:73], v11 offset:0
  ds_read_b64_tr_b16 v[74:75], v11 offset:512
  v_mfma_f32_16x16x32_bf16 v[96:99], v[248:251], v[84:87], v[96:99]
  s_lshl_b32 s77, s57, 8
  s_lshl_b32 s68, s68, 10
  v_mfma_f32_16x16x32_bf16 v[100:103], v[252:255], v[84:87], v[100:103]
  ds_read_b64_tr_b16 v[76:77], v11 offset:4096
  ds_read_b64_tr_b16 v[78:79], v11 offset:4608
  v_mfma_f32_16x16x32_bf16 v[100:103], v[244:247], v[80:83], v[100:103]
  s_add_u32 s77, s77, s74
  s_add_u32 s100, s54, s75
  s_addc_u32 s101, s55, 0
  s_lshl_b32 s69, s61, 7
  v_mfma_f32_16x16x32_bf16 v[108:111], v[244:247], v[88:91], v[108:111]
  ds_read_b64_tr_b16 v[80:81], v10 offset:8192
  ds_read_b64_tr_b16 v[82:83], v10 offset:8704
  v_mfma_f32_16x16x32_bf16 v[108:111], v[252:255], v[92:95], v[108:111]
  s_add_u32 s68, s68, s69
  s_xor_b32 s69, s68, 32768
  v_lshrrev_b32 v48, 3, v0
  v_mfma_f32_16x16x32_bf16 v[104:107], v[248:251], v[92:95], v[104:107]
  ds_read_b64_tr_b16 v[84:85], v10 offset:12288
  ds_read_b64_tr_b16 v[86:87], v10 offset:12800
  v_mfma_f32_16x16x32_bf16 v[104:107], v[240:243], v[88:91], v[104:107]
  v_and_b32 v28, 7, v0
  v_lshlrev_b32 v28, 4, v28
  v_lshl_add_u32 v28, v48, 10, v28
  s_waitcnt lgkmcnt(4)
  v_mfma_f32_16x16x32_bf16 v[112:115], v[128:131], v[64:67], 0
  ds_read_b64_tr_b16 v[88:89], v11 offset:8192
  ds_read_b64_tr_b16 v[90:91], v11 offset:8704
  v_mfma_f32_16x16x32_bf16 v[112:115], v[136:139], v[68:71], v[112:115]
  buffer_load_dwordx4 v[48:51], v28, s[4:7], s68 offen
  v_mfma_f32_16x16x32_bf16 v[116:119], v[140:143], v[68:71], 0
  ds_read_b64_tr_b16 v[92:93], v11 offset:12288
  ds_read_b64_tr_b16 v[94:95], v11 offset:12800
  v_mfma_f32_16x16x32_bf16 v[116:119], v[132:135], v[64:67], v[116:119]
  buffer_load_dwordx4 v[52:55], v28, s[4:7], s69 offen
  v_mul_f32 v56, v96, v16
  v_mul_f32 v57, v97, v17
  v_mul_f32 v58, v98, v18
  v_mfma_f32_16x16x32_bf16 v[124:127], v[132:135], v[72:75], 0
  ds_read_b64_tr_b16 v[64:65], v10 offset:16384
  ds_read_b64_tr_b16 v[66:67], v10 offset:16896
  v_mfma_f32_16x16x32_bf16 v[124:127], v[140:143], v[76:79], v[124:127]
  v_mul_f32 v59, v99, v19
  v_exp_f32 v60, v56 clamp
  v_exp_f32 v61, v57 clamp
  v_mfma_f32_16x16x32_bf16 v[120:123], v[136:139], v[76:79], 0
  ds_read_b64_tr_b16 v[68:69], v10 offset:20480
  ds_read_b64_tr_b16 v[70:71], v10 offset:20992
  v_mfma_f32_16x16x32_bf16 v[120:123], v[128:131], v[72:75], v[120:123]
  v_exp_f32 v62, v58 clamp
  v_exp_f32 v63, v59 clamp
  s_waitcnt lgkmcnt(4)
  v_mfma_f32_16x16x32_bf16 v[112:115], v[144:147], v[80:83], v[112:115]
  ds_read_b64_tr_b16 v[72:73], v11 offset:16384
  ds_read_b64_tr_b16 v[74:75], v11 offset:16896
  v_mfma_f32_16x16x32_bf16 v[112:115], v[152:155], v[84:87], v[112:115]
  v_add_f32 v60, s88, v60
  v_add_f32 v61, s88, v61
  v_add_f32 v62, s88, v62
  v_add_f32 v63, s88, v63
  v_mfma_f32_16x16x32_bf16 v[116:119], v[156:159], v[84:87], v[116:119]
  ds_read_b64_tr_b16 v[76:77], v11 offset:20480
  ds_read_b64_tr_b16 v[78:79], v11 offset:20992
  v_mfma_f32_16x16x32_bf16 v[116:119], v[148:151], v[80:83], v[116:119]
  v_fma_f32 v56, v56, s87, v60
  v_fma_f32 v57, v57, s87, v61
  v_fma_f32 v58, v58, s87, v62
  v_fma_f32 v59, v59, s87, v63
  v_mfma_f32_16x16x32_bf16 v[124:127], v[148:151], v[88:91], v[124:127]
  ds_read_b64_tr_b16 v[80:81], v10 offset:24576
  ds_read_b64_tr_b16 v[82:83], v10 offset:25088
  v_mfma_f32_16x16x32_bf16 v[124:127], v[156:159], v[92:95], v[124:127]
  v_max_f32 v56, v56, v60
  v_max_f32 v57, v57, v61
  v_max_f32 v58, v58, v62
  v_max_f32 v59, v59, v63
  v_cvt_pk_bf16_f32 v32, v56, v57
  v_mfma_f32_16x16x32_bf16 v[120:123], v[152:155], v[92:95], v[120:123]
  ds_read_b64_tr_b16 v[84:85], v10 offset:28672
  ds_read_b64_tr_b16 v[86:87], v10 offset:29184
  v_mfma_f32_16x16x32_bf16 v[120:123], v[144:147], v[88:91], v[120:123]
  v_cvt_pk_bf16_f32 v33, v58, v59
  v_mul_f32 v56, v100, v20
  v_mul_f32 v57, v101, v21
  v_mul_f32 v58, v102, v22
  s_waitcnt lgkmcnt(4)
  v_mfma_f32_16x16x32_bf16 v[112:115], v[160:163], v[64:67], v[112:115]
  ds_read_b64_tr_b16 v[88:89], v11 offset:24576
  ds_read_b64_tr_b16 v[90:91], v11 offset:25088
  v_mfma_f32_16x16x32_bf16 v[112:115], v[168:171], v[68:71], v[112:115]
  v_mul_f32 v59, v103, v23
  v_exp_f32 v60, v56 clamp
  v_mfma_f32_16x16x32_bf16 v[116:119], v[172:175], v[68:71], v[116:119]
  ds_read_b64_tr_b16 v[92:93], v11 offset:28672
  ds_read_b64_tr_b16 v[94:95], v11 offset:29184
  v_mfma_f32_16x16x32_bf16 v[116:119], v[164:167], v[64:67], v[116:119]
  v_exp_f32 v61, v57 clamp
  v_exp_f32 v62, v58 clamp
  v_exp_f32 v63, v59 clamp
  v_mfma_f32_16x16x32_bf16 v[124:127], v[164:167], v[72:75], v[124:127]
  ds_read_b64_tr_b16 v[64:65], v10 offset:32768
  ds_read_b64_tr_b16 v[66:67], v10 offset:33280
  v_mfma_f32_16x16x32_bf16 v[124:127], v[172:175], v[76:79], v[124:127]
  v_add_f32 v60, s88, v60
  v_add_f32 v61, s88, v61
  v_add_f32 v62, s88, v62
  v_add_f32 v63, s88, v63
  v_mfma_f32_16x16x32_bf16 v[120:123], v[168:171], v[76:79], v[120:123]
  ds_read_b64_tr_b16 v[68:69], v10 offset:36864
  ds_read_b64_tr_b16 v[70:71], v10 offset:37376
  v_mfma_f32_16x16x32_bf16 v[120:123], v[160:163], v[72:75], v[120:123]
  v_fma_f32 v56, v56, s87, v60
  v_fma_f32 v57, v57, s87, v61
  v_fma_f32 v58, v58, s87, v62
  v_fma_f32 v59, v59, s87, v63
  s_waitcnt lgkmcnt(4)
  v_mfma_f32_16x16x32_bf16 v[112:115], v[176:179], v[80:83], v[112:115]
  ds_read_b64_tr_b16 v[72:73], v11 offset:32768
  ds_read_b64_tr_b16 v[74:75], v11 offset:33280
  v_mfma_f32_16x16x32_bf16 v[112:115], v[184:187], v[84:87], v[112:115]
  s_barrier
  v_max_f32 v56, v56, v60
  v_max_f32 v57, v57, v61
  v_max_f32 v58, v58, v62
  v_mfma_f32_16x16x32_bf16 v[116:119], v[188:191], v[84:87], v[116:119]
  ds_read_b64_tr_b16 v[76:77], v11 offset:36864
  ds_read_b64_tr_b16 v[78:79], v11 offset:37376
  v_mfma_f32_16x16x32_bf16 v[116:119], v[180:183], v[80:83], v[116:119]
  v_max_f32 v59, v59, v63
  v_cvt_pk_bf16_f32 v34, v56, v57
  v_cvt_pk_bf16_f32 v35, v58, v59
  v_mul_f32 v56, v104, v16
  v_mfma_f32_16x16x32_bf16 v[124:127], v[180:183], v[88:91], v[124:127]
  ds_read_b64_tr_b16 v[80:81], v10 offset:40960
  ds_read_b64_tr_b16 v[82:83], v10 offset:41472
  v_mfma_f32_16x16x32_bf16 v[124:127], v[188:191], v[92:95], v[124:127]
  v_xor_b32 v8, 65536, v14
  v_xor_b32 v9, 32, v8
  v_mul_f32 v57, v105, v17
  v_mul_f32 v58, v106, v18
  v_mul_f32 v59, v107, v19
  v_mfma_f32_16x16x32_bf16 v[120:123], v[184:187], v[92:95], v[120:123]
  ds_read_b64_tr_b16 v[84:85], v10 offset:45056
  ds_read_b64_tr_b16 v[86:87], v10 offset:45568
  v_mfma_f32_16x16x32_bf16 v[120:123], v[176:179], v[88:91], v[120:123]
  v_exp_f32 v60, v56 clamp
  v_exp_f32 v61, v57 clamp
  s_waitcnt lgkmcnt(4)
  v_mfma_f32_16x16x32_bf16 v[112:115], v[192:195], v[64:67], v[112:115]
  ds_read_b64_tr_b16 v[88:89], v11 offset:40960
  ds_read_b64_tr_b16 v[90:91], v11 offset:41472
  v_mfma_f32_16x16x32_bf16 v[112:115], v[200:203], v[68:71], v[112:115]
  v_exp_f32 v62, v58 clamp
  v_exp_f32 v63, v59 clamp
  v_mfma_f32_16x16x32_bf16 v[116:119], v[204:207], v[68:71], v[116:119]
  ds_read_b64_tr_b16 v[92:93], v11 offset:45056
  ds_read_b64_tr_b16 v[94:95], v11 offset:45568
  v_mfma_f32_16x16x32_bf16 v[116:119], v[196:199], v[64:67], v[116:119]
  v_add_f32 v60, s88, v60
  v_add_f32 v61, s88, v61
  v_add_f32 v62, s88, v62
  v_add_f32 v63, s88, v63
  v_mfma_f32_16x16x32_bf16 v[124:127], v[196:199], v[72:75], v[124:127]
  ds_read_b64_tr_b16 v[64:65], v10 offset:49152
  ds_read_b64_tr_b16 v[66:67], v10 offset:49664
  v_mfma_f32_16x16x32_bf16 v[124:127], v[204:207], v[76:79], v[124:127]
  v_fma_f32 v56, v56, s87, v60
  v_fma_f32 v57, v57, s87, v61
  v_fma_f32 v58, v58, s87, v62
  v_fma_f32 v59, v59, s87, v63
  v_mfma_f32_16x16x32_bf16 v[120:123], v[200:203], v[76:79], v[120:123]
  ds_read_b64_tr_b16 v[68:69], v10 offset:53248
  ds_read_b64_tr_b16 v[70:71], v10 offset:53760
  v_mfma_f32_16x16x32_bf16 v[120:123], v[192:195], v[72:75], v[120:123]
  v_max_f32 v56, v56, v60
  v_max_f32 v57, v57, v61
  v_max_f32 v58, v58, v62
  v_max_f32 v59, v59, v63
  v_cvt_pk_bf16_f32 v36, v56, v57
  s_waitcnt lgkmcnt(4)
  v_mfma_f32_16x16x32_bf16 v[112:115], v[208:211], v[80:83], v[112:115]
  ds_read_b64_tr_b16 v[72:73], v11 offset:49152
  ds_read_b64_tr_b16 v[74:75], v11 offset:49664
  v_mfma_f32_16x16x32_bf16 v[112:115], v[216:219], v[84:87], v[112:115]
  v_cvt_pk_bf16_f32 v37, v58, v59
  v_mul_f32 v56, v108, v20
  v_mul_f32 v57, v109, v21
  v_mfma_f32_16x16x32_bf16 v[116:119], v[220:223], v[84:87], v[116:119]
  ds_read_b64_tr_b16 v[76:77], v11 offset:53248
  ds_read_b64_tr_b16 v[78:79], v11 offset:53760
  v_mfma_f32_16x16x32_bf16 v[116:119], v[212:215], v[80:83], v[116:119]
  ds_read_b32 v6, v4 offset:1380
  v_mul_f32 v58, v110, v22
  v_mul_f32 v59, v111, v23
  v_exp_f32 v60, v56 clamp
  v_mfma_f32_16x16x32_bf16 v[124:127], v[212:215], v[88:91], v[124:127]
  ds_read_b64_tr_b16 v[80:81], v10 offset:57344
  ds_read_b64_tr_b16 v[82:83], v10 offset:57856
  v_mfma_f32_16x16x32_bf16 v[124:127], v[220:223], v[92:95], v[124:127]
  v_exp_f32 v61, v57 clamp
  v_exp_f32 v62, v58 clamp
  v_mfma_f32_16x16x32_bf16 v[120:123], v[216:219], v[92:95], v[120:123]
  ds_read_b64_tr_b16 v[84:85], v10 offset:61440
  ds_read_b64_tr_b16 v[86:87], v10 offset:61952
  v_mfma_f32_16x16x32_bf16 v[120:123], v[208:211], v[88:91], v[120:123]
  v_exp_f32 v63, v59 clamp
  v_add_f32 v60, s88, v60
  v_add_f32 v61, s88, v61
  v_add_f32 v62, s88, v62
  s_waitcnt lgkmcnt(5)
  v_mfma_f32_16x16x32_bf16 v[112:115], v[224:227], v[64:67], v[112:115]
  ds_read_b64_tr_b16 v[88:89], v11 offset:57344
  ds_read_b64_tr_b16 v[90:91], v11 offset:57856
  v_mfma_f32_16x16x32_bf16 v[112:115], v[232:235], v[68:71], v[112:115]
  v_add_f32 v63, s88, v63
  v_fma_f32 v56, v56, s87, v60
  v_fma_f32 v57, v57, s87, v61
  v_mfma_f32_16x16x32_bf16 v[116:119], v[236:239], v[68:71], v[116:119]
  ds_read_b64_tr_b16 v[92:93], v11 offset:61440
  ds_read_b64_tr_b16 v[94:95], v11 offset:61952
  v_mfma_f32_16x16x32_bf16 v[116:119], v[228:231], v[64:67], v[116:119]
  s_waitcnt lgkmcnt(8)
  v_cmp_ne_u32 vcc, 0, v6
  s_cbranch_vccnz L_lp_43
L_lr_44:
  v_fma_f32 v58, v58, s87, v62
  v_fma_f32 v59, v59, s87, v63
  v_max_f32 v56, v56, v60
  v_mfma_f32_16x16x32_bf16 v[124:127], v[228:231], v[72:75], v[124:127]
  ds_read_b64_tr_b16 v[64:65], v8 offset:0
  ds_read_b64_tr_b16 v[66:67], v8 offset:512
  v_mfma_f32_16x16x32_bf16 v[124:127], v[236:239], v[76:79], v[124:127]
  v_max_f32 v57, v57, v61
  v_max_f32 v58, v58, v62
  v_max_f32 v59, v59, v63
  v_cvt_pk_bf16_f32 v38, v56, v57
  v_mfma_f32_16x16x32_bf16 v[120:123], v[232:235], v[76:79], v[120:123]
  ds_read_b64_tr_b16 v[68:69], v8 offset:4096
  ds_read_b64_tr_b16 v[70:71], v8 offset:4608
  v_mfma_f32_16x16x32_bf16 v[120:123], v[224:227], v[72:75], v[120:123]
  v_cvt_pk_bf16_f32 v39, v58, v59
  v_mfma_f32_16x16x32_bf16 v[96:99], v[24:27], v[32:35], 0
  s_waitcnt lgkmcnt(4)
  v_mfma_f32_16x16x32_bf16 v[112:115], v[240:243], v[80:83], v[112:115]
  ds_read_b64_tr_b16 v[72:73], v9 offset:0
  ds_read_b64_tr_b16 v[74:75], v9 offset:512
  v_mfma_f32_16x16x32_bf16 v[112:115], v[248:251], v[84:87], v[112:115]
  s_barrier
  v_mfma_f32_16x16x32_bf16 v[100:103], v[24:27], v[36:39], 0
  v_mfma_f32_16x16x32_bf16 v[116:119], v[252:255], v[84:87], v[116:119]
  ds_read_b64_tr_b16 v[76:77], v9 offset:4096
  ds_read_b64_tr_b16 v[78:79], v9 offset:4608
  v_mfma_f32_16x16x32_bf16 v[116:119], v[244:247], v[80:83], v[116:119]
  v_mfma_f32_16x16x32_bf16 v[124:127], v[244:247], v[88:91], v[124:127]
  ds_read_b64_tr_b16 v[80:81], v8 offset:8192
  ds_read_b64_tr_b16 v[82:83], v8 offset:8704
  v_mfma_f32_16x16x32_bf16 v[124:127], v[252:255], v[92:95], v[124:127]
  v_mfma_f32_16x16x32_bf16 v[120:123], v[248:251], v[92:95], v[120:123]
  ds_read_b64_tr_b16 v[84:85], v8 offset:12288
  ds_read_b64_tr_b16 v[86:87], v8 offset:12800
  v_mfma_f32_16x16x32_bf16 v[120:123], v[240:243], v[88:91], v[120:123]
  s_mov_b64 vcc, 0xffff
  v_cndmask_b32 v15, v100, v96, vcc
  s_waitcnt lgkmcnt(4)
  v_mfma_f32_16x16x32_bf16 v[96:99], v[128:131], v[64:67], 0
  ds_read_b64_tr_b16 v[88:89], v9 offset:8192
  ds_read_b64_tr_b16 v[90:91], v9 offset:8704
  v_mfma_f32_16x16x32_bf16 v[96:99], v[136:139], v[68:71], v[96:99]
  v_mfma_f32_16x16x32_bf16 v[100:103], v[140:143], v[68:71], 0
  ds_read_b64_tr_b16 v[92:93], v9 offset:12288
  ds_read_b64_tr_b16 v[94:95], v9 offset:12800
  v_mfma_f32_16x16x32_bf16 v[100:103], v[132:135], v[64:67], v[100:103]
  v_mul_f32 v56, v112, v16
  v_mul_f32 v57, v113, v17
  v_mul_f32 v58, v114, v18
  v_mul_f32 v59, v115, v19
  v_mfma_f32_16x16x32_bf16 v[108:111], v[132:135], v[72:75], 0
  ds_read_b64_tr_b16 v[64:65], v8 offset:16384
  ds_read_b64_tr_b16 v[66:67], v8 offset:16896
  v_mfma_f32_16x16x32_bf16 v[108:111], v[140:143], v[76:79], v[108:111]
  v_exp_f32 v60, v56 clamp
  v_exp_f32 v61, v57 clamp
  v_mfma_f32_16x16x32_bf16 v[104:107], v[136:139], v[76:79], 0
  ds_read_b64_tr_b16 v[68:69], v8 offset:20480
  ds_read_b64_tr_b16 v[70:71], v8 offset:20992
  v_mfma_f32_16x16x32_bf16 v[104:107], v[128:131], v[72:75], v[104:107]
  v_exp_f32 v62, v58 clamp
  v_exp_f32 v63, v59 clamp
  v_add_f32 v60, s88, v60
  s_waitcnt lgkmcnt(4)
  v_mfma_f32_16x16x32_bf16 v[96:99], v[144:147], v[80:83], v[96:99]
  ds_read_b64_tr_b16 v[72:73], v9 offset:16384
  ds_read_b64_tr_b16 v[74:75], v9 offset:16896
  v_mfma_f32_16x16x32_bf16 v[96:99], v[152:155], v[84:87], v[96:99]
  v_add_f32 v61, s88, v61
  v_add_f32 v62, s88, v62
  v_add_f32 v63, s88, v63
  v_mfma_f32_16x16x32_bf16 v[100:103], v[156:159], v[84:87], v[100:103]
  ds_read_b64_tr_b16 v[76:77], v9 offset:20480
  ds_read_b64_tr_b16 v[78:79], v9 offset:20992
  v_mfma_f32_16x16x32_bf16 v[100:103], v[148:151], v[80:83], v[100:103]
  ds_read_b32 v6, v4 offset:1376
  v_fma_f32 v56, v56, s87, v60
  v_fma_f32 v57, v57, s87, v61
  v_fma_f32 v58, v58, s87, v62
  v_fma_f32 v59, v59, s87, v63
  v_mfma_f32_16x16x32_bf16 v[108:111], v[148:151], v[88:91], v[108:111]
  ds_read_b64_tr_b16 v[80:81], v8 offset:24576
  ds_read_b64_tr_b16 v[82:83], v8 offset:25088
  v_mfma_f32_16x16x32_bf16 v[108:111], v[156:159], v[92:95], v[108:111]
  v_max_f32 v56, v56, v60
  v_max_f32 v57, v57, v61
  v_max_f32 v58, v58, v62
  v_max_f32 v59, v59, v63
  v_mfma_f32_16x16x32_bf16 v[104:107], v[152:155], v[92:95], v[104:107]
  ds_read_b64_tr_b16 v[84:85], v8 offset:28672
  ds_read_b64_tr_b16 v[86:87], v8 offset:29184
  v_mfma_f32_16x16x32_bf16 v[104:107], v[144:147], v[88:91], v[104:107]
  v_cvt_pk_bf16_f32 v40, v56, v57
  v_cvt_pk_bf16_f32 v41, v58, v59
  v_mul_f32 v56, v116, v20
  v_mul_f32 v57, v117, v21
  v_mul_f32 v58, v118, v22
  s_waitcnt lgkmcnt(5)
  v_mfma_f32_16x16x32_bf16 v[96:99], v[160:163], v[64:67], v[96:99]
  ds_read_b64_tr_b16 v[88:89], v9 offset:24576
  ds_read_b64_tr_b16 v[90:91], v9 offset:25088
  v_mfma_f32_16x16x32_bf16 v[96:99], v[168:171], v[68:71], v[96:99]
  v_mul_f32 v59, v119, v23
  v_exp_f32 v60, v56 clamp
  v_mfma_f32_16x16x32_bf16 v[100:103], v[172:175], v[68:71], v[100:103]
  ds_read_b64_tr_b16 v[92:93], v9 offset:28672
  ds_read_b64_tr_b16 v[94:95], v9 offset:29184
  v_mfma_f32_16x16x32_bf16 v[100:103], v[164:167], v[64:67], v[100:103]
  s_waitcnt lgkmcnt(8)
  v_cmp_ne_u32 vcc, 0, v6
  s_cbranch_vccnz L_lp_45
L_lr_46:
  v_exp_f32 v61, v57 clamp
  v_mfma_f32_16x16x32_bf16 v[108:111], v[164:167], v[72:75], v[108:111]
  ds_read_b64_tr_b16 v[64:65], v8 offset:32768
  ds_read_b64_tr_b16 v[66:67], v8 offset:33280
  v_mfma_f32_16x16x32_bf16 v[108:111], v[172:175], v[76:79], v[108:111]
  v_exp_f32 v62, v58 clamp
  v_exp_f32 v63, v59 clamp
  v_add_f32 v60, s88, v60
  v_mfma_f32_16x16x32_bf16 v[104:107], v[168:171], v[76:79], v[104:107]
  ds_read_b64_tr_b16 v[68:69], v8 offset:36864
  ds_read_b64_tr_b16 v[70:71], v8 offset:37376
  v_mfma_f32_16x16x32_bf16 v[104:107], v[160:163], v[72:75], v[104:107]
  v_add_f32 v61, s88, v61
  v_add_f32 v62, s88, v62
  v_add_f32 v63, s88, v63
  v_fma_f32 v56, v56, s87, v60
  s_waitcnt lgkmcnt(4)
  v_mfma_f32_16x16x32_bf16 v[96:99], v[176:179], v[80:83], v[96:99]
  ds_read_b64_tr_b16 v[72:73], v9 offset:32768
  ds_read_b64_tr_b16 v[74:75], v9 offset:33280
  v_mfma_f32_16x16x32_bf16 v[96:99], v[184:187], v[84:87], v[96:99]
  v_fma_f32 v57, v57, s87, v61
  v_fma_f32 v58, v58, s87, v62
  v_fma_f32 v59, v59, s87, v63
  v_mfma_f32_16x16x32_bf16 v[100:103], v[188:191], v[84:87], v[100:103]
  ds_read_b64_tr_b16 v[76:77], v9 offset:36864
  ds_read_b64_tr_b16 v[78:79], v9 offset:37376
  v_mfma_f32_16x16x32_bf16 v[100:103], v[180:183], v[80:83], v[100:103]
  v_max_f32 v56, v56, v60
  v_max_f32 v57, v57, v61
  v_max_f32 v58, v58, v62
  v_max_f32 v59, v59, v63
  v_cvt_pk_bf16_f32 v42, v56, v57
  v_mfma_f32_16x16x32_bf16 v[108:111], v[180:183], v[88:91], v[108:111]
  ds_read_b64_tr_b16 v[80:81], v8 offset:40960
  ds_read_b64_tr_b16 v[82:83], v8 offset:41472
  v_mfma_f32_16x16x32_bf16 v[108:111], v[188:191], v[92:95], v[108:111]
  v_xor_b32 v10, 65600, v14
  v_xor_b32 v11, 32, v10
  v_cvt_pk_bf16_f32 v43, v58, v59
  v_mul_f32 v56, v120, v16
  v_mfma_f32_16x16x32_bf16 v[104:107], v[184:187], v[92:95], v[104:107]
  ds_read_b64_tr_b16 v[84:85], v8 offset:45056
  ds_read_b64_tr_b16 v[86:87], v8 offset:45568
  v_mfma_f32_16x16x32_bf16 v[104:107], v[176:179], v[88:91], v[104:107]
  v_mul_f32 v57, v121, v17
  v_mul_f32 v58, v122, v18
  v_mul_f32 v59, v123, v19
  v_exp_f32 v60, v56 clamp
  s_waitcnt lgkmcnt(4)
  v_mfma_f32_16x16x32_bf16 v[96:99], v[192:195], v[64:67], v[96:99]
  ds_read_b64_tr_b16 v[88:89], v9 offset:40960
  ds_read_b64_tr_b16 v[90:91], v9 offset:41472
  v_mfma_f32_16x16x32_bf16 v[96:99], v[200:203], v[68:71], v[96:99]
  v_exp_f32 v61, v57 clamp
  v_mfma_f32_16x16x32_bf16 v[100:103], v[204:207], v[68:71], v[100:103]
  ds_read_b64_tr_b16 v[92:93], v9 offset:45056
  ds_read_b64_tr_b16 v[94:95], v9 offset:45568
  v_mfma_f32_16x16x32_bf16 v[100:103], v[196:199], v[64:67], v[100:103]
  v_exp_f32 v62, v58 clamp
  v_exp_f32 v63, v59 clamp
  v_add_f32 v60, s88, v60
  v_mfma_f32_16x16x32_bf16 v[108:111], v[196:199], v[72:75], v[108:111]
  ds_read_b64_tr_b16 v[64:65], v8 offset:49152
  ds_read_b64_tr_b16 v[66:67], v8 offset:49664
  v_mfma_f32_16x16x32_bf16 v[108:111], v[204:207], v[76:79], v[108:111]
  v_add_f32 v61, s88, v61
  v_add_f32 v62, s88, v62
  v_add_f32 v63, s88, v63
  v_fma_f32 v56, v56, s87, v60
  v_mfma_f32_16x16x32_bf16 v[104:107], v[200:203], v[76:79], v[104:107]
  ds_read_b64_tr_b16 v[68:69], v8 offset:53248
  ds_read_b64_tr_b16 v[70:71], v8 offset:53760
  v_mfma_f32_16x16x32_bf16 v[104:107], v[192:195], v[72:75], v[104:107]
  v_fma_f32 v57, v57, s87, v61
  v_fma_f32 v58, v58, s87, v62
  v_fma_f32 v59, v59, s87, v63
  v_max_f32 v56, v56, v60
  v_max_f32 v57, v57, v61
  s_waitcnt lgkmcnt(4)
  v_mfma_f32_16x16x32_bf16 v[96:99], v[208:211], v[80:83], v[96:99]
  ds_read_b64_tr_b16 v[72:73], v9 offset:49152
  ds_read_b64_tr_b16 v[74:75], v9 offset:49664
  v_mfma_f32_16x16x32_bf16 v[96:99], v[216:219], v[84:87], v[96:99]
  v_max_f32 v58, v58, v62
  v_max_f32 v59, v59, v63
  v_cvt_pk_bf16_f32 v44, v56, v57
  v_mfma_f32_16x16x32_bf16 v[100:103], v[220:223], v[84:87], v[100:103]
  ds_read_b64_tr_b16 v[76:77], v9 offset:53248
  ds_read_b64_tr_b16 v[78:79], v9 offset:53760
  v_mfma_f32_16x16x32_bf16 v[100:103], v[212:215], v[80:83], v[100:103]
  v_cvt_pk_bf16_f32 v45, v58, v59
  v_mul_f32 v56, v124, v20
  v_mul_f32 v57, v125, v21
  v_mul_f32 v58, v126, v22
  v_mul_f32 v59, v127, v23
  v_mfma_f32_16x16x32_bf16 v[108:111], v[212:215], v[88:91], v[108:111]
  ds_read_b64_tr_b16 v[80:81], v8 offset:57344
  ds_read_b64_tr_b16 v[82:83], v8 offset:57856
  v_mfma_f32_16x16x32_bf16 v[108:111], v[220:223], v[92:95], v[108:111]
  v_exp_f32 v60, v56 clamp
  v_exp_f32 v61, v57 clamp
  v_mfma_f32_16x16x32_bf16 v[104:107], v[216:219], v[92:95], v[104:107]
  ds_read_b64_tr_b16 v[84:85], v8 offset:61440
  ds_read_b64_tr_b16 v[86:87], v8 offset:61952
  v_mfma_f32_16x16x32_bf16 v[104:107], v[208:211], v[88:91], v[104:107]
  v_exp_f32 v62, v58 clamp
  v_exp_f32 v63, v59 clamp
  s_waitcnt lgkmcnt(4)
  v_mfma_f32_16x16x32_bf16 v[96:99], v[224:227], v[64:67], v[96:99]
  ds_read_b64_tr_b16 v[88:89], v9 offset:57344
  ds_read_b64_tr_b16 v[90:91], v9 offset:57856
  v_mfma_f32_16x16x32_bf16 v[96:99], v[232:235], v[68:71], v[96:99]
  v_add_f32 v60, s88, v60
  v_add_f32 v61, s88, v61
  v_add_f32 v62, s88, v62
  v_add_f32 v63, s88, v63
  v_mfma_f32_16x16x32_bf16 v[100:103], v[236:239], v[68:71], v[100:103]
  ds_read_b64_tr_b16 v[92:93], v9 offset:61440
  ds_read_b64_tr_b16 v[94:95], v9 offset:61952
  v_mfma_f32_16x16x32_bf16 v[100:103], v[228:231], v[64:67], v[100:103]
  v_fma_f32 v56, v56, s87, v60
  v_fma_f32 v57, v57, s87, v61
  v_fma_f32 v58, v58, s87, v62
  v_fma_f32 v59, v59, s87, v63
  v_mfma_f32_16x16x32_bf16 v[108:111], v[228:231], v[72:75], v[108:111]
  ds_read_b64_tr_b16 v[64:65], v10 offset:0
  ds_read_b64_tr_b16 v[66:67], v10 offset:512
  v_mfma_f32_16x16x32_bf16 v[108:111], v[236:239], v[76:79], v[108:111]
  v_max_f32 v56, v56, v60
  v_max_f32 v57, v57, v61
  v_max_f32 v58, v58, v62
  v_max_f32 v59, v59, v63
  v_mfma_f32_16x16x32_bf16 v[104:107], v[232:235], v[76:79], v[104:107]
  ds_read_b64_tr_b16 v[68:69], v10 offset:4096
  ds_read_b64_tr_b16 v[70:71], v10 offset:4608
  v_mfma_f32_16x16x32_bf16 v[104:107], v[224:227], v[72:75], v[104:107]
  v_cvt_pk_bf16_f32 v46, v56, v57
  v_cvt_pk_bf16_f32 v47, v58, v59
  s_waitcnt lgkmcnt(4)
  v_mfma_f32_16x16x32_bf16 v[96:99], v[240:243], v[80:83], v[96:99]
  ds_read_b64_tr_b16 v[72:73], v11 offset:0
  ds_read_b64_tr_b16 v[74:75], v11 offset:512
  v_mfma_f32_16x16x32_bf16 v[96:99], v[248:251], v[84:87], v[96:99]
  v_mfma_f32_16x16x32_bf16 v[112:115], v[24:27], v[40:43], 0
  v_mfma_f32_16x16x32_bf16 v[116:119], v[24:27], v[44:47], 0
  v_mfma_f32_16x16x32_bf16 v[100:103], v[252:255], v[84:87], v[100:103]
  ds_read_b64_tr_b16 v[76:77], v11 offset:4096
  ds_read_b64_tr_b16 v[78:79], v11 offset:4608
  v_mfma_f32_16x16x32_bf16 v[100:103], v[244:247], v[80:83], v[100:103]
  v_mfma_f32_16x16x32_bf16 v[108:111], v[244:247], v[88:91], v[108:111]
  ds_read_b64_tr_b16 v[80:81], v10 offset:8192
  ds_read_b64_tr_b16 v[82:83], v10 offset:8704
  v_mfma_f32_16x16x32_bf16 v[108:111], v[252:255], v[92:95], v[108:111]
  v_mfma_f32_16x16x32_bf16 v[104:107], v[248:251], v[92:95], v[104:107]
  ds_read_b64_tr_b16 v[84:85], v10 offset:12288
  ds_read_b64_tr_b16 v[86:87], v10 offset:12800
  v_mfma_f32_16x16x32_bf16 v[104:107], v[240:243], v[88:91], v[104:107]
  s_mov_b32 vcc_lo, 0
  s_mov_b32 vcc_hi, -1
  v_cndmask_b32 v15, v15, v116, vcc
  s_mov_b32 vcc_hi, 0xffff
  v_cndmask_b32 v15, v15, v112, vcc
  s_waitcnt lgkmcnt(4)
  v_mfma_f32_16x16x32_bf16 v[112:115], v[128:131], v[64:67], 0
  ds_read_b64_tr_b16 v[88:89], v11 offset:8192
  ds_read_b64_tr_b16 v[90:91], v11 offset:8704
  v_mfma_f32_16x16x32_bf16 v[112:115], v[136:139], v[68:71], v[112:115]
  v_mfma_f32_16x16x32_bf16 v[116:119], v[140:143], v[68:71], 0
  ds_read_b64_tr_b16 v[92:93], v11 offset:12288
  ds_read_b64_tr_b16 v[94:95], v11 offset:12800
  v_mfma_f32_16x16x32_bf16 v[116:119], v[132:135], v[64:67], v[116:119]
  v_mul_f32 v56, v96, v16
  v_mul_f32 v57, v97, v17
  v_mfma_f32_16x16x32_bf16 v[124:127], v[132:135], v[72:75], 0
  ds_read_b64_tr_b16 v[64:65], v10 offset:16384
  ds_read_b64_tr_b16 v[66:67], v10 offset:16896
  v_mfma_f32_16x16x32_bf16 v[124:127], v[140:143], v[76:79], v[124:127]
  v_mul_f32 v58, v98, v18
  v_mul_f32 v59, v99, v19
  v_cvt_pk_bf16_f32 v96, v56, v57
  v_mfma_f32_16x16x32_bf16 v[120:123], v[136:139], v[76:79], 0
  ds_read_b64_tr_b16 v[68:69], v10 offset:20480
  ds_read_b64_tr_b16 v[70:71], v10 offset:20992
  v_mfma_f32_16x16x32_bf16 v[120:123], v[128:131], v[72:75], v[120:123]
  v_cvt_pk_bf16_f32 v97, v58, v59
  v_mul_f32 v60, v100, v20
  s_waitcnt lgkmcnt(4)
  v_mfma_f32_16x16x32_bf16 v[112:115], v[144:147], v[80:83], v[112:115]
  ds_read_b64_tr_b16 v[72:73], v11 offset:16384
  ds_read_b64_tr_b16 v[74:75], v11 offset:16896
  v_mfma_f32_16x16x32_bf16 v[112:115], v[152:155], v[84:87], v[112:115]
  v_mul_f32 v61, v101, v21
  v_mfma_f32_16x16x32_bf16 v[116:119], v[156:159], v[84:87], v[116:119]
  ds_read_b64_tr_b16 v[76:77], v11 offset:20480
  ds_read_b64_tr_b16 v[78:79], v11 offset:20992
  v_mfma_f32_16x16x32_bf16 v[116:119], v[148:151], v[80:83], v[116:119]
  v_mul_f32 v62, v102, v22
  v_mul_f32 v63, v103, v23
  v_cvt_pk_bf16_f32 v98, v60, v61
  v_mfma_f32_16x16x32_bf16 v[124:127], v[148:151], v[88:91], v[124:127]
  ds_read_b64_tr_b16 v[80:81], v10 offset:24576
  ds_read_b64_tr_b16 v[82:83], v10 offset:25088
  v_mfma_f32_16x16x32_bf16 v[124:127], v[156:159], v[92:95], v[124:127]
  v_cvt_pk_bf16_f32 v99, v62, v63
  v_mul_f32 v56, v104, v16
  v_mfma_f32_16x16x32_bf16 v[120:123], v[152:155], v[92:95], v[120:123]
  ds_read_b64_tr_b16 v[84:85], v10 offset:28672
  ds_read_b64_tr_b16 v[86:87], v10 offset:29184
  v_mfma_f32_16x16x32_bf16 v[120:123], v[144:147], v[88:91], v[120:123]
  v_mul_f32 v57, v105, v17
  v_mul_f32 v58, v106, v18
  s_waitcnt lgkmcnt(4)
  v_mfma_f32_16x16x32_bf16 v[112:115], v[160:163], v[64:67], v[112:115]
  ds_read_b64_tr_b16 v[88:89], v11 offset:24576
  ds_read_b64_tr_b16 v[90:91], v11 offset:25088
  v_mfma_f32_16x16x32_bf16 v[112:115], v[168:171], v[68:71], v[112:115]
  v_mul_f32 v59, v107, v19
  v_cvt_pk_bf16_f32 v100, v56, v57
  v_mfma_f32_16x16x32_bf16 v[116:119], v[172:175], v[68:71], v[116:119]
  ds_read_b64_tr_b16 v[92:93], v11 offset:28672
  ds_read_b64_tr_b16 v[94:95], v11 offset:29184
  v_mfma_f32_16x16x32_bf16 v[116:119], v[164:167], v[64:67], v[116:119]
  v_cvt_pk_bf16_f32 v101, v58, v59
  v_mfma_f32_16x16x32_bf16 v[24:27], v[32:35], v[96:99], 0
  v_mfma_f32_16x16x32_bf16 v[124:127], v[164:167], v[72:75], v[124:127]
  ds_read_b64_tr_b16 v[64:65], v10 offset:32768
  ds_read_b64_tr_b16 v[66:67], v10 offset:33280
  v_mfma_f32_16x16x32_bf16 v[124:127], v[172:175], v[76:79], v[124:127]
  v_mul_f32 v60, v108, v20
  v_mfma_f32_16x16x32_bf16 v[120:123], v[168:171], v[76:79], v[120:123]
  ds_read_b64_tr_b16 v[68:69], v10 offset:36864
  ds_read_b64_tr_b16 v[70:71], v10 offset:37376
  v_mfma_f32_16x16x32_bf16 v[120:123], v[160:163], v[72:75], v[120:123]
  v_mul_f32 v61, v109, v21
  v_mul_f32 v62, v110, v22
  v_mul_f32 v63, v111, v23
  s_waitcnt lgkmcnt(4)
  v_mfma_f32_16x16x32_bf16 v[112:115], v[176:179], v[80:83], v[112:115]
  ds_read_b64_tr_b16 v[72:73], v11 offset:32768
  ds_read_b64_tr_b16 v[74:75], v11 offset:33280
  v_mfma_f32_16x16x32_bf16 v[112:115], v[184:187], v[84:87], v[112:115]
  v_cvt_pk_bf16_f32 v102, v60, v61
  v_mfma_f32_16x16x32_bf16 v[116:119], v[188:191], v[84:87], v[116:119]
  ds_read_b64_tr_b16 v[76:77], v11 offset:36864
  ds_read_b64_tr_b16 v[78:79], v11 offset:37376
  v_mfma_f32_16x16x32_bf16 v[116:119], v[180:183], v[80:83], v[116:119]
  v_cvt_pk_bf16_f32 v103, v62, v63
  v_mfma_f32_16x16x32_bf16 v[124:127], v[180:183], v[88:91], v[124:127]
  ds_read_b64_tr_b16 v[80:81], v10 offset:40960
  ds_read_b64_tr_b16 v[82:83], v10 offset:41472
  v_mfma_f32_16x16x32_bf16 v[124:127], v[188:191], v[92:95], v[124:127]
  v_xor_b32 v8, 0, v14
  v_xor_b32 v9, 32, v8
  v_mfma_f32_16x16x32_bf16 v[120:123], v[184:187], v[92:95], v[120:123]
  ds_read_b64_tr_b16 v[84:85], v10 offset:45056
  ds_read_b64_tr_b16 v[86:87], v10 offset:45568
  v_mfma_f32_16x16x32_bf16 v[120:123], v[176:179], v[88:91], v[120:123]
  v_mfma_f32_16x16x32_bf16 v[28:31], v[36:39], v[100:103], 0
  s_waitcnt lgkmcnt(4)
  v_mfma_f32_16x16x32_bf16 v[112:115], v[192:195], v[64:67], v[112:115]
  ds_read_b64_tr_b16 v[88:89], v11 offset:40960
  ds_read_b64_tr_b16 v[90:91], v11 offset:41472
  v_mfma_f32_16x16x32_bf16 v[112:115], v[200:203], v[68:71], v[112:115]
  v_mfma_f32_16x16x32_bf16 v[116:119], v[204:207], v[68:71], v[116:119]
  ds_read_b64_tr_b16 v[92:93], v11 offset:45056
  ds_read_b64_tr_b16 v[94:95], v11 offset:45568
  v_mfma_f32_16x16x32_bf16 v[116:119], v[196:199], v[64:67], v[116:119]
  v_mfma_f32_16x16x32_bf16 v[124:127], v[196:199], v[72:75], v[124:127]
  ds_read_b64_tr_b16 v[64:65], v10 offset:49152
  ds_read_b64_tr_b16 v[66:67], v10 offset:49664
  v_mfma_f32_16x16x32_bf16 v[124:127], v[204:207], v[76:79], v[124:127]
  v_mfma_f32_16x16x32_bf16 v[120:123], v[200:203], v[76:79], v[120:123]
  ds_read_b64_tr_b16 v[68:69], v10 offset:53248
  ds_read_b64_tr_b16 v[70:71], v10 offset:53760
  v_mfma_f32_16x16x32_bf16 v[120:123], v[192:195], v[72:75], v[120:123]
  s_waitcnt lgkmcnt(4)
  v_mfma_f32_16x16x32_bf16 v[112:115], v[208:211], v[80:83], v[112:115]
  ds_read_b64_tr_b16 v[72:73], v11 offset:49152
  ds_read_b64_tr_b16 v[74:75], v11 offset:49664
  v_mfma_f32_16x16x32_bf16 v[112:115], v[216:219], v[84:87], v[112:115]
  v_mfma_f32_16x16x32_bf16 v[116:119], v[220:223], v[84:87], v[116:119]
  ds_read_b64_tr_b16 v[76:77], v11 offset:53248
  ds_read_b64_tr_b16 v[78:79], v11 offset:53760
  v_mfma_f32_16x16x32_bf16 v[116:119], v[212:215], v[80:83], v[116:119]
  ds_read_b32 v6, v4 offset:1368
  v_mfma_f32_16x16x32_bf16 v[124:127], v[212:215], v[88:91], v[124:127]
  ds_read_b64_tr_b16 v[80:81], v10 offset:57344
  ds_read_b64_tr_b16 v[82:83], v10 offset:57856
  v_mfma_f32_16x16x32_bf16 v[124:127], v[220:223], v[92:95], v[124:127]
  v_mfma_f32_16x16x32_bf16 v[120:123], v[216:219], v[92:95], v[120:123]
  ds_read_b64_tr_b16 v[84:85], v10 offset:61440
  ds_read_b64_tr_b16 v[86:87], v10 offset:61952
  v_mfma_f32_16x16x32_bf16 v[120:123], v[208:211], v[88:91], v[120:123]
  s_waitcnt lgkmcnt(5)
  v_mfma_f32_16x16x32_bf16 v[112:115], v[224:227], v[64:67], v[112:115]
  ds_read_b64_tr_b16 v[88:89], v11 offset:57344
  ds_read_b64_tr_b16 v[90:91], v11 offset:57856
  v_mfma_f32_16x16x32_bf16 v[112:115], v[232:235], v[68:71], v[112:115]
  v_mfma_f32_16x16x32_bf16 v[116:119], v[236:239], v[68:71], v[116:119]
  ds_read_b64_tr_b16 v[92:93], v11 offset:61440
  ds_read_b64_tr_b16 v[94:95], v11 offset:61952
  v_mfma_f32_16x16x32_bf16 v[116:119], v[228:231], v[64:67], v[116:119]
  s_waitcnt lgkmcnt(8)
  v_cmp_ne_u32 vcc, 0, v6
  s_cbranch_vccnz L_lp_47
L_lr_48:
  v_mfma_f32_16x16x32_bf16 v[124:127], v[228:231], v[72:75], v[124:127]
  ds_read_b64_tr_b16 v[64:65], v8 offset:0
  ds_read_b64_tr_b16 v[66:67], v8 offset:512
  v_mfma_f32_16x16x32_bf16 v[124:127], v[236:239], v[76:79], v[124:127]
  s_lshl_b32 s64, s56, 8
  v_mfma_f32_16x16x32_bf16 v[120:123], v[232:235], v[76:79], v[120:123]
  ds_read_b64_tr_b16 v[68:69], v8 offset:4096
  ds_read_b64_tr_b16 v[70:71], v8 offset:4608
  v_mfma_f32_16x16x32_bf16 v[120:123], v[224:227], v[72:75], v[120:123]
  s_add_u32 s64, s64, 151168
  s_waitcnt lgkmcnt(4)
  v_mfma_f32_16x16x32_bf16 v[112:115], v[240:243], v[80:83], v[112:115]
  ds_read_b64_tr_b16 v[72:73], v9 offset:0
  ds_read_b64_tr_b16 v[74:75], v9 offset:512
  v_mfma_f32_16x16x32_bf16 v[112:115], v[248:251], v[84:87], v[112:115]
  v_lshl_add_u32 v56, v0, 2, s64
  v_mfma_f32_16x16x32_bf16 v[116:119], v[252:255], v[84:87], v[116:119]
  ds_read_b64_tr_b16 v[76:77], v9 offset:4096
  ds_read_b64_tr_b16 v[78:79], v9 offset:4608
  v_mfma_f32_16x16x32_bf16 v[116:119], v[244:247], v[80:83], v[116:119]
  ds_write_b32 v56, v15
  v_mfma_f32_16x16x32_bf16 v[124:127], v[244:247], v[88:91], v[124:127]
  ds_read_b64_tr_b16 v[80:81], v8 offset:8192
  ds_read_b64_tr_b16 v[82:83], v8 offset:8704
  v_mfma_f32_16x16x32_bf16 v[124:127], v[252:255], v[92:95], v[124:127]
  ds_write_b128 v5, v[24:27] offset:0
  v_mfma_f32_16x16x32_bf16 v[120:123], v[248:251], v[92:95], v[120:123]
  ds_read_b64_tr_b16 v[84:85], v8 offset:12288
  ds_read_b64_tr_b16 v[86:87], v8 offset:12800
  v_mfma_f32_16x16x32_bf16 v[120:123], v[240:243], v[88:91], v[120:123]
  ds_write_b128 v5, v[28:31] offset:1024
  s_waitcnt lgkmcnt(7)
  v_mfma_f32_16x16x32_bf16 v[96:99], v[64:67], v[128:131], 0
  ds_read_b64_tr_b16 v[88:89], v9 offset:8192
  ds_read_b64_tr_b16 v[90:91], v9 offset:8704
  v_mfma_f32_16x16x32_bf16 v[96:99], v[68:71], v[136:139], v[96:99]
  v_mfma_f32_16x16x32_bf16 v[104:107], v[68:71], v[140:143], 0
  ds_read_b64_tr_b16 v[92:93], v9 offset:12288
  ds_read_b64_tr_b16 v[94:95], v9 offset:12800
  v_mfma_f32_16x16x32_bf16 v[104:107], v[64:67], v[132:135], v[104:107]
  v_mul_f32 v56, v112, v16
  v_mul_f32 v57, v113, v17
  v_mul_f32 v58, v114, v18
  v_mul_f32 v59, v115, v19
  v_cvt_pk_bf16_f32 v112, v56, v57
  v_cvt_pk_bf16_f32 v113, v58, v59
  v_mul_f32 v60, v116, v20
  v_mul_f32 v61, v117, v21
  v_mfma_f32_16x16x32_bf16 v[108:111], v[72:75], v[132:135], 0
  ds_read_b64_tr_b16 v[64:65], v8 offset:16384
  ds_read_b64_tr_b16 v[66:67], v8 offset:16896
  v_mfma_f32_16x16x32_bf16 v[108:111], v[76:79], v[140:143], v[108:111]
  v_mul_f32 v62, v118, v22
  v_mul_f32 v63, v119, v23
  v_cvt_pk_bf16_f32 v114, v60, v61
  v_cvt_pk_bf16_f32 v115, v62, v63
  v_mul_f32 v56, v120, v16
  v_mul_f32 v57, v121, v17
  v_mul_f32 v58, v122, v18
  v_mul_f32 v59, v123, v19
  v_mfma_f32_16x16x32_bf16 v[100:103], v[76:79], v[136:139], 0
  ds_read_b64_tr_b16 v[68:69], v8 offset:20480
  ds_read_b64_tr_b16 v[70:71], v8 offset:20992
  v_mfma_f32_16x16x32_bf16 v[100:103], v[72:75], v[128:131], v[100:103]
  v_cvt_pk_bf16_f32 v116, v56, v57
  v_cvt_pk_bf16_f32 v117, v58, v59
  v_mfma_f32_16x16x32_bf16 v[32:35], v[40:43], v[112:115], 0
  v_mul_f32 v60, v124, v20
  v_mul_f32 v61, v125, v21
  v_mul_f32 v62, v126, v22
  s_waitcnt lgkmcnt(4)
  v_mfma_f32_16x16x32_bf16 v[96:99], v[80:83], v[144:147], v[96:99]
  ds_read_b64_tr_b16 v[72:73], v9 offset:16384
  ds_read_b64_tr_b16 v[74:75], v9 offset:16896
  v_mfma_f32_16x16x32_bf16 v[96:99], v[84:87], v[152:155], v[96:99]
  v_mul_f32 v63, v127, v23
  v_cvt_pk_bf16_f32 v118, v60, v61
  v_cvt_pk_bf16_f32 v119, v62, v63
  s_nop 1
  v_mfma_f32_16x16x32_bf16 v[36:39], v[44:47], v[116:119], 0
  v_mfma_f32_16x16x32_bf16 v[104:107], v[84:87], v[156:159], v[104:107]
  ds_read_b64_tr_b16 v[76:77], v9 offset:20480
  ds_read_b64_tr_b16 v[78:79], v9 offset:20992
  v_mfma_f32_16x16x32_bf16 v[104:107], v[80:83], v[148:151], v[104:107]
  s_lshl_b32 s64, s56, 10
  s_add_u32 s64, s64, 131072
  v_add_u32 v16, s64, v1
  ds_write_b128 v5, v[32:35] offset:2048
  v_mfma_f32_16x16x32_bf16 v[108:111], v[88:91], v[148:151], v[108:111]
  ds_read_b64_tr_b16 v[80:81], v8 offset:24576
  ds_read_b64_tr_b16 v[82:83], v8 offset:25088
  v_mfma_f32_16x16x32_bf16 v[108:111], v[92:95], v[156:159], v[108:111]
  v_lshlrev_b32 v17, 2, v0
  v_add_u32 v18, 151168, v17
  ds_write_b128 v5, v[36:39] offset:3072
  ds_write_b32 v2, v3 offset:52
  v_mfma_f32_16x16x32_bf16 v[100:103], v[92:95], v[152:155], v[100:103]
  ds_read_b64_tr_b16 v[84:85], v8 offset:28672
  ds_read_b64_tr_b16 v[86:87], v8 offset:29184
  v_mfma_f32_16x16x32_bf16 v[100:103], v[88:91], v[144:147], v[100:103]
  s_waitcnt lgkmcnt(7)
  v_mfma_f32_16x16x32_bf16 v[96:99], v[64:67], v[160:163], v[96:99]
  ds_read_b64_tr_b16 v[88:89], v9 offset:24576
  ds_read_b64_tr_b16 v[90:91], v9 offset:25088
  v_mfma_f32_16x16x32_bf16 v[96:99], v[68:71], v[168:171], v[96:99]
  v_mfma_f32_16x16x32_bf16 v[104:107], v[68:71], v[172:175], v[104:107]
  ds_read_b64_tr_b16 v[92:93], v9 offset:28672
  ds_read_b64_tr_b16 v[94:95], v9 offset:29184
  v_mfma_f32_16x16x32_bf16 v[104:107], v[64:67], v[164:167], v[104:107]
  ds_read_b32 v6, v4 offset:52
  v_mfma_f32_16x16x32_bf16 v[108:111], v[72:75], v[164:167], v[108:111]
  ds_read_b64_tr_b16 v[64:65], v8 offset:32768
  ds_read_b64_tr_b16 v[66:67], v8 offset:33280
  v_mfma_f32_16x16x32_bf16 v[108:111], v[76:79], v[172:175], v[108:111]
  v_mfma_f32_16x16x32_bf16 v[100:103], v[76:79], v[168:171], v[100:103]
  ds_read_b64_tr_b16 v[68:69], v8 offset:36864
  ds_read_b64_tr_b16 v[70:71], v8 offset:37376
  v_mfma_f32_16x16x32_bf16 v[100:103], v[72:75], v[160:163], v[100:103]
  s_waitcnt lgkmcnt(4)
  v_cmp_ne_u32 vcc, 0, v6
  s_cbranch_vccz L_lr_37
L_lp_36:
  s_add_u32 s86, s86, 1
  s_cmp_gt_u32 s86, 1048576
  s_cbranch_scc1 L_lr_37
  ds_read_b32 v6, v4 offset:52
  s_waitcnt lgkmcnt(0)
  v_cmp_ne_u32 vcc, 0, v6
  s_cbranch_vccnz L_lp_36
L_lr_37:
  ds_read_b128 v[112:115], v16 offset:0
  ds_read_b128 v[116:119], v16 offset:4096
  ds_read_b128 v[120:123], v16 offset:8192
  ds_read_b128 v[124:127], v16 offset:12288
  ds_read_b32 v56, v18 offset:0
  ds_read_b32 v57, v18 offset:256
  ds_read_b32 v58, v18 offset:512
  ds_read_b32 v59, v18 offset:768
  v_mfma_f32_16x16x32_bf16 v[96:99], v[80:83], v[176:179], v[96:99]
  ds_read_b64_tr_b16 v[72:73], v9 offset:32768
  ds_read_b64_tr_b16 v[74:75], v9 offset:33280
  v_mfma_f32_16x16x32_bf16 v[96:99], v[84:87], v[184:187], v[96:99]
  v_mfma_f32_16x16x32_bf16 v[104:107], v[84:87], v[188:191], v[104:107]
  ds_read_b64_tr_b16 v[76:77], v9 offset:36864
  ds_read_b64_tr_b16 v[78:79], v9 offset:37376
  v_mfma_f32_16x16x32_bf16 v[104:107], v[80:83], v[180:183], v[104:107]
  v_mfma_f32_16x16x32_bf16 v[108:111], v[88:91], v[180:183], v[108:111]
  ds_read_b64_tr_b16 v[80:81], v8 offset:40960
  ds_read_b64_tr_b16 v[82:83], v8 offset:41472
  v_mfma_f32_16x16x32_bf16 v[108:111], v[92:95], v[188:191], v[108:111]
  v_xor_b32 v10, 64, v14
  v_xor_b32 v11, 32, v10
  s_waitcnt lgkmcnt(12)
  v_add_f32 v112, v112, v116
  v_add_f32 v113, v113, v117
  v_add_f32 v114, v114, v118
  v_add_f32 v115, v115, v119
  s_waitcnt lgkmcnt(10)
  v_add_f32 v120, v120, v124
  v_add_f32 v121, v121, v125
  v_add_f32 v122, v122, v126
  v_mfma_f32_16x16x32_bf16 v[100:103], v[92:95], v[184:187], v[100:103]
  ds_read_b64_tr_b16 v[84:85], v8 offset:45056
  ds_read_b64_tr_b16 v[86:87], v8 offset:45568
  v_mfma_f32_16x16x32_bf16 v[100:103], v[88:91], v[176:179], v[100:103]
  v_add_f32 v123, v123, v127
  v_add_f32 v112, v112, v120
  v_add_f32 v113, v113, v121
  v_add_f32 v114, v114, v122
  v_add_f32 v115, v115, v123
  v_cvt_pk_bf16_f32 v116, v112, v113
  v_cvt_pk_bf16_f32 v117, v114, v115
  s_waitcnt lgkmcnt(10)
  v_add_f32 v56, v56, v57
  s_waitcnt lgkmcnt(8)
  v_add_f32 v58, v58, v59
  v_permlane32_swap_b32 v116, v118
  s_waitcnt lgkmcnt(4)
  v_mfma_f32_16x16x32_bf16 v[96:99], v[64:67], v[192:195], v[96:99]
  ds_read_b64_tr_b16 v[88:89], v9 offset:40960
  ds_read_b64_tr_b16 v[90:91], v9 offset:41472
  v_mfma_f32_16x16x32_bf16 v[96:99], v[68:71], v[200:203], v[96:99]
  v_permlane32_swap_b32 v117, v119
  v_add_f32 v56, v56, v58
  s_mov_b32 exec_hi, 0
  buffer_store_dwordx4 v[116:119], v1, s[12:15], s76 offen sc1
  s_mov_b32 exec_hi, -1
  s_cmp_lg_u32 s56, 0
  s_cbranch_scc1 L_skipz_38
  buffer_store_dword v56, v17, s[12:15], s77 offen sc1
L_skipz_38:
  v_mfma_f32_16x16x32_bf16 v[104:107], v[68:71], v[204:207], v[104:107]
  ds_read_b64_tr_b16 v[92:93], v9 offset:45056
  ds_read_b64_tr_b16 v[94:95], v9 offset:45568
  v_mfma_f32_16x16x32_bf16 v[104:107], v[64:67], v[196:199], v[104:107]
  v_and_b32 v61, 1, v0
  v_lshlrev_b32 v61, 4, v61
  v_mfma_f32_16x16x32_bf16 v[108:111], v[72:75], v[196:199], v[108:111]
  ds_read_b64_tr_b16 v[64:65], v8 offset:49152
  ds_read_b64_tr_b16 v[66:67], v8 offset:49664
  v_mfma_f32_16x16x32_bf16 v[108:111], v[76:79], v[204:207], v[108:111]
  v_mov_b32 v62, 0x3f80
  v_mfma_f32_16x16x32_bf16 v[100:103], v[76:79], v[200:203], v[100:103]
  ds_read_b64_tr_b16 v[68:69], v8 offset:53248
  ds_read_b64_tr_b16 v[70:71], v8 offset:53760
  v_mfma_f32_16x16x32_bf16 v[100:103], v[72:75], v[192:195], v[100:103]
  v_lshlrev_b32 v61, v61, v62
  s_waitcnt lgkmcnt(4)
  v_mfma_f32_16x16x32_bf16 v[96:99], v[80:83], v[208:211], v[96:99]
  ds_read_b64_tr_b16 v[72:73], v9 offset:49152
  ds_read_b64_tr_b16 v[74:75], v9 offset:49664
  v_mfma_f32_16x16x32_bf16 v[96:99], v[84:87], v[216:219], v[96:99]
  s_mov_b32 vcc_lo, 0x3
  s_mov_b32 vcc_hi, vcc_lo
  v_cndmask_b32 v32, 0, v61, vcc
  v_mfma_f32_16x16x32_bf16 v[104:107], v[84:87], v[220:223], v[104:107]
  ds_read_b64_tr_b16 v[76:77], v9 offset:53248
  ds_read_b64_tr_b16 v[78:79], v9 offset:53760
  v_mfma_f32_16x16x32_bf16 v[104:107], v[80:83], v[212:215], v[104:107]
  v_mfma_f32_16x16x32_bf16 v[108:111], v[88:91], v[212:215], v[108:111]
  ds_read_b64_tr_b16 v[80:81], v8 offset:57344
  ds_read_b64_tr_b16 v[82:83], v8 offset:57856
  v_mfma_f32_16x16x32_bf16 v[108:111], v[92:95], v[220:223], v[108:111]
  s_mov_b32 vcc_lo, 0xc
  s_mov_b32 vcc_hi, vcc_lo
  v_cndmask_b32 v33, 0, v61, vcc
  v_mfma_f32_16x16x32_bf16 v[100:103], v[92:95], v[216:219], v[100:103]
  ds_read_b64_tr_b16 v[84:85], v8 offset:61440
  ds_read_b64_tr_b16 v[86:87], v8 offset:61952
  v_mfma_f32_16x16x32_bf16 v[100:103], v[88:91], v[208:211], v[100:103]
  s_waitcnt lgkmcnt(4)
  v_mfma_f32_16x16x32_bf16 v[96:99], v[64:67], v[224:227], v[96:99]
  ds_read_b64_tr_b16 v[88:89], v9 offset:57344
  ds_read_b64_tr_b16 v[90:91], v9 offset:57856
  v_mfma_f32_16x16x32_bf16 v[96:99], v[68:71], v[232:235], v[96:99]
  s_mov_b32 vcc_lo, 0x30
  s_mov_b32 vcc_hi, vcc_lo
  v_cndmask_b32 v34, 0, v61, vcc
  v_mfma_f32_16x16x32_bf16 v[104:107], v[68:71], v[236:239], v[104:107]
  ds_read_b64_tr_b16 v[92:93], v9 offset:61440
  ds_read_b64_tr_b16 v[94:95], v9 offset:61952
  v_mfma_f32_16x16x32_bf16 v[104:107], v[64:67], v[228:231], v[104:107]
  v_mfma_f32_16x16x32_bf16 v[108:111], v[72:75], v[228:231], v[108:111]
  ds_read_b64_tr_b16 v[64:65], v10 offset:0
  ds_read_b64_tr_b16 v[66:67], v10 offset:512
  v_mfma_f32_16x16x32_bf16 v[108:111], v[76:79], v[236:239], v[108:111]
  s_mov_b32 vcc_lo, 0xc0
  s_mov_b32 vcc_hi, vcc_lo
  v_cndmask_b32 v35, 0, v61, vcc
  v_mfma_f32_16x16x32_bf16 v[100:103], v[76:79], v[232:235], v[100:103]
  ds_read_b64_tr_b16 v[68:69], v10 offset:4096
  ds_read_b64_tr_b16 v[70:71], v10 offset:4608
  v_mfma_f32_16x16x32_bf16 v[100:103], v[72:75], v[224:227], v[100:103]
  v_lshlrev_b32 v37, 3, v0
  s_waitcnt lgkmcnt(4)
  v_mfma_f32_16x16x32_bf16 v[96:99], v[80:83], v[240:243], v[96:99]
  ds_read_b64_tr_b16 v[72:73], v11 offset:0
  ds_read_b64_tr_b16 v[74:75], v11 offset:512
  v_mfma_f32_16x16x32_bf16 v[96:99], v[84:87], v[248:251], v[96:99]
  v_mfma_f32_16x16x32_bf16 v[104:107], v[84:87], v[252:255], v[104:107]
  ds_read_b64_tr_b16 v[76:77], v11 offset:4096
  ds_read_b64_tr_b16 v[78:79], v11 offset:4608
  v_mfma_f32_16x16x32_bf16 v[104:107], v[80:83], v[244:247], v[104:107]
  v_add_u32 v37, 152192, v37
  s_lshl_b32 s64, s56, 9
  v_mfma_f32_16x16x32_bf16 v[108:111], v[88:91], v[244:247], v[108:111]
  ds_read_b64_tr_b16 v[80:81], v10 offset:8192
  ds_read_b64_tr_b16 v[82:83], v10 offset:8704
  v_mfma_f32_16x16x32_bf16 v[108:111], v[92:95], v[252:255], v[108:111]
  v_add_u32 v36, s64, v37
  v_add_u32 v39, 154240, v1
  v_mfma_f32_16x16x32_bf16 v[100:103], v[92:95], v[248:251], v[100:103]
  ds_read_b64_tr_b16 v[84:85], v10 offset:12288
  ds_read_b64_tr_b16 v[86:87], v10 offset:12800
  v_mfma_f32_16x16x32_bf16 v[100:103], v[88:91], v[240:243], v[100:103]
  v_and_b32 v38, 48, v0
  s_waitcnt lgkmcnt(4)
  v_mfma_f32_16x16x32_bf16 v[112:115], v[64:67], v[128:131], 0
  ds_read_b64_tr_b16 v[88:89], v11 offset:8192
  ds_read_b64_tr_b16 v[90:91], v11 offset:8704
  v_mfma_f32_16x16x32_bf16 v[112:115], v[68:71], v[136:139], v[112:115]
  v_add_u32 v38, 154240, v38
  v_mfma_f32_16x16x32_bf16 v[120:123], v[68:71], v[140:143], 0
  ds_read_b64_tr_b16 v[92:93], v11 offset:12288
  ds_read_b64_tr_b16 v[94:95], v11 offset:12800
  v_mfma_f32_16x16x32_bf16 v[120:123], v[64:67], v[132:135], v[120:123]
  v_mul_f32 v56, v96, v12
  v_mul_f32 v57, v97, v12
  v_mul_f32 v58, v98, v12
  v_mfma_f32_16x16x32_bf16 v[124:127], v[72:75], v[132:135], 0
  ds_read_b64_tr_b16 v[64:65], v10 offset:16384
  ds_read_b64_tr_b16 v[66:67], v10 offset:16896
  v_mfma_f32_16x16x32_bf16 v[124:127], v[76:79], v[140:143], v[124:127]
  v_mul_f32 v59, v99, v12
  v_exp_f32 v60, v56 clamp
  v_mfma_f32_16x16x32_bf16 v[116:119], v[76:79], v[136:139], 0
  ds_read_b64_tr_b16 v[68:69], v10 offset:20480
  ds_read_b64_tr_b16 v[70:71], v10 offset:20992
  v_mfma_f32_16x16x32_bf16 v[116:119], v[72:75], v[128:131], v[116:119]
  v_exp_f32 v61, v57 clamp
  v_exp_f32 v62, v58 clamp
  s_waitcnt lgkmcnt(4)
  v_mfma_f32_16x16x32_bf16 v[112:115], v[80:83], v[144:147], v[112:115]
  ds_read_b64_tr_b16 v[72:73], v11 offset:16384
  ds_read_b64_tr_b16 v[74:75], v11 offset:16896
  v_mfma_f32_16x16x32_bf16 v[112:115], v[84:87], v[152:155], v[112:115]
  v_exp_f32 v63, v59 clamp
  v_mfma_f32_16x16x32_bf16 v[120:123], v[84:87], v[156:159], v[120:123]
  ds_read_b64_tr_b16 v[76:77], v11 offset:20480
  ds_read_b64_tr_b16 v[78:79], v11 offset:20992
  v_mfma_f32_16x16x32_bf16 v[120:123], v[80:83], v[148:151], v[120:123]
  v_add_f32 v60, s88, v60
  v_add_f32 v61, s88, v61
  v_add_f32 v62, s88, v62
  v_add_f32 v63, s88, v63
  v_mfma_f32_16x16x32_bf16 v[124:127], v[88:91], v[148:151], v[124:127]
  ds_read_b64_tr_b16 v[80:81], v10 offset:24576
  ds_read_b64_tr_b16 v[82:83], v10 offset:25088
  v_mfma_f32_16x16x32_bf16 v[124:127], v[92:95], v[156:159], v[124:127]
  s_mov_b32 s3, 0x1
  s_waitcnt vmcnt(0)
  s_atomic_add s3, s[100:101], 0
  v_fma_f32 v56, v56, s87, v60
  v_mfma_f32_16x16x32_bf16 v[116:119], v[92:95], v[152:155], v[116:119]
  ds_read_b64_tr_b16 v[84:85], v10 offset:28672
  ds_read_b64_tr_b16 v[86:87], v10 offset:29184
  v_mfma_f32_16x16x32_bf16 v[116:119], v[88:91], v[144:147], v[116:119]
  v_fma_f32 v57, v57, s87, v61
  v_fma_f32 v58, v58, s87, v62
  v_fma_f32 v59, v59, s87, v63
  s_waitcnt lgkmcnt(4)
  v_mfma_f32_16x16x32_bf16 v[112:115], v[64:67], v[160:163], v[112:115]
  ds_read_b64_tr_b16 v[88:89], v11 offset:24576
  ds_read_b64_tr_b16 v[90:91], v11 offset:25088
  v_mfma_f32_16x16x32_bf16 v[112:115], v[68:71], v[168:171], v[112:115]
  v_max_f32 v56, v56, v60
  v_max_f32 v57, v57, v61
  v_max_f32 v58, v58, v62
  v_mfma_f32_16x16x32_bf16 v[120:123], v[68:71], v[172:175], v[120:123]
  ds_read_b64_tr_b16 v[92:93], v11 offset:28672
  ds_read_b64_tr_b16 v[94:95], v11 offset:29184
  v_mfma_f32_16x16x32_bf16 v[120:123], v[64:67], v[164:167], v[120:123]
  v_max_f32 v59, v59, v63
  v_cvt_pk_bf16_f32 v16, v56, v57
  v_cvt_pk_bf16_f32 v17, v58, v59
  v_mfma_f32_16x16x32_bf16 v[124:127], v[72:75], v[164:167], v[124:127]
  ds_read_b64_tr_b16 v[64:65], v10 offset:32768
  ds_read_b64_tr_b16 v[66:67], v10 offset:33280
  v_mfma_f32_16x16x32_bf16 v[124:127], v[76:79], v[172:175], v[124:127]
  v_mul_f32 v56, v100, v12
  v_mul_f32 v57, v101, v12
  v_mul_f32 v58, v102, v12
  v_mfma_f32_16x16x32_bf16 v[116:119], v[76:79], v[168:171], v[116:119]
  ds_read_b64_tr_b16 v[68:69], v10 offset:36864
  ds_read_b64_tr_b16 v[70:71], v10 offset:37376
  v_mfma_f32_16x16x32_bf16 v[116:119], v[72:75], v[160:163], v[116:119]
  v_mul_f32 v59, v103, v12
  v_exp_f32 v60, v56 clamp
  s_waitcnt lgkmcnt(4)
  v_mfma_f32_16x16x32_bf16 v[112:115], v[80:83], v[176:179], v[112:115]
  ds_read_b64_tr_b16 v[72:73], v11 offset:32768
  ds_read_b64_tr_b16 v[74:75], v11 offset:33280
  v_mfma_f32_16x16x32_bf16 v[112:115], v[84:87], v[184:187], v[112:115]
  v_exp_f32 v61, v57 clamp
  v_mfma_f32_16x16x32_bf16 v[120:123], v[84:87], v[188:191], v[120:123]
  ds_read_b64_tr_b16 v[76:77], v11 offset:36864
  ds_read_b64_tr_b16 v[78:79], v11 offset:37376
  v_mfma_f32_16x16x32_bf16 v[120:123], v[80:83], v[180:183], v[120:123]
  v_exp_f32 v62, v58 clamp
  v_exp_f32 v63, v59 clamp
  v_mfma_f32_16x16x32_bf16 v[124:127], v[88:91], v[180:183], v[124:127]
  ds_read_b64_tr_b16 v[80:81], v10 offset:40960
  ds_read_b64_tr_b16 v[82:83], v10 offset:41472
  v_mfma_f32_16x16x32_bf16 v[124:127], v[92:95], v[188:191], v[124:127]
  v_add_f32 v60, s88, v60
  v_add_f32 v61, s88, v61
  v_add_f32 v62, s88, v62
  v_add_f32 v63, s88, v63
  v_mfma_f32_16x16x32_bf16 v[116:119], v[92:95], v[184:187], v[116:119]
  ds_read_b64_tr_b16 v[84:85], v10 offset:45056
  ds_read_b64_tr_b16 v[86:87], v10 offset:45568
  v_mfma_f32_16x16x32_bf16 v[116:119], v[88:91], v[176:179], v[116:119]
  v_fma_f32 v56, v56, s87, v60
  v_fma_f32 v57, v57, s87, v61
  v_fma_f32 v58, v58, s87, v62
  s_waitcnt lgkmcnt(4)
  v_mfma_f32_16x16x32_bf16 v[112:115], v[64:67], v[192:195], v[112:115]
  ds_read_b64_tr_b16 v[88:89], v11 offset:40960
  ds_read_b64_tr_b16 v[90:91], v11 offset:41472
  v_mfma_f32_16x16x32_bf16 v[112:115], v[68:71], v[200:203], v[112:115]
  v_fma_f32 v59, v59, s87, v63
  v_max_f32 v56, v56, v60
  v_mfma_f32_16x16x32_bf16 v[120:123], v[68:71], v[204:207], v[120:123]
  ds_read_b64_tr_b16 v[92:93], v11 offset:45056
  ds_read_b64_tr_b16 v[94:95], v11 offset:45568
  v_mfma_f32_16x16x32_bf16 v[120:123], v[64:67], v[196:199], v[120:123]
  v_max_f32 v57, v57, v61
  v_max_f32 v58, v58, v62
  v_max_f32 v59, v59, v63
  v_mfma_f32_16x16x32_bf16 v[124:127], v[72:75], v[196:199], v[124:127]
  ds_read_b64_tr_b16 v[64:65], v10 offset:49152
  ds_read_b64_tr_b16 v[66:67], v10 offset:49664
  v_mfma_f32_16x16x32_bf16 v[124:127], v[76:79], v[204:207], v[124:127]
  v_cvt_pk_bf16_f32 v18, v56, v57
  v_cvt_pk_bf16_f32 v19, v58, v59
  v_mul_f32 v56, v104, v13
  v_mul_f32 v57, v105, v13
  v_mfma_f32_16x16x32_bf16 v[116:119], v[76:79], v[200:203], v[116:119]
  ds_read_b64_tr_b16 v[68:69], v10 offset:53248
  ds_read_b64_tr_b16 v[70:71], v10 offset:53760
  v_mfma_f32_16x16x32_bf16 v[116:119], v[72:75], v[192:195], v[116:119]
  v_mul_f32 v58, v106, v13
  v_mul_f32 v59, v107, v13
  v_exp_f32 v60, v56 clamp
  s_waitcnt lgkmcnt(4)
  v_mfma_f32_16x16x32_bf16 v[112:115], v[80:83], v[208:211], v[112:115]
  ds_read_b64_tr_b16 v[72:73], v11 offset:49152
  ds_read_b64_tr_b16 v[74:75], v11 offset:49664
  v_mfma_f32_16x16x32_bf16 v[112:115], v[84:87], v[216:219], v[112:115]
  v_exp_f32 v61, v57 clamp
  v_mfma_f32_16x16x32_bf16 v[120:123], v[84:87], v[220:223], v[120:123]
  ds_read_b64_tr_b16 v[76:77], v11 offset:53248
  ds_read_b64_tr_b16 v[78:79], v11 offset:53760
  v_mfma_f32_16x16x32_bf16 v[120:123], v[80:83], v[212:215], v[120:123]
  v_exp_f32 v62, v58 clamp
  v_mfma_f32_16x16x32_bf16 v[124:127], v[88:91], v[212:215], v[124:127]
  ds_read_b64_tr_b16 v[80:81], v10 offset:57344
  ds_read_b64_tr_b16 v[82:83], v10 offset:57856
  v_mfma_f32_16x16x32_bf16 v[124:127], v[92:95], v[220:223], v[124:127]
  v_exp_f32 v63, v59 clamp
  v_add_f32 v60, s88, v60
  v_add_f32 v61, s88, v61
  v_mfma_f32_16x16x32_bf16 v[116:119], v[92:95], v[216:219], v[116:119]
  ds_read_b64_tr_b16 v[84:85], v10 offset:61440
  ds_read_b64_tr_b16 v[86:87], v10 offset:61952
  v_mfma_f32_16x16x32_bf16 v[116:119], v[88:91], v[208:211], v[116:119]
  v_add_f32 v62, s88, v62
  v_add_f32 v63, s88, v63
  v_fma_f32 v56, v56, s87, v60
  s_waitcnt lgkmcnt(4)
  v_mfma_f32_16x16x32_bf16 v[112:115], v[64:67], v[224:227], v[112:115]
  ds_read_b64_tr_b16 v[88:89], v11 offset:57344
  ds_read_b64_tr_b16 v[90:91], v11 offset:57856
  v_mfma_f32_16x16x32_bf16 v[112:115], v[68:71], v[232:235], v[112:115]
  v_fma_f32 v57, v57, s87, v61
  v_fma_f32 v58, v58, s87, v62
  v_fma_f32 v59, v59, s87, v63
  v_mfma_f32_16x16x32_bf16 v[120:123], v[68:71], v[236:239], v[120:123]
  ds_read_b64_tr_b16 v[92:93], v11 offset:61440
  ds_read_b64_tr_b16 v[94:95], v11 offset:61952
  v_mfma_f32_16x16x32_bf16 v[120:123], v[64:67], v[228:231], v[120:123]
  v_max_f32 v56, v56, v60
  v_max_f32 v57, v57, v61
  v_max_f32 v58, v58, v62
  v_mfma_f32_16x16x32_bf16 v[124:127], v[72:75], v[228:231], v[124:127]
  v_mfma_f32_16x16x32_bf16 v[124:127], v[76:79], v[236:239], v[124:127]
  v_max_f32 v59, v59, v63
  v_cvt_pk_bf16_f32 v20, v56, v57
  v_cvt_pk_bf16_f32 v21, v58, v59
  v_mul_f32 v56, v108, v13
  v_mul_f32 v57, v109, v13
  v_mfma_f32_16x16x32_bf16 v[116:119], v[76:79], v[232:235], v[116:119]
  v_mfma_f32_16x16x32_bf16 v[116:119], v[72:75], v[224:227], v[116:119]
  v_mul_f32 v58, v110, v13
  v_mul_f32 v59, v111, v13
  v_exp_f32 v60, v56 clamp
  v_exp_f32 v61, v57 clamp
  s_waitcnt lgkmcnt(0)
  v_mfma_f32_16x16x32_bf16 v[112:115], v[80:83], v[240:243], v[112:115]
  v_mfma_f32_16x16x32_bf16 v[112:115], v[84:87], v[248:251], v[112:115]
  v_exp_f32 v62, v58 clamp
  v_exp_f32 v63, v59 clamp
  v_mfma_f32_16x16x32_bf16 v[120:123], v[84:87], v[252:255], v[120:123]
  v_mfma_f32_16x16x32_bf16 v[120:123], v[80:83], v[244:247], v[120:123]
  s_mov_b32 s89, 0
  s_atomic_add s89, s[100:101], 0 glc
  v_add_f32 v60, s88, v60
  v_add_f32 v61, s88, v61
  v_add_f32 v62, s88, v62
  v_mfma_f32_16x16x32_bf16 v[124:127], v[88:91], v[244:247], v[124:127]
  v_mfma_f32_16x16x32_bf16 v[124:127], v[92:95], v[252:255], v[124:127]
  v_add_f32 v63, s88, v63
  v_fma_f32 v56, v56, s87, v60
  v_fma_f32 v57, v57, s87, v61
  v_fma_f32 v58, v58, s87, v62
  v_fma_f32 v59, v59, s87, v63
  v_max_f32 v56, v56, v60
  v_mfma_f32_16x16x32_bf16 v[116:119], v[92:95], v[248:251], v[116:119]
  v_mfma_f32_16x16x32_bf16 v[116:119], v[88:91], v[240:243], v[116:119]
  v_max_f32 v57, v57, v61
  v_max_f32 v58, v58, v62
  v_max_f32 v59, v59, v63
  v_cvt_pk_bf16_f32 v22, v56, v57
  v_cvt_pk_bf16_f32 v23, v58, v59
  v_mul_f32 v56, v112, v12
  v_mul_f32 v57, v113, v12
  v_mul_f32 v58, v114, v12
  v_mul_f32 v59, v115, v12
  v_exp_f32 v60, v56 clamp
  v_exp_f32 v61, v57 clamp
  v_exp_f32 v62, v58 clamp
  v_exp_f32 v63, v59 clamp
  v_add_f32 v60, s88, v60
  v_add_f32 v61, s88, v61
  v_add_f32 v62, s88, v62
  v_add_f32 v63, s88, v63
  v_fma_f32 v56, v56, s87, v60
  v_fma_f32 v57, v57, s87, v61
  v_fma_f32 v58, v58, s87, v62
  v_fma_f32 v59, v59, s87, v63
  v_max_f32 v56, v56, v60
  v_max_f32 v57, v57, v61
  v_max_f32 v58, v58, v62
  v_max_f32 v59, v59, v63
  v_cvt_pk_bf16_f32 v24, v56, v57
  v_cvt_pk_bf16_f32 v25, v58, v59
  v_mul_f32 v56, v116, v12
  v_mul_f32 v57, v117, v12
  v_mul_f32 v58, v118, v12
  v_mul_f32 v59, v119, v12
  v_exp_f32 v60, v56 clamp
  v_exp_f32 v61, v57 clamp
  v_exp_f32 v62, v58 clamp
  v_exp_f32 v63, v59 clamp
  v_add_f32 v60, s88, v60
  v_add_f32 v61, s88, v61
  v_add_f32 v62, s88, v62
  v_add_f32 v63, s88, v63
  v_fma_f32 v56, v56, s87, v60
  v_fma_f32 v57, v57, s87, v61
  v_fma_f32 v58, v58, s87, v62
  v_fma_f32 v59, v59, s87, v63
  v_max_f32 v56, v56, v60
  v_max_f32 v57, v57, v61
  v_max_f32 v58, v58, v62
  v_max_f32 v59, v59, v63
  v_cvt_pk_bf16_f32 v26, v56, v57
  v_cvt_pk_bf16_f32 v27, v58, v59
  s_waitcnt lgkmcnt(0)
  s_cmp_lt_u32 s89, 16
  s_cbranch_scc0 L_sr_50
L_sp_49:
  s_add_u32 s86, s86, 1
  s_cmp_gt_u32 s86, 1048576
  s_cbranch_scc1 L_sr_50
  s_mov_b32 s89, 0
  s_atomic_add s89, s[100:101], 0 glc
  s_waitcnt lgkmcnt(0)
  s_cmp_lt_u32 s89, 16
  s_cbranch_scc1 L_sp_49
L_sr_50:
  s_cmp_lg_u32 s56, 0
  s_cbranch_scc1 L_skipz_51
  buffer_load_dwordx4 v[192:195], v1, s[12:15], s74 offen offset:0 sc1
  buffer_load_dwordx4 v[196:199], v1, s[12:15], s74 offen offset:1024 sc1
  buffer_load_dwordx4 v[200:203], v1, s[12:15], s74 offen offset:2048 sc1
  buffer_load_dwordx4 v[204:207], v1, s[12:15], s74 offen offset:3072 sc1
L_skipz_51:
  buffer_load_dwordx4 v[128:131], v1, s[12:15], s73 offen offset:0 sc1
  buffer_load_dwordx4 v[132:135], v1, s[12:15], s73 offen offset:1024 sc1
  buffer_load_dwordx4 v[136:139], v1, s[12:15], s73 offen offset:2048 sc1
  buffer_load_dwordx4 v[140:143], v1, s[12:15], s73 offen offset:3072 sc1
  s_add_u32 s73, s73, 4096
  buffer_load_dwordx4 v[144:147], v1, s[12:15], s73 offen offset:0 sc1
  buffer_load_dwordx4 v[148:151], v1, s[12:15], s73 offen offset:1024 sc1
  buffer_load_dwordx4 v[152:155], v1, s[12:15], s73 offen offset:2048 sc1
  buffer_load_dwordx4 v[156:159], v1, s[12:15], s73 offen offset:3072 sc1
  v_mul_f32 v56, v120, v13
  v_mul_f32 v57, v121, v13
  v_mul_f32 v58, v122, v13
  v_mul_f32 v59, v123, v13
  v_exp_f32 v60, v56 clamp
  v_exp_f32 v61, v57 clamp
  v_exp_f32 v62, v58 clamp
  v_exp_f32 v63, v59 clamp
  v_add_f32 v60, s88, v60
  v_add_f32 v61, s88, v61
  v_add_f32 v62, s88, v62
  v_add_f32 v63, s88, v63
  v_fma_f32 v56, v56, s87, v60
  v_fma_f32 v57, v57, s87, v61
  v_fma_f32 v58, v58, s87, v62
  v_fma_f32 v59, v59, s87, v63
  v_max_f32 v56, v56, v60
  v_max_f32 v57, v57, v61
  v_max_f32 v58, v58, v62
  v_max_f32 v59, v59, v63
  v_cvt_pk_bf16_f32 v28, v56, v57
  v_cvt_pk_bf16_f32 v29, v58, v59
  v_mul_f32 v56, v124, v13
  v_mul_f32 v57, v125, v13
  v_mul_f32 v58, v126, v13
  v_mul_f32 v59, v127, v13
  v_exp_f32 v60, v56 clamp
  v_exp_f32 v61, v57 clamp
  v_exp_f32 v62, v58 clamp
  v_exp_f32 v63, v59 clamp
  v_add_f32 v60, s88, v60
  v_add_f32 v61, s88, v61
  v_add_f32 v62, s88, v62
  v_add_f32 v63, s88, v63
  v_fma_f32 v56, v56, s87, v60
  v_fma_f32 v57, v57, s87, v61
  v_fma_f32 v58, v58, s87, v62
  v_fma_f32 v59, v59, s87, v63
  v_max_f32 v56, v56, v60
  v_max_f32 v57, v57, v61
  v_max_f32 v58, v58, v62
  v_max_f32 v59, v59, v63
  v_cvt_pk_bf16_f32 v30, v56, v57
  v_cvt_pk_bf16_f32 v31, v58, v59
  s_waitcnt vmcnt(7)
  s_cmp_lg_u32 s56, 0
  s_cbranch_scc1 L_skipz_52
  v_add_f32 v192, v192, v196
  v_add_f32 v193, v193, v197
  v_add_f32 v194, v194, v198
  v_add_f32 v195, v195, v199
  v_add_f32 v192, v192, v200
  v_add_f32 v193, v193, v201
  v_add_f32 v194, v194, v202
  v_add_f32 v195, v195, v203
  v_add_f32 v192, v192, v204
  v_add_f32 v193, v193, v205
  v_add_f32 v194, v194, v206
  v_add_f32 v195, v195, v207
  v_mov_b32 v196, v192
  v_mov_b32 v197, v193
  v_mov_b32 v198, v194
  v_mov_b32 v199, v195
  v_permlane32_swap_b32 v192, v196
  v_permlane32_swap_b32 v193, v197
  v_permlane32_swap_b32 v194, v198
  v_permlane32_swap_b32 v195, v199
  v_add_f32 v192, v192, v196
  v_add_f32 v193, v193, v197
  v_add_f32 v194, v194, v198
  v_add_f32 v195, v195, v199
  v_mov_b32 v196, v192
  v_mov_b32 v197, v193
  v_mov_b32 v198, v194
  v_mov_b32 v199, v195
  v_permlane16_swap_b32 v192, v196
  v_permlane16_swap_b32 v193, v197
  v_permlane16_swap_b32 v194, v198
  v_permlane16_swap_b32 v195, v199
  v_add_f32 v192, v192, v196
  v_add_f32 v193, v193, v197
  v_add_f32 v194, v194, v198
  v_add_f32 v195, v195, v199
  s_mov_b64 exec, 0xffff
  ds_write_b128 v39, v[192:195]
  s_mov_b64 exec, -1
L_skipz_52:
  v_mfma_f32_32x32x16_bf16 v[96:111], v[32:35], v[128:131], 0
  s_waitcnt vmcnt(6)
  v_mfma_f32_32x32x16_bf16 v[96:111], v[32:35], v[132:135], v[96:111]
  s_waitcnt vmcnt(5)
  v_mfma_f32_32x32x16_bf16 v[96:111], v[32:35], v[136:139], v[96:111]
  s_waitcnt vmcnt(4)
  v_mfma_f32_32x32x16_bf16 v[96:111], v[32:35], v[140:143], v[96:111]
  s_waitcnt vmcnt(3)
  v_mfma_f32_32x32x16_bf16 v[96:111], v[32:35], v[144:147], v[96:111]
  s_waitcnt vmcnt(2)
  v_mfma_f32_32x32x16_bf16 v[96:111], v[32:35], v[148:151], v[96:111]
  s_waitcnt vmcnt(1)
  v_mfma_f32_32x32x16_bf16 v[96:111], v[32:35], v[152:155], v[96:111]
  s_waitcnt vmcnt(0)
  v_mfma_f32_32x32x16_bf16 v[96:111], v[32:35], v[156:159], v[96:111]
  s_nop 11
  v_cvt_pk_bf16_f32 v136, v96, v97
  v_cvt_pk_bf16_f32 v137, v98, v99
  ds_write_b64 v36, v[136:137]
  ds_write_b32 v2, v3 offset:44
  ds_read_b32 v6, v4 offset:44
  s_waitcnt lgkmcnt(0)
  v_cmp_ne_u32 vcc, 0, v6
  s_cbranch_vccz L_lr_54
L_lp_53:
  s_add_u32 s86, s86, 1
  s_cmp_gt_u32 s86, 1048576
  s_cbranch_scc1 L_lr_54
  ds_read_b32 v6, v4 offset:44
  s_waitcnt lgkmcnt(0)
  v_cmp_ne_u32 vcc, 0, v6
  s_cbranch_vccnz L_lp_53
L_lr_54:
  ds_read_b128 v[152:155], v38 offset:0
  ds_read_b64 v[144:145], v37 offset:0
  ds_read_b128 v[156:159], v38 offset:64
  ds_read_b64 v[146:147], v37 offset:512
  ds_read_b128 v[160:163], v38 offset:128
  ds_read_b64 v[148:149], v37 offset:1024
  ds_read_b128 v[164:167], v38 offset:192
  ds_read_b64 v[150:151], v37 offset:1536
  s_waitcnt lgkmcnt(7)
  v_cvt_pk_bf16_f32 v168, v152, v153
  v_cvt_pk_bf16_f32 v169, v154, v155
  s_waitcnt lgkmcnt(5)
  v_cvt_pk_bf16_f32 v170, v156, v157
  v_cvt_pk_bf16_f32 v171, v158, v159
  v_mfma_f32_16x16x16_bf16 v[192:195], v[144:145], v[16:17], 0
  v_mfma_f32_16x16x16_bf16 v[196:199], v[168:169], v[16:17], 0
  s_waitcnt lgkmcnt(4)
  v_mfma_f32_16x16x16_bf16 v[208:211], v[146:147], v[18:19], 0
  v_mfma_f32_16x16x16_bf16 v[212:215], v[170:171], v[18:19], 0
  v_mfma_f32_16x16x16_bf16 v[200:203], v[144:145], v[20:21], 0
  v_mfma_f32_16x16x16_bf16 v[204:207], v[168:169], v[20:21], 0
  v_mfma_f32_16x16x16_bf16 v[216:219], v[146:147], v[22:23], 0
  v_mfma_f32_16x16x16_bf16 v[220:223], v[170:171], v[22:23], 0
  s_waitcnt lgkmcnt(3)
  v_cvt_pk_bf16_f32 v172, v160, v161
  v_cvt_pk_bf16_f32 v173, v162, v163
  s_waitcnt lgkmcnt(1)
  v_cvt_pk_bf16_f32 v174, v164, v165
  v_cvt_pk_bf16_f32 v175, v166, v167
  v_mfma_f32_16x16x16_bf16 v[224:227], v[148:149], v[24:25], 0
  v_add_f32 v196, s88, v196
  v_add_f32 v212, s88, v212
  v_mfma_f32_16x16x16_bf16 v[228:231], v[172:173], v[24:25], 0
  v_rcp_f32 v196, v196
  s_waitcnt lgkmcnt(0)
  v_mfma_f32_16x16x16_bf16 v[240:243], v[150:151], v[26:27], 0
  v_rcp_f32 v212, v212
  v_mul_f32 v192, v192, v196
  v_mfma_f32_16x16x16_bf16 v[244:247], v[174:175], v[26:27], 0
  v_mul_f32 v193, v193, v196
  v_mul_f32 v194, v194, v196
  v_mul_f32 v195, v195, v196
  v_mfma_f32_16x16x16_bf16 v[232:235], v[148:149], v[28:29], 0
  v_cvt_pk_bf16_f32 v64, v192, v193
  v_cvt_pk_bf16_f32 v65, v194, v195
  v_mfma_f32_16x16x16_bf16 v[236:239], v[172:173], v[28:29], 0
  v_mul_f32 v208, v208, v212
  v_mul_f32 v209, v209, v212
  v_mfma_f32_16x16x16_bf16 v[248:251], v[150:151], v[30:31], 0
  v_mul_f32 v210, v210, v212
  v_mul_f32 v211, v211, v212
  v_cvt_pk_bf16_f32 v66, v208, v209
  v_mfma_f32_16x16x16_bf16 v[252:255], v[174:175], v[30:31], 0
  v_cvt_pk_bf16_f32 v67, v210, v211
  buffer_store_dwordx4 v[64:67], v1, s[12:15], s70 offen offset:0 sc1
  v_add_f32 v204, s88, v204
  v_add_f32 v220, s88, v220
  v_rcp_f32 v204, v204
  v_rcp_f32 v220, v220
  v_mul_f32 v200, v200, v204
  v_mul_f32 v201, v201, v204
  v_mul_f32 v202, v202, v204
  v_mul_f32 v203, v203, v204
  v_cvt_pk_bf16_f32 v68, v200, v201
  v_cvt_pk_bf16_f32 v69, v202, v203
  v_mul_f32 v216, v216, v220
  v_mul_f32 v217, v217, v220
  v_mul_f32 v218, v218, v220
  v_mul_f32 v219, v219, v220
  v_cvt_pk_bf16_f32 v70, v216, v217
  v_cvt_pk_bf16_f32 v71, v218, v219
  buffer_store_dwordx4 v[68:71], v1, s[12:15], s78 offen offset:0 sc1
  v_add_f32 v228, s88, v228
  v_add_f32 v244, s88, v244
  v_rcp_f32 v228, v228
  v_rcp_f32 v244, v244
  v_mul_f32 v224, v224, v228
  v_mul_f32 v225, v225, v228
  v_mul_f32 v226, v226, v228
  v_mul_f32 v227, v227, v228
  v_cvt_pk_bf16_f32 v72, v224, v225
  v_cvt_pk_bf16_f32 v73, v226, v227
  v_mul_f32 v240, v240, v244
  v_mul_f32 v241, v241, v244
  v_mul_f32 v242, v242, v244
  v_mul_f32 v243, v243, v244
  v_cvt_pk_bf16_f32 v74, v240, v241
  v_cvt_pk_bf16_f32 v75, v242, v243
  buffer_store_dwordx4 v[72:75], v1, s[12:15], s70 offen offset:1024 sc1
  v_add_f32 v236, s88, v236
  v_add_f32 v252, s88, v252
  v_rcp_f32 v236, v236
  v_rcp_f32 v252, v252
  v_mul_f32 v232, v232, v236
  v_mul_f32 v233, v233, v236
  v_mul_f32 v234, v234, v236
  v_mul_f32 v235, v235, v236
  v_cvt_pk_bf16_f32 v76, v232, v233
  v_cvt_pk_bf16_f32 v77, v234, v235
  v_mul_f32 v248, v248, v252
  v_mul_f32 v249, v249, v252
  v_mul_f32 v250, v250, v252
  v_mul_f32 v251, v251, v252
  v_cvt_pk_bf16_f32 v78, v248, v249
  v_cvt_pk_bf16_f32 v79, v250, v251
  buffer_store_dwordx4 v[76:79], v1, s[12:15], s78 offen offset:1024 sc1
  s_mov_b32 s3, 0x10000000
  s_waitcnt vmcnt(0)
  s_atomic_add s3, s[98:99], 0
  s_nop 0
  v_lshrrev_b32 v16, 3, v0
  v_and_b32 v56, 7, v0
  v_lshlrev_b32 v56, 4, v56
  v_lshl_add_u32 v56, v16, 10, v56
L_p1_done:
  s_setprio 0
  v_lshrrev_b32 v16, 3, v0
  v_and_b32 v17, 7, v0
  v_bfe_u32 v19, v16, 1, 1
  v_lshl_add_u32 v19, v19, 3, v16
  v_xor_b32 v19, v19, v17
  v_lshlrev_b32 v16, 8, v16
  v_lshl_add_u32 v16, v19, 4, v16
  s_xor_b32 s64, s59, 1
  s_lshl_b32 s64, s64, 16
  s_lshl_b32 s65, s56, 11
  s_add_u32 s65, s65, s64
  v_add_u32 v16, s65, v16
  v_xor_b32 v17, 128, v16
  s_lshr_b32 s64, s56, 1
  s_lshl_b32 s64, s64, 2
  v_subrev_u32 v19, s64, v4
  s_mov_b32 s87, 0x3f317218
  v_lshlrev_b32 v64, 16, v48
  v_and_b32 v65, 0xffff0000, v48
  v_lshlrev_b32 v66, 16, v49
  v_and_b32 v67, 0xffff0000, v49
  v_lshlrev_b32 v68, 16, v50
  v_and_b32 v69, 0xffff0000, v50
  v_lshlrev_b32 v70, 16, v51
  v_and_b32 v71, 0xffff0000, v51
  v_lshlrev_b32 v72, 16, v52
  v_and_b32 v73, 0xffff0000, v52
  v_lshlrev_b32 v74, 16, v53
  v_and_b32 v75, 0xffff0000, v53
  v_lshlrev_b32 v76, 16, v54
  v_and_b32 v77, 0xffff0000, v54
  v_lshlrev_b32 v78, 16, v55
  v_and_b32 v79, 0xffff0000, v55
  ds_read_b32 v6, v19 offset:1356
  s_waitcnt lgkmcnt(0)
  v_cmp_ne_u32 vcc, 0, v6
  s_cbranch_vccz L_lr_56
L_lp_55:
  s_add_u32 s86, s86, 1
  s_cmp_gt_u32 s86, 1048576
  s_cbranch_scc1 L_lr_56
  ds_read_b32 v6, v19 offset:1356
  s_waitcnt lgkmcnt(0)
  v_cmp_ne_u32 vcc, 0, v6
  s_cbranch_vccnz L_lp_55
L_lr_56:
  s_setprio 2
  ds_read_b128 v[96:99], v16 offset:0
  ds_read_b128 v[100:103], v17 offset:0
  ds_read_b128 v[104:107], v16 offset:16384
  ds_read_b128 v[108:111], v17 offset:16384
  ds_read_b128 v[112:115], v16 offset:32768
  ds_read_b128 v[116:119], v17 offset:32768
  ds_read_b128 v[120:123], v16 offset:49152
  ds_read_b128 v[124:127], v17 offset:49152
  s_waitcnt lgkmcnt(5)
  v_add_f32 v96, v96, v104
  v_add_f32 v97, v97, v105
  v_add_f32 v98, v98, v106
  v_add_f32 v99, v99, v107
  s_waitcnt lgkmcnt(4)
  v_add_f32 v100, v100, v108
  v_add_f32 v101, v101, v109
  v_add_f32 v102, v102, v110
  v_add_f32 v103, v103, v111
  s_waitcnt lgkmcnt(3)
  v_add_f32 v96, v96, v112
  v_add_f32 v97, v97, v113
  v_add_f32 v98, v98, v114
  v_add_f32 v99, v99, v115
  s_waitcnt lgkmcnt(2)
  v_add_f32 v100, v100, v116
  v_add_f32 v101, v101, v117
  v_add_f32 v102, v102, v118
  v_add_f32 v103, v103, v119
  s_waitcnt lgkmcnt(1)
  v_add_f32 v96, v96, v120
  v_add_f32 v97, v97, v121
  v_add_f32 v98, v98, v122
  v_add_f32 v99, v99, v123
  s_waitcnt lgkmcnt(0)
  v_add_f32 v100, v100, v124
  v_add_f32 v101, v101, v125
  v_add_f32 v102, v102, v126
  v_add_f32 v103, v103, v127
  v_fmac_f32 v64, s87, v96
  v_fmac_f32 v65, s87, v97
  v_fmac_f32 v66, s87, v98
  v_fmac_f32 v67, s87, v99
  v_fmac_f32 v68, s87, v100
  v_fmac_f32 v69, s87, v101
  v_fmac_f32 v70, s87, v102
  v_fmac_f32 v71, s87, v103
  v_cvt_pk_bf16_f32 v48, v64, v65
  v_cvt_pk_bf16_f32 v49, v66, v67
  v_cvt_pk_bf16_f32 v50, v68, v69
  v_cvt_pk_bf16_f32 v51, v70, v71
  buffer_store_dwordx4 v[48:51], v56, s[24:27], s68 offen sc1
  ds_read_b32 v6, v19 offset:1348
  s_waitcnt lgkmcnt(0)
  v_cmp_ne_u32 vcc, 0, v6
  s_cbranch_vccz L_lr_58
L_lp_57:
  s_add_u32 s86, s86, 1
  s_cmp_gt_u32 s86, 1048576
  s_cbranch_scc1 L_lr_58
  ds_read_b32 v6, v19 offset:1348
  s_waitcnt lgkmcnt(0)
  v_cmp_ne_u32 vcc, 0, v6
  s_cbranch_vccnz L_lp_57
L_lr_58:
  ds_read_b128 v[96:99], v16 offset:8192
  ds_read_b128 v[100:103], v17 offset:8192
  ds_read_b128 v[104:107], v16 offset:24576
  ds_read_b128 v[108:111], v17 offset:24576
  ds_read_b128 v[112:115], v16 offset:40960
  ds_read_b128 v[116:119], v17 offset:40960
  ds_read_b128 v[120:123], v16 offset:57344
  ds_read_b128 v[124:127], v17 offset:57344
  s_waitcnt lgkmcnt(5)
  v_add_f32 v96, v96, v104
  v_add_f32 v97, v97, v105
  v_add_f32 v98, v98, v106
  v_add_f32 v99, v99, v107
  s_waitcnt lgkmcnt(4)
  v_add_f32 v100, v100, v108
  v_add_f32 v101, v101, v109
  v_add_f32 v102, v102, v110
  v_add_f32 v103, v103, v111
  s_waitcnt lgkmcnt(3)
  v_add_f32 v96, v96, v112
  v_add_f32 v97, v97, v113
  v_add_f32 v98, v98, v114
  v_add_f32 v99, v99, v115
  s_waitcnt lgkmcnt(2)
  v_add_f32 v100, v100, v116
  v_add_f32 v101, v101, v117
  v_add_f32 v102, v102, v118
  v_add_f32 v103, v103, v119
  s_waitcnt lgkmcnt(1)
  v_add_f32 v96, v96, v120
  v_add_f32 v97, v97, v121
  v_add_f32 v98, v98, v122
  v_add_f32 v99, v99, v123
  s_waitcnt lgkmcnt(0)
  v_add_f32 v100, v100, v124
  v_add_f32 v101, v101, v125
  v_add_f32 v102, v102, v126
  v_add_f32 v103, v103, v127
  v_fmac_f32 v72, s87, v96
  v_fmac_f32 v73, s87, v97
  v_fmac_f32 v74, s87, v98
  v_fmac_f32 v75, s87, v99
  v_fmac_f32 v76, s87, v100
  v_fmac_f32 v77, s87, v101
  v_fmac_f32 v78, s87, v102
  v_fmac_f32 v79, s87, v103
  v_cvt_pk_bf16_f32 v52, v72, v73
  v_cvt_pk_bf16_f32 v53, v74, v75
  v_cvt_pk_bf16_f32 v54, v76, v77
  v_cvt_pk_bf16_f32 v55, v78, v79
  buffer_store_dwordx4 v[52:55], v56, s[24:27], s69 offen sc1
  s_endpgm
L_lwave:
  v_mov_b32 v3, 0
  v_and_b32 v4, 3, v0
  v_mul_u32_u24 v4, 336, v4
  v_add_u32 v4, 147456, v4
  s_mul_i32 s64, s78, 336
  s_add_u32 s64, s64, 147456
  v_mov_b32 v5, s64
  v_lshlrev_b32 v1, 4, v0
  s_lshr_b32 s64, s58, 1
  s_mul_i32 s64, s64, 896
  s_add_u32 s74, s64, 384
  s_and_b32 s65, s58, 1
  s_lshl_b32 s65, s65, 9
  s_add_u32 s75, s64, s65
  s_add_u32 s76, s75, 128
  s_add_u32 s77, s75, 256
  s_lshl_b32 s64, s58, 7
  s_add_u32 s65, s64, 1024
  s_add_u32 s66, s64, 2048
  s_cmp_eq_u32 s59, 0
  s_cselect_b32 s74, s65, s74
  s_cselect_b32 s75, s66, s75
  s_cselect_b32 s76, s64, s76
  s_lshl_b32 s63, s59, 9
  s_add_u32 s63, s63, 3072
  v_and_b32 v75, 2, v70
  v_xor_b32 v75, v75, v71
  v_lshlrev_b32 v75, 4, v75
  v_mul_lo_u32 v72, v70, s63
  v_add_u32 v8, v72, v75
  s_lshl_b32 s64, s63, 3
  s_sub_u32 s64, s64, 1024
  v_add_u32 v9, s64, v8
  v_add_u32 v10, s64, v9
  v_add_u32 v11, s64, v10
  v_xor_b32 v9, 64, v9
  v_xor_b32 v11, 64, v11
  s_mov_b32 s83, 0
  s_lshl_b32 s65, s83, 2
  s_lshl_b32 s64, s62, 1
  s_add_u32 s65, s65, s64
  s_add_u32 s65, s65, s78
  s_lshl_b32 s66, s63, 5
  s_add_u32 s64, s65, 0
  s_and_b32 s64, s64, 15
  s_mul_i32 s70, s64, s66
  s_add_u32 s64, s65, 4
  s_and_b32 s64, s64, 15
  s_mul_i32 s71, s64, s66
  s_add_u32 s64, s65, 8
  s_and_b32 s64, s64, 15
  s_mul_i32 s72, s64, s66
  s_add_u32 s64, s65, 12
  s_and_b32 s64, s64, 15
  s_mul_i32 s73, s64, s66
  s_lshl_b32 s83, s83, 14
  s_add_u32 s83, s83, s82
  s_cmp_eq_u32 s59, 0
  s_cselect_b32 s8, s38, s44
  s_cselect_b32 s9, s39, s45
  s_lshl_b32 s10, s63, 9
  s_mov_b32 s11, 0x20000
  s_waitcnt lgkmcnt(0)
  s_barrier
  s_cmp_eq_u32 s59, 0
  s_cbranch_scc1 L_la
  s_add_u32 s64, s62, 2
  s_and_b32 s64, s64, 7
  s_add_u32 m0, s82, 49152
  s_lshl_b32 s64, s64, 7
  s_waitcnt vmcnt(10)
  buffer_load_dwordx4 v16, s[4:7], s64 offen offset:0 lds
  buffer_load_dwordx4 v17, s[4:7], s64 offen offset:1024 lds
  s_waitcnt vmcnt(10)
  buffer_load_dwordx4 v18, s[4:7], s64 offen offset:2048 lds
  buffer_load_dwordx4 v19, s[4:7], s64 offen offset:3072 lds
  s_mov_b32 m0, s35
  s_nop 0
  buffer_load_dword v15, s[4:7], 0 offen offset:68 lds
  s_and_b32 s67, s2, 7
  s_lshr_b32 s65, s2, 3
  s_lshl_b32 s60, s67, 2
  s_lshr_b32 s66, s65, 3
  s_add_u32 s60, s60, s66
  s_lshl_b32 s66, s66, 1
  s_add_u32 s65, s65, s66
  s_and_b32 s61, s65, 7
  s_mov_b32 s86, 0
  s_lshl_b32 s65, s60, 2
  s_add_u32 s65, s65, s78
  s_lshl_b32 s66, s65, 7
  s_mul_i32 s65, s65, 73728
  s_add_u32 s79, s65, 4194304
  s_mov_b32 s89, s66
  s_lshl_b32 s65, s61, 2
  s_add_u32 s65, s65, s78
  s_add_u32 s64, s62, 3
  s_and_b32 s64, s64, 7
  s_add_u32 m0, s82, 65536
  s_lshl_b32 s64, s64, 7
  s_waitcnt vmcnt(10)
  buffer_load_dwordx4 v16, s[4:7], s64 offen offset:0 lds
  buffer_load_dwordx4 v17, s[4:7], s64 offen offset:1024 lds
  s_waitcnt vmcnt(10)
  buffer_load_dwordx4 v18, s[4:7], s64 offen offset:2048 lds
  buffer_load_dwordx4 v19, s[4:7], s64 offen offset:3072 lds
  s_mov_b32 m0, s35
  s_nop 0
  buffer_load_dword v15, s[4:7], 0 offen offset:64 lds
  s_lshl_b32 s88, s65, 7
  s_add_u32 s88, s88, 20480
  s_mul_i32 s65, s65, 73728
  s_add_u32 s80, s65, 1048576
  s_mov_b64 s[12:13], s[54:55]
  s_mov_b32 s14, 0x10000000
  s_mov_b32 s15, 0x20000
  s_mov_b64 s[28:29], s[52:53]
  s_mov_b32 s30, 0x100
  s_mov_b32 s31, 0x20000
  v_mov_b32 v29, 0
  v_and_b32 v72, 31, v0
  s_lshl_b32 s65, s57, 5
  v_add_u32 v72, s65, v72
  v_mul_lo_u32 v72, v72, s63
  v_lshrrev_b32 v73, 5, v0
  s_sub_u32 s65, s77, s76
  s_add_u32 s64, s62, 4
  s_and_b32 s64, s64, 7
  s_add_u32 m0, s82, 81920
  s_lshl_b32 s64, s64, 7
  s_waitcnt vmcnt(10)
  buffer_load_dwordx4 v16, s[4:7], s64 offen offset:0 lds
  buffer_load_dwordx4 v17, s[4:7], s64 offen offset:1024 lds
  s_waitcnt vmcnt(10)
  buffer_load_dwordx4 v18, s[4:7], s64 offen offset:2048 lds
  buffer_load_dwordx4 v19, s[4:7], s64 offen offset:3072 lds
  s_mov_b32 m0, s35
  s_nop 0
  buffer_load_dword v15, s[4:7], 0 offen offset:60 lds
  v_mul_lo_u32 v73, v73, s65
  v_add3_u32 v28, v72, v73, s76
  s_lshl_b32 s81, s57, 3
  s_add_u32 s81, s81, s58
  s_and_b32 s66, s81, 1
  s_xor_b32 s67, s78, 3
  s_or_b32 s85, s66, s67
  s_lshr_b32 s81, s81, 1
  s_lshr_b32 s65, s81, 5
  s_add_u32 s65, s65, 16
  s_bfe_u32 s66, s81, 0x20003
  s_and_b32 s81, s81, 7
  s_lshl_b32 s68, s81, 2
  s_add_u32 s68, s68, s66
  s_mul_i32 s69, s68, 18
  s_add_u32 s69, s69, s65
  s_add_u32 s64, s62, 5
  s_and_b32 s64, s64, 7
  s_add_u32 m0, s82, 98304
  s_lshl_b32 s64, s64, 7
  s_waitcnt vmcnt(10)
  buffer_load_dwordx4 v16, s[4:7], s64 offen offset:0 lds
  buffer_load_dwordx4 v17, s[4:7], s64 offen offset:1024 lds
  s_waitcnt vmcnt(10)
  buffer_load_dwordx4 v18, s[4:7], s64 offen offset:2048 lds
  buffer_load_dwordx4 v19, s[4:7], s64 offen offset:3072 lds
  s_mov_b32 m0, s35
  s_nop 0
  buffer_load_dword v15, s[4:7], 0 offen offset:56 lds
  s_lshl_b32 s69, s69, 12
  s_add_u32 s84, s69, 1048576
  s_lshl_b32 s68, s68, 7
  s_add_u32 s68, s68, 20480
  s_add_u32 s100, s54, s68
  s_addc_u32 s101, s55, 0
  v_lshrrev_b32 v72, 2, v0
  v_lshlrev_b32 v72, 7, v72
  v_bfe_u32 v73, v0, 3, 2
  v_lshl_add_u32 v72, v73, 5, v72
  v_and_b32 v73, 3, v0
  v_lshl_add_u32 v72, v73, 3, v72
  s_add_u32 s65, s82, 0
  v_add_u32 v24, s65, v72
  v_xor_b32 v25, 32, v24
  v_xor_b32 v26, 64, v24
  v_xor_b32 v27, 96, v24
  s_add_u32 s64, s62, 6
  s_and_b32 s64, s64, 7
  s_add_u32 m0, s82, 114688
  s_lshl_b32 s64, s64, 7
  s_waitcnt vmcnt(10)
  buffer_load_dwordx4 v16, s[4:7], s64 offen offset:0 lds
  buffer_load_dwordx4 v17, s[4:7], s64 offen offset:1024 lds
  s_waitcnt vmcnt(10)
  buffer_load_dwordx4 v18, s[4:7], s64 offen offset:2048 lds
  buffer_load_dwordx4 v19, s[4:7], s64 offen offset:3072 lds
  s_mov_b32 m0, s35
  s_nop 0
  buffer_load_dword v15, s[4:7], 0 offen offset:52 lds
  s_cmp_lg_u32 s85, 0
  s_cbranch_scc1 L_sk_61
  ds_read_b32 v6, v5 offset:76
  s_waitcnt lgkmcnt(0)
  v_cmp_ne_u32 vcc, 0, v6
  s_cbranch_vccz L_lr_60
L_lp_59:
  s_add_u32 s86, s86, 1
  s_cmp_gt_u32 s86, 1048576
  s_cbranch_scc1 L_lr_60
  ds_read_b32 v6, v5 offset:76
  s_waitcnt lgkmcnt(0)
  v_cmp_ne_u32 vcc, 0, v6
  s_cbranch_vccnz L_lp_59
L_lr_60:
  ds_read_b64_tr_b16 v[32:33], v24 offset:0
  ds_read_b64_tr_b16 v[34:35], v24 offset:2048
  ds_read_b64_tr_b16 v[36:37], v25 offset:0
  ds_read_b64_tr_b16 v[38:39], v25 offset:2048
  ds_read_b64_tr_b16 v[40:41], v26 offset:0
  ds_read_b64_tr_b16 v[42:43], v26 offset:2048
  ds_read_b64_tr_b16 v[44:45], v27 offset:0
  ds_read_b64_tr_b16 v[46:47], v27 offset:2048
L_sk_61:
  s_add_u32 s64, s62, 7
  s_and_b32 s64, s64, 7
  s_add_u32 m0, s82, 131072
  s_lshl_b32 s64, s64, 7
  s_waitcnt vmcnt(10)
  buffer_load_dwordx4 v16, s[4:7], s64 offen offset:0 lds
  buffer_load_dwordx4 v17, s[4:7], s64 offen offset:1024 lds
  s_waitcnt vmcnt(10)
  buffer_load_dwordx4 v18, s[4:7], s64 offen offset:2048 lds
  buffer_load_dwordx4 v19, s[4:7], s64 offen offset:3072 lds
  s_mov_b32 m0, s35
  s_nop 0
  buffer_load_dword v15, s[4:7], 0 offen offset:48 lds
  s_add_u32 s98, s54, s89
  s_addc_u32 s99, s55, 0
  ds_read_b32 v6, v5 offset:72
  s_waitcnt lgkmcnt(0)
  v_cmp_ne_u32 vcc, 0, v6
  s_cbranch_vccz L_lr_63
L_lp_62:
  s_add_u32 s86, s86, 1
  s_cmp_gt_u32 s86, 1048576
  s_cbranch_scc1 L_lr_63
  ds_read_b32 v6, v5 offset:72
  s_waitcnt lgkmcnt(0)
  v_cmp_ne_u32 vcc, 0, v6
  s_cbranch_vccnz L_lp_62
L_lr_63:
  s_add_u32 s64, s83, 0
  s_and_b32 s64, s64, 0xffff
  s_add_u32 m0, s64, 0
  s_add_u32 s64, s70, s74
  buffer_load_dwordx4 v8, s[8:11], s64 offen offset:0 lds
  buffer_load_dwordx4 v9, s[8:11], s64 offen offset:1024 lds
  buffer_load_dwordx4 v10, s[8:11], s64 offen offset:2048 lds
  buffer_load_dwordx4 v11, s[8:11], s64 offen offset:3072 lds
  s_add_u32 s64, s83, 16384
  s_and_b32 s64, s64, 0xffff
  s_add_u32 m0, s64, 0
  s_add_u32 s64, s71, s74
  s_waitcnt vmcnt(7)
  buffer_load_dwordx4 v8, s[8:11], s64 offen offset:0 lds
  buffer_load_dwordx4 v9, s[8:11], s64 offen offset:1024 lds
  s_waitcnt vmcnt(7)
  buffer_load_dwordx4 v10, s[8:11], s64 offen offset:2048 lds
  buffer_load_dwordx4 v11, s[8:11], s64 offen offset:3072 lds
  s_mov_b32 m0, s35
  s_nop 0
  buffer_load_dword v15, s[4:7], 0 offen offset:44 lds
  s_add_u32 s64, s83, 32768
  s_and_b32 s64, s64, 0xffff
  s_add_u32 m0, s64, 0
  s_add_u32 s64, s72, s74
  s_waitcnt vmcnt(7)
  buffer_load_dwordx4 v8, s[8:11], s64 offen offset:0 lds
  buffer_load_dwordx4 v9, s[8:11], s64 offen offset:1024 lds
  s_waitcnt vmcnt(7)
  buffer_load_dwordx4 v10, s[8:11], s64 offen offset:2048 lds
  buffer_load_dwordx4 v11, s[8:11], s64 offen offset:3072 lds
  s_add_u32 s64, s83, 49152
  s_and_b32 s64, s64, 0xffff
  s_add_u32 m0, s64, 0
  s_add_u32 s64, s73, s74
  s_waitcnt vmcnt(7)
  buffer_load_dwordx4 v8, s[8:11], s64 offen offset:0 lds
  buffer_load_dwordx4 v9, s[8:11], s64 offen offset:1024 lds
  s_waitcnt vmcnt(7)
  buffer_load_dwordx4 v10, s[8:11], s64 offen offset:2048 lds
  buffer_load_dwordx4 v11, s[8:11], s64 offen offset:3072 lds
  s_mov_b32 m0, s35
  s_nop 0
  buffer_load_dword v15, s[4:7], 0 offen offset:40 lds
  buffer_load_dword v254, v29, s[28:31], 0 offen sc1
  ds_read_b32 v6, v5 offset:68
  s_waitcnt lgkmcnt(0)
  v_cmp_ne_u32 vcc, 0, v6
  s_cbranch_vccz L_lr_72
L_lp_71:
  s_add_u32 s86, s86, 1
  s_cmp_gt_u32 s86, 1048576
  s_cbranch_scc1 L_lr_72
  ds_read_b32 v6, v5 offset:68
  s_waitcnt lgkmcnt(0)
  v_cmp_ne_u32 vcc, 0, v6
  s_cbranch_vccnz L_lp_71
L_lr_72:
  s_add_u32 s64, s83, 0
  s_and_b32 s64, s64, 0xffff
  s_add_u32 m0, s64, 65536
  s_add_u32 s64, s70, s75
  s_waitcnt vmcnt(7)
  buffer_load_dwordx4 v8, s[8:11], s64 offen offset:0 lds
  buffer_load_dwordx4 v9, s[8:11], s64 offen offset:1024 lds
  s_waitcnt vmcnt(7)
  buffer_load_dwordx4 v10, s[8:11], s64 offen offset:2048 lds
  buffer_load_dwordx4 v11, s[8:11], s64 offen offset:3072 lds
  s_add_u32 s64, s83, 16384
  s_and_b32 s64, s64, 0xffff
  s_add_u32 m0, s64, 65536
  s_add_u32 s64, s71, s75
  s_waitcnt vmcnt(7)
  buffer_load_dwordx4 v8, s[8:11], s64 offen offset:0 lds
  buffer_load_dwordx4 v9, s[8:11], s64 offen offset:1024 lds
  s_waitcnt vmcnt(7)
  buffer_load_dwordx4 v10, s[8:11], s64 offen offset:2048 lds
  buffer_load_dwordx4 v11, s[8:11], s64 offen offset:3072 lds
  s_mov_b32 m0, s35
  s_nop 0
  buffer_load_dword v15, s[4:7], 0 offen offset:36 lds
  ds_read_b32 v6, v5 offset:64
  s_waitcnt lgkmcnt(0)
  v_cmp_ne_u32 vcc, 0, v6
  s_cbranch_vccz L_lr_70
L_lp_69:
  s_add_u32 s86, s86, 1
  s_cmp_gt_u32 s86, 1048576
  s_cbranch_scc1 L_lr_70
  ds_read_b32 v6, v5 offset:64
  s_waitcnt lgkmcnt(0)
  v_cmp_ne_u32 vcc, 0, v6
  s_cbranch_vccnz L_lp_69
L_lr_70:
  s_add_u32 s64, s83, 32768
  s_and_b32 s64, s64, 0xffff
  s_add_u32 m0, s64, 65536
  s_add_u32 s64, s72, s75
  s_waitcnt vmcnt(7)
  buffer_load_dwordx4 v8, s[8:11], s64 offen offset:0 lds
  buffer_load_dwordx4 v9, s[8:11], s64 offen offset:1024 lds
  s_waitcnt vmcnt(7)
  buffer_load_dwordx4 v10, s[8:11], s64 offen offset:2048 lds
  buffer_load_dwordx4 v11, s[8:11], s64 offen offset:3072 lds
  s_add_u32 s64, s83, 49152
  s_and_b32 s64, s64, 0xffff
  s_add_u32 m0, s64, 65536
  s_add_u32 s64, s73, s75
  s_waitcnt vmcnt(7)
  buffer_load_dwordx4 v8, s[8:11], s64 offen offset:0 lds
  buffer_load_dwordx4 v9, s[8:11], s64 offen offset:1024 lds
  s_waitcnt vmcnt(7)
  buffer_load_dwordx4 v10, s[8:11], s64 offen offset:2048 lds
  buffer_load_dwordx4 v11, s[8:11], s64 offen offset:3072 lds
  v_cmp_gt_u32 vcc, 8, v254
  s_cbranch_vccnz L_ip_66
L_ir_67:
  s_mov_b32 m0, s35
  s_nop 0
  buffer_load_dword v15, s[4:7], 0 offen offset:32 lds
  s_barrier
  s_cmp_lg_u32 s85, 0
  s_cbranch_scc1 L_sk_64
  buffer_store_dwordx4 v[32:35], v1, s[12:15], s84 offen offset:0 sc1
  buffer_store_dwordx4 v[36:39], v1, s[12:15], s84 offen offset:1024 sc1
  buffer_store_dwordx4 v[40:43], v1, s[12:15], s84 offen offset:2048 sc1
  buffer_store_dwordx4 v[44:47], v1, s[12:15], s84 offen offset:3072 sc1
L_sk_64:
  s_cmp_lg_u32 s78, 0
  s_cbranch_scc1 L_sk_65
  s_mov_b32 exec_lo, 0
  buffer_load_dword v255, v28, s[8:11], 0 offen
  s_mov_b64 exec, -1
L_sk_65:
  s_add_u32 s64, s83, 0
  s_and_b32 s64, s64, 0xffff
  s_add_u32 m0, s64, 0
  s_add_u32 s64, s70, s76
  s_waitcnt vmcnt(7)
  buffer_load_dwordx4 v8, s[8:11], s64 offen offset:0 lds
  buffer_load_dwordx4 v9, s[8:11], s64 offen offset:1024 lds
  s_waitcnt vmcnt(7)
  buffer_load_dwordx4 v10, s[8:11], s64 offen offset:2048 lds
  buffer_load_dwordx4 v11, s[8:11], s64 offen offset:3072 lds
  s_add_u32 s64, s83, 16384
  s_and_b32 s64, s64, 0xffff
  s_add_u32 m0, s64, 0
  s_add_u32 s64, s71, s76
  s_waitcnt vmcnt(7)
  buffer_load_dwordx4 v8, s[8:11], s64 offen offset:0 lds
  buffer_load_dwordx4 v9, s[8:11], s64 offen offset:1024 lds
  s_waitcnt vmcnt(7)
  buffer_load_dwordx4 v10, s[8:11], s64 offen offset:2048 lds
  buffer_load_dwordx4 v11, s[8:11], s64 offen offset:3072 lds
  s_cmp_lg_u32 s85, 0
  s_cbranch_scc1 L_sk_68
  s_mov_b32 s3, 0x10000
  s_waitcnt vmcnt(8)
  s_atomic_add s3, s[100:101], 0
L_sk_68:
  s_add_u32 s100, s54, s88
  s_addc_u32 s101, s55, 0
  s_add_u32 s64, s83, 32768
  s_and_b32 s64, s64, 0xffff
  s_add_u32 m0, s64, 0
  s_add_u32 s64, s72, s76
  s_waitcnt vmcnt(7)
  buffer_load_dwordx4 v8, s[8:11], s64 offen offset:0 lds
  buffer_load_dwordx4 v9, s[8:11], s64 offen offset:1024 lds
  s_waitcnt vmcnt(7)
  buffer_load_dwordx4 v10, s[8:11], s64 offen offset:2048 lds
  buffer_load_dwordx4 v11, s[8:11], s64 offen offset:3072 lds
  s_mov_b32 s89, 0
  s_atomic_add s89, s[100:101], 0 glc
  s_add_u32 s64, s83, 49152
  s_and_b32 s64, s64, 0xffff
  s_add_u32 m0, s64, 0
  s_add_u32 s64, s73, s76
  s_waitcnt vmcnt(7)
  buffer_load_dwordx4 v8, s[8:11], s64 offen offset:0 lds
  buffer_load_dwordx4 v9, s[8:11], s64 offen offset:1024 lds
  s_waitcnt vmcnt(7)
  buffer_load_dwordx4 v10, s[8:11], s64 offen offset:2048 lds
  buffer_load_dwordx4 v11, s[8:11], s64 offen offset:3072 lds
  s_mov_b32 m0, s35
  s_nop 0
  buffer_load_dword v15, s[4:7], 0 offen offset:24 lds
  s_waitcnt lgkmcnt(0)
  s_bitcmp0_b32 s89, 3
  s_cbranch_scc0 L_sr_74
L_sp_73:
  s_add_u32 s86, s86, 1
  s_cmp_gt_u32 s86, 1048576
  s_cbranch_scc1 L_sr_74
  s_mov_b32 s89, 0
  s_atomic_add s89, s[100:101], 0 glc
  s_waitcnt lgkmcnt(0)
  s_bitcmp0_b32 s89, 3
  s_cbranch_scc1 L_sp_73
L_sr_74:
  s_waitcnt vmcnt(7)
  buffer_load_dwordx4 v[16:19], v1, s[12:15], s80 offen offset:0 sc1
  buffer_load_dwordx4 v[20:23], v1, s[12:15], s80 offen offset:1024 sc1
  s_waitcnt vmcnt(7)
  buffer_load_dwordx4 v[24:27], v1, s[12:15], s80 offen offset:2048 sc1
  buffer_load_dwordx4 v[28:31], v1, s[12:15], s80 offen offset:3072 sc1
  s_waitcnt vmcnt(7)
  s_add_u32 s80, s80, 4096
  buffer_load_dwordx4 v[32:35], v1, s[12:15], s80 offen offset:0 sc1
  buffer_load_dwordx4 v[36:39], v1, s[12:15], s80 offen offset:1024 sc1
  s_waitcnt vmcnt(7)
  buffer_load_dwordx4 v[40:43], v1, s[12:15], s80 offen offset:2048 sc1
  buffer_load_dwordx4 v[44:47], v1, s[12:15], s80 offen offset:3072 sc1
  s_waitcnt vmcnt(7)
  s_add_u32 s80, s80, 4096
  buffer_load_dwordx4 v[48:51], v1, s[12:15], s80 offen offset:0 sc1
  buffer_load_dwordx4 v[52:55], v1, s[12:15], s80 offen offset:1024 sc1
  s_waitcnt vmcnt(7)
  buffer_load_dwordx4 v[56:59], v1, s[12:15], s80 offen offset:2048 sc1
  buffer_load_dwordx4 v[60:63], v1, s[12:15], s80 offen offset:3072 sc1
  s_waitcnt vmcnt(7)
  s_add_u32 s80, s80, 4096
  buffer_load_dwordx4 v[64:67], v1, s[12:15], s80 offen offset:0 sc1
  buffer_load_dwordx4 v[68:71], v1, s[12:15], s80 offen offset:1024 sc1
  s_waitcnt vmcnt(7)
  buffer_load_dwordx4 v[72:75], v1, s[12:15], s80 offen offset:2048 sc1
  buffer_load_dwordx4 v[76:79], v1, s[12:15], s80 offen offset:3072 sc1
  ds_read_b32 v6, v4 offset:56
  s_waitcnt lgkmcnt(0)
  v_cmp_ne_u32 vcc, 0, v6
  s_cbranch_vccz L_lr_76
L_lp_75:
  s_add_u32 s86, s86, 1
  s_cmp_gt_u32 s86, 1048576
  s_cbranch_scc1 L_lr_76
  ds_read_b32 v6, v4 offset:56
  s_waitcnt lgkmcnt(0)
  v_cmp_ne_u32 vcc, 0, v6
  s_cbranch_vccnz L_lp_75
L_lr_76:
  s_add_u32 s64, s83, 0
  s_and_b32 s64, s64, 0xffff
  s_add_u32 m0, s64, 65536
  s_add_u32 s64, s70, s77
  s_waitcnt vmcnt(7)
  buffer_load_dwordx4 v8, s[8:11], s64 offen offset:0 lds
  buffer_load_dwordx4 v9, s[8:11], s64 offen offset:1024 lds
  s_waitcnt vmcnt(7)
  buffer_load_dwordx4 v10, s[8:11], s64 offen offset:2048 lds
  buffer_load_dwordx4 v11, s[8:11], s64 offen offset:3072 lds
  s_add_u32 s64, s83, 16384
  s_and_b32 s64, s64, 0xffff
  s_add_u32 m0, s64, 65536
  s_add_u32 s64, s71, s77
  s_waitcnt vmcnt(7)
  buffer_load_dwordx4 v8, s[8:11], s64 offen offset:0 lds
  buffer_load_dwordx4 v9, s[8:11], s64 offen offset:1024 lds
  s_waitcnt vmcnt(7)
  buffer_load_dwordx4 v10, s[8:11], s64 offen offset:2048 lds
  buffer_load_dwordx4 v11, s[8:11], s64 offen offset:3072 lds
  s_add_u32 s64, s83, 32768
  s_and_b32 s64, s64, 0xffff
  s_add_u32 m0, s64, 65536
  s_add_u32 s64, s72, s77
  s_waitcnt vmcnt(7)
  buffer_load_dwordx4 v8, s[8:11], s64 offen offset:0 lds
  buffer_load_dwordx4 v9, s[8:11], s64 offen offset:1024 lds
  s_waitcnt vmcnt(7)
  buffer_load_dwordx4 v10, s[8:11], s64 offen offset:2048 lds
  buffer_load_dwordx4 v11, s[8:11], s64 offen offset:3072 lds
  s_add_u32 s64, s83, 49152
  s_and_b32 s64, s64, 0xffff
  s_add_u32 m0, s64, 65536
  s_add_u32 s64, s73, s77
  s_waitcnt vmcnt(7)
  buffer_load_dwordx4 v8, s[8:11], s64 offen offset:0 lds
  buffer_load_dwordx4 v9, s[8:11], s64 offen offset:1024 lds
  s_waitcnt vmcnt(7)
  buffer_load_dwordx4 v10, s[8:11], s64 offen offset:2048 lds
  buffer_load_dwordx4 v11, s[8:11], s64 offen offset:3072 lds
  s_mov_b32 m0, s35
  s_nop 0
  buffer_load_dword v15, s[4:7], 0 offen offset:16 lds
  s_waitcnt vmcnt(7)
  s_add_u32 s80, s80, 4096
  buffer_load_dwordx4 v[80:83], v1, s[12:15], s80 offen offset:0 sc1
  buffer_load_dwordx4 v[84:87], v1, s[12:15], s80 offen offset:1024 sc1
  s_waitcnt vmcnt(7)
  buffer_load_dwordx4 v[88:91], v1, s[12:15], s80 offen offset:2048 sc1
  buffer_load_dwordx4 v[92:95], v1, s[12:15], s80 offen offset:3072 sc1
  s_mov_b32 s89, 0
  s_atomic_add s89, s[100:101], 0 glc
  s_waitcnt vmcnt(7)
  s_add_u32 s80, s80, 4096
  buffer_load_dwordx4 v[96:99], v1, s[12:15], s80 offen offset:0 sc1
  buffer_load_dwordx4 v[100:103], v1, s[12:15], s80 offen offset:1024 sc1
  s_waitcnt vmcnt(7)
  buffer_load_dwordx4 v[104:107], v1, s[12:15], s80 offen offset:2048 sc1
  buffer_load_dwordx4 v[108:111], v1, s[12:15], s80 offen offset:3072 sc1
  s_waitcnt vmcnt(7)
  s_add_u32 s80, s80, 4096
  buffer_load_dwordx4 v[112:115], v1, s[12:15], s80 offen offset:0 sc1
  buffer_load_dwordx4 v[116:119], v1, s[12:15], s80 offen offset:1024 sc1
  s_waitcnt vmcnt(7)
  buffer_load_dwordx4 v[120:123], v1, s[12:15], s80 offen offset:2048 sc1
  buffer_load_dwordx4 v[124:127], v1, s[12:15], s80 offen offset:3072 sc1
  s_waitcnt lgkmcnt(0)
  s_cmp_lt_u32 s89, 0xa0000
  s_cbranch_scc0 L_sr_78
L_sp_77:
  s_add_u32 s86, s86, 1
  s_cmp_gt_u32 s86, 1048576
  s_cbranch_scc1 L_sr_78
  s_mov_b32 s89, 0
  s_atomic_add s89, s[100:101], 0 glc
  s_waitcnt lgkmcnt(0)
  s_cmp_lt_u32 s89, 0xa0000
  s_cbranch_scc1 L_sp_77
L_sr_78:
  s_mov_b32 s89, 0
  s_atomic_add s89, s[98:99], 0 glc
  s_waitcnt vmcnt(7)
  s_add_u32 s80, s80, 4096
  buffer_load_dwordx4 v[128:131], v1, s[12:15], s80 offen offset:0 sc1
  buffer_load_dwordx4 v[132:135], v1, s[12:15], s80 offen offset:1024 sc1
  s_waitcnt vmcnt(7)
  buffer_load_dwordx4 v[136:139], v1, s[12:15], s80 offen offset:2048 sc1
  buffer_load_dwordx4 v[140:143], v1, s[12:15], s80 offen offset:3072 sc1
  s_waitcnt vmcnt(7)
  s_add_u32 s80, s80, 4096
  buffer_load_dwordx4 v[144:147], v1, s[12:15], s80 offen offset:0 sc1
  buffer_load_dwordx4 v[148:151], v1, s[12:15], s80 offen offset:1024 sc1
  s_waitcnt vmcnt(7)
  buffer_load_dwordx4 v[152:155], v1, s[12:15], s80 offen offset:2048 sc1
  buffer_load_dwordx4 v[156:159], v1, s[12:15], s80 offen offset:3072 sc1
  s_waitcnt lgkmcnt(0)
  s_bitcmp0_b32 s89, 2
  s_cbranch_scc0 L_sr_80
L_sp_79:
  s_add_u32 s86, s86, 1
  s_cmp_gt_u32 s86, 1048576
  s_cbranch_scc1 L_sr_80
  s_mov_b32 s89, 0
  s_atomic_add s89, s[98:99], 0 glc
  s_waitcnt lgkmcnt(0)
  s_bitcmp0_b32 s89, 2
  s_cbranch_scc1 L_sp_79
L_sr_80:
  buffer_load_dwordx4 v[160:163], v1, s[12:15], s79 offen offset:0 sc1
  buffer_load_dwordx4 v[164:167], v1, s[12:15], s79 offen offset:1024 sc1
  buffer_load_dwordx4 v[168:171], v1, s[12:15], s79 offen offset:2048 sc1
  buffer_load_dwordx4 v[172:175], v1, s[12:15], s79 offen offset:3072 sc1
  s_add_u32 s79, s79, 4096
  buffer_load_dwordx4 v[176:179], v1, s[12:15], s79 offen offset:0 sc1
  buffer_load_dwordx4 v[180:183], v1, s[12:15], s79 offen offset:1024 sc1
  buffer_load_dwordx4 v[184:187], v1, s[12:15], s79 offen offset:2048 sc1
  buffer_load_dwordx4 v[188:191], v1, s[12:15], s79 offen offset:3072 sc1
  s_lshl_b32 s66, s78, 14
  s_add_u32 s66, s66, 0
  v_add_u32 v12, s66, v1
  s_add_u32 s65, s82, 131072
  v_add_u32 v13, s65, v1
  v_bfe_u32 v9, v0, 4, 1
  v_bfe_u32 v10, v0, 1, 1
  v_xor_b32 v9, v9, v10
  v_lshrrev_b32 v10, 5, v0
  v_and_b32 v11, 7, v0
  v_xor_b32 v10, v10, v11
  v_lshl_add_u32 v9, v9, 3, v10
  v_and_b32 v10, 15, v0
  v_lshlrev_b32 v10, 8, v10
  v_lshl_add_u32 v9, v9, 4, v10
  v_add_u32 v8, s66, v9
  v_xor_b32 v9, 32, v8
  v_xor_b32 v10, 64, v8
  v_xor_b32 v11, 96, v8
  ds_read_b32 v6, v4 offset:52
  s_waitcnt lgkmcnt(0)
  v_cmp_ne_u32 vcc, 0, v6
  s_cbranch_vccz L_lr_82
L_lp_81:
  s_add_u32 s86, s86, 1
  s_cmp_gt_u32 s86, 1048576
  s_cbranch_scc1 L_lr_82
  ds_read_b32 v6, v4 offset:52
  s_waitcnt lgkmcnt(0)
  v_cmp_ne_u32 vcc, 0, v6
  s_cbranch_vccnz L_lp_81
L_lr_82:
  s_add_u32 s80, s80, 4096
  s_add_u32 m0, s66, 0
  s_waitcnt vmcnt(7)
  buffer_load_dwordx4 v1, s[12:15], s80 offen offset:0 sc1 lds
  buffer_load_dwordx4 v1, s[12:15], s80 offen offset:1024 sc1 lds
  s_waitcnt vmcnt(7)
  buffer_load_dwordx4 v1, s[12:15], s80 offen offset:2048 sc1 lds
  buffer_load_dwordx4 v1, s[12:15], s80 offen offset:3072 sc1 lds
  s_add_u32 s80, s80, 4096
  s_add_u32 m0, s66, 4096
  s_waitcnt vmcnt(7)
  buffer_load_dwordx4 v1, s[12:15], s80 offen offset:0 sc1 lds
  buffer_load_dwordx4 v1, s[12:15], s80 offen offset:1024 sc1 lds
  s_waitcnt vmcnt(7)
  buffer_load_dwordx4 v1, s[12:15], s80 offen offset:2048 sc1 lds
  buffer_load_dwordx4 v1, s[12:15], s80 offen offset:3072 sc1 lds
  s_add_u32 s80, s80, 4096
  s_add_u32 m0, s66, 8192
  s_waitcnt vmcnt(7)
  buffer_load_dwordx4 v1, s[12:15], s80 offen offset:0 sc1 lds
  buffer_load_dwordx4 v1, s[12:15], s80 offen offset:1024 sc1 lds
  s_waitcnt vmcnt(7)
  buffer_load_dwordx4 v1, s[12:15], s80 offen offset:2048 sc1 lds
  buffer_load_dwordx4 v1, s[12:15], s80 offen offset:3072 sc1 lds
  s_add_u32 s80, s80, 4096
  s_add_u32 m0, s66, 12288
  s_bitcmp1_b32 s89, 6
  s_cbranch_scc1 L_np_83
  s_mov_b32 s89, 0
  s_atomic_add s89, s[98:99], 0 glc
L_np_83:
  s_waitcnt vmcnt(7)
  buffer_load_dwordx4 v1, s[12:15], s80 offen offset:0 sc1 lds
  buffer_load_dwordx4 v1, s[12:15], s80 offen offset:1024 sc1 lds
  s_waitcnt vmcnt(7)
  buffer_load_dwordx4 v1, s[12:15], s80 offen offset:2048 sc1 lds
  buffer_load_dwordx4 v1, s[12:15], s80 offen offset:3072 sc1 lds
  s_add_u32 s80, s80, 4096
  s_add_u32 m0, s82, 131072
  s_waitcnt vmcnt(7)
  buffer_load_dwordx4 v1, s[12:15], s80 offen offset:0 sc1 lds
  buffer_load_dwordx4 v1, s[12:15], s80 offen offset:1024 sc1 lds
  s_waitcnt vmcnt(7)
  buffer_load_dwordx4 v1, s[12:15], s80 offen offset:2048 sc1 lds
  buffer_load_dwordx4 v1, s[12:15], s80 offen offset:3072 sc1 lds
  v_mfma_f32_16x16x32_bf16 v[192:195], v[16:19], v[160:163], 0
  v_mfma_f32_16x16x32_bf16 v[192:195], v[32:35], v[164:167], v[192:195]
  v_mfma_f32_16x16x32_bf16 v[196:199], v[36:39], v[164:167], 0
  v_mfma_f32_16x16x32_bf16 v[196:199], v[20:23], v[160:163], v[196:199]
  v_mfma_f32_16x16x32_bf16 v[200:203], v[24:27], v[160:163], 0
  v_mfma_f32_16x16x32_bf16 v[200:203], v[40:43], v[164:167], v[200:203]
  v_mfma_f32_16x16x32_bf16 v[204:207], v[44:47], v[164:167], 0
  v_mfma_f32_16x16x32_bf16 v[204:207], v[28:31], v[160:163], v[204:207]
  s_waitcnt lgkmcnt(0)
  s_bitcmp0_b32 s89, 6
  s_cbranch_scc0 L_sr_85
L_sp_84:
  s_add_u32 s86, s86, 1
  s_cmp_gt_u32 s86, 1048576
  s_cbranch_scc1 L_sr_85
  s_mov_b32 s89, 0
  s_atomic_add s89, s[98:99], 0 glc
  s_waitcnt lgkmcnt(0)
  s_bitcmp0_b32 s89, 6
  s_cbranch_scc1 L_sp_84
L_sr_85:
  s_add_u32 s79, s79, 4096
  buffer_load_dwordx4 v[164:167], v1, s[12:15], s79 offen offset:0 sc1
  v_mfma_f32_16x16x32_bf16 v[220:223], v[28:31], v[168:171], 0
  v_mfma_f32_16x16x32_bf16 v[220:223], v[44:47], v[172:175], v[220:223]
  s_bitcmp1_b32 s89, 10
  s_cbranch_scc1 L_np_102
  s_mov_b32 s89, 0
  s_atomic_add s89, s[98:99], 0 glc
L_np_102:
  buffer_load_dwordx4 v[160:163], v1, s[12:15], s79 offen offset:1024 sc1
  v_mfma_f32_16x16x32_bf16 v[216:219], v[40:43], v[172:175], 0
  v_mfma_f32_16x16x32_bf16 v[216:219], v[24:27], v[168:171], v[216:219]
  v_mfma_f32_16x16x32_bf16 v[212:215], v[20:23], v[168:171], 0
  v_mfma_f32_16x16x32_bf16 v[212:215], v[36:39], v[172:175], v[212:215]
  v_mfma_f32_16x16x32_bf16 v[208:211], v[32:35], v[172:175], 0
  v_mfma_f32_16x16x32_bf16 v[208:211], v[16:19], v[168:171], v[208:211]
  buffer_load_dwordx4 v[172:175], v1, s[12:15], s79 offen offset:2048 sc1
  v_mfma_f32_16x16x32_bf16 v[224:227], v[16:19], v[176:179], 0
  v_mfma_f32_16x16x32_bf16 v[224:227], v[32:35], v[180:183], v[224:227]
  buffer_load_dwordx4 v[168:171], v1, s[12:15], s79 offen offset:3072 sc1
  v_mfma_f32_16x16x32_bf16 v[228:231], v[36:39], v[180:183], 0
  v_mfma_f32_16x16x32_bf16 v[228:231], v[20:23], v[176:179], v[228:231]
  v_mfma_f32_16x16x32_bf16 v[232:235], v[24:27], v[176:179], 0
  v_mfma_f32_16x16x32_bf16 v[232:235], v[40:43], v[180:183], v[232:235]
  v_mfma_f32_16x16x32_bf16 v[236:239], v[44:47], v[180:183], 0
  v_mfma_f32_16x16x32_bf16 v[236:239], v[28:31], v[176:179], v[236:239]
  s_add_u32 s79, s79, 4096
  buffer_load_dwordx4 v[180:183], v1, s[12:15], s79 offen offset:0 sc1
  v_mfma_f32_16x16x32_bf16 v[252:255], v[28:31], v[184:187], 0
  v_mfma_f32_16x16x32_bf16 v[252:255], v[44:47], v[188:191], v[252:255]
  buffer_load_dwordx4 v[176:179], v1, s[12:15], s79 offen offset:1024 sc1
  v_mfma_f32_16x16x32_bf16 v[248:251], v[40:43], v[188:191], 0
  v_mfma_f32_16x16x32_bf16 v[248:251], v[24:27], v[184:187], v[248:251]
  buffer_load_dwordx4 v[28:31], v1, s[12:15], s79 offen offset:2048 sc1
  v_mfma_f32_16x16x32_bf16 v[244:247], v[20:23], v[184:187], 0
  v_mfma_f32_16x16x32_bf16 v[244:247], v[36:39], v[188:191], v[244:247]
  buffer_load_dwordx4 v[44:47], v1, s[12:15], s79 offen offset:3072 sc1
  v_mfma_f32_16x16x32_bf16 v[240:243], v[32:35], v[188:191], 0
  v_mfma_f32_16x16x32_bf16 v[240:243], v[16:19], v[184:187], v[240:243]
  s_waitcnt lgkmcnt(0)
  s_bitcmp0_b32 s89, 10
  s_cbranch_scc0 L_sr_87
L_sp_86:
  s_add_u32 s86, s86, 1
  s_cmp_gt_u32 s86, 1048576
  s_cbranch_scc1 L_sr_87
  s_mov_b32 s89, 0
  s_atomic_add s89, s[98:99], 0 glc
  s_waitcnt lgkmcnt(0)
  s_bitcmp0_b32 s89, 10
  s_cbranch_scc1 L_sp_86
L_sr_87:
  s_add_u32 s79, s79, 4096
  buffer_load_dwordx4 v[40:43], v1, s[12:15], s79 offen offset:0 sc1
  s_waitcnt vmcnt(7)
  v_mfma_f32_16x16x32_bf16 v[192:195], v[48:51], v[164:167], v[192:195]
  v_mfma_f32_16x16x32_bf16 v[192:195], v[64:67], v[160:163], v[192:195]
  s_add_u32 s80, s80, 4096
  buffer_load_dwordx4 v[24:27], v1, s[12:15], s80 offen offset:0 sc1
  v_mfma_f32_16x16x32_bf16 v[196:199], v[68:71], v[160:163], v[196:199]
  v_mfma_f32_16x16x32_bf16 v[196:199], v[52:55], v[164:167], v[196:199]
  s_bitcmp1_b32 s89, 14
  s_cbranch_scc1 L_np_101
  s_mov_b32 s89, 0
  s_atomic_add s89, s[98:99], 0 glc
L_np_101:
  buffer_load_dwordx4 v[20:23], v1, s[12:15], s79 offen offset:1024 sc1
  v_mfma_f32_16x16x32_bf16 v[200:203], v[56:59], v[164:167], v[200:203]
  v_mfma_f32_16x16x32_bf16 v[200:203], v[72:75], v[160:163], v[200:203]
  buffer_load_dwordx4 v[36:39], v1, s[12:15], s79 offen offset:2048 sc1
  v_mfma_f32_16x16x32_bf16 v[204:207], v[76:79], v[160:163], v[204:207]
  v_mfma_f32_16x16x32_bf16 v[204:207], v[60:63], v[164:167], v[204:207]
  buffer_load_dwordx4 v[188:191], v1, s[12:15], s80 offen offset:1024 sc1
  s_waitcnt vmcnt(9)
  v_mfma_f32_16x16x32_bf16 v[220:223], v[60:63], v[172:175], v[220:223]
  v_mfma_f32_16x16x32_bf16 v[220:223], v[76:79], v[168:171], v[220:223]
  buffer_load_dwordx4 v[32:35], v1, s[12:15], s79 offen offset:3072 sc1
  v_mfma_f32_16x16x32_bf16 v[216:219], v[72:75], v[168:171], v[216:219]
  v_mfma_f32_16x16x32_bf16 v[216:219], v[56:59], v[172:175], v[216:219]
  s_add_u32 s79, s79, 4096
  buffer_load_dwordx4 v[184:187], v1, s[12:15], s79 offen offset:0 sc1
  v_mfma_f32_16x16x32_bf16 v[212:215], v[52:55], v[172:175], v[212:215]
  v_mfma_f32_16x16x32_bf16 v[212:215], v[68:71], v[168:171], v[212:215]
  buffer_load_dwordx4 v[16:19], v1, s[12:15], s80 offen offset:2048 sc1
  v_mfma_f32_16x16x32_bf16 v[208:211], v[64:67], v[168:171], v[208:211]
  v_mfma_f32_16x16x32_bf16 v[208:211], v[48:51], v[172:175], v[208:211]
  buffer_load_dwordx4 v[160:163], v1, s[12:15], s79 offen offset:1024 sc1
  s_waitcnt vmcnt(11)
  v_mfma_f32_16x16x32_bf16 v[224:227], v[48:51], v[180:183], v[224:227]
  v_mfma_f32_16x16x32_bf16 v[224:227], v[64:67], v[176:179], v[224:227]
  buffer_load_dwordx4 v[164:167], v1, s[12:15], s79 offen offset:2048 sc1
  v_mfma_f32_16x16x32_bf16 v[228:231], v[68:71], v[176:179], v[228:231]
  v_mfma_f32_16x16x32_bf16 v[228:231], v[52:55], v[180:183], v[228:231]
  v_mfma_f32_16x16x32_bf16 v[232:235], v[56:59], v[180:183], v[232:235]
  v_mfma_f32_16x16x32_bf16 v[232:235], v[72:75], v[176:179], v[232:235]
  v_mfma_f32_16x16x32_bf16 v[236:239], v[76:79], v[176:179], v[236:239]
  v_mfma_f32_16x16x32_bf16 v[236:239], v[60:63], v[180:183], v[236:239]
  buffer_load_dwordx4 v[168:171], v1, s[12:15], s80 offen offset:3072 sc1
  s_waitcnt vmcnt(11)
  v_mfma_f32_16x16x32_bf16 v[252:255], v[60:63], v[28:31], v[252:255]
  v_mfma_f32_16x16x32_bf16 v[252:255], v[76:79], v[44:47], v[252:255]
  buffer_load_dwordx4 v[172:175], v1, s[12:15], s79 offen offset:3072 sc1
  v_mfma_f32_16x16x32_bf16 v[248:251], v[72:75], v[44:47], v[248:251]
  v_mfma_f32_16x16x32_bf16 v[248:251], v[56:59], v[28:31], v[248:251]
  v_mfma_f32_16x16x32_bf16 v[244:247], v[52:55], v[28:31], v[244:247]
  v_mfma_f32_16x16x32_bf16 v[244:247], v[68:71], v[44:47], v[244:247]
  v_mfma_f32_16x16x32_bf16 v[240:243], v[64:67], v[44:47], v[240:243]
  v_mfma_f32_16x16x32_bf16 v[240:243], v[48:51], v[28:31], v[240:243]
  s_waitcnt lgkmcnt(0)
  s_bitcmp0_b32 s89, 14
  s_cbranch_scc0 L_sr_89
L_sp_88:
  s_add_u32 s86, s86, 1
  s_cmp_gt_u32 s86, 1048576
  s_cbranch_scc1 L_sr_89
  s_mov_b32 s89, 0
  s_atomic_add s89, s[98:99], 0 glc
  s_waitcnt lgkmcnt(0)
  s_bitcmp0_b32 s89, 14
  s_cbranch_scc1 L_sp_88
L_sr_89:
  s_add_u32 s79, s79, 4096
  buffer_load_dwordx4 v[176:179], v1, s[12:15], s79 offen offset:0 sc1
  s_waitcnt vmcnt(10)
  v_mfma_f32_16x16x32_bf16 v[192:195], v[80:83], v[40:43], v[192:195]
  v_mfma_f32_16x16x32_bf16 v[192:195], v[96:99], v[20:23], v[192:195]
  s_add_u32 s80, s80, 4096
  buffer_load_dwordx4 v[180:183], v1, s[12:15], s80 offen offset:0 sc1
  v_mfma_f32_16x16x32_bf16 v[196:199], v[100:103], v[20:23], v[196:199]
  v_mfma_f32_16x16x32_bf16 v[196:199], v[84:87], v[40:43], v[196:199]
  s_bitcmp1_b32 s89, 18
  s_cbranch_scc1 L_np_100
  s_mov_b32 s89, 0
  s_atomic_add s89, s[98:99], 0 glc
L_np_100:
  buffer_load_dwordx4 v[60:63], v1, s[12:15], s79 offen offset:1024 sc1
  v_mfma_f32_16x16x32_bf16 v[200:203], v[88:91], v[40:43], v[200:203]
  v_mfma_f32_16x16x32_bf16 v[200:203], v[104:107], v[20:23], v[200:203]
  v_mfma_f32_16x16x32_bf16 v[204:207], v[108:111], v[20:23], v[204:207]
  v_mfma_f32_16x16x32_bf16 v[204:207], v[92:95], v[40:43], v[204:207]
  buffer_load_dwordx4 v[76:79], v1, s[12:15], s79 offen offset:2048 sc1
  s_waitcnt vmcnt(10)
  v_mfma_f32_16x16x32_bf16 v[220:223], v[92:95], v[36:39], v[220:223]
  v_mfma_f32_16x16x32_bf16 v[220:223], v[108:111], v[32:35], v[220:223]
  buffer_load_dwordx4 v[72:75], v1, s[12:15], s80 offen offset:1024 sc1
  v_mfma_f32_16x16x32_bf16 v[216:219], v[104:107], v[32:35], v[216:219]
  v_mfma_f32_16x16x32_bf16 v[216:219], v[88:91], v[36:39], v[216:219]
  buffer_load_dwordx4 v[56:59], v1, s[12:15], s79 offen offset:3072 sc1
  v_mfma_f32_16x16x32_bf16 v[212:215], v[84:87], v[36:39], v[212:215]
  v_mfma_f32_16x16x32_bf16 v[212:215], v[100:103], v[32:35], v[212:215]
  v_mfma_f32_16x16x32_bf16 v[208:211], v[96:99], v[32:35], v[208:211]
  v_mfma_f32_16x16x32_bf16 v[208:211], v[80:83], v[36:39], v[208:211]
  s_add_u32 s79, s79, 4096
  buffer_load_dwordx4 v[52:55], v1, s[12:15], s79 offen offset:0 sc1
  s_waitcnt vmcnt(10)
  v_mfma_f32_16x16x32_bf16 v[224:227], v[80:83], v[184:187], v[224:227]
  v_mfma_f32_16x16x32_bf16 v[224:227], v[96:99], v[160:163], v[224:227]
  buffer_load_dwordx4 v[68:71], v1, s[12:15], s80 offen offset:2048 sc1
  v_mfma_f32_16x16x32_bf16 v[228:231], v[100:103], v[160:163], v[228:231]
  v_mfma_f32_16x16x32_bf16 v[228:231], v[84:87], v[184:187], v[228:231]
  buffer_load_dwordx4 v[44:47], v1, s[12:15], s79 offen offset:1024 sc1
  v_mfma_f32_16x16x32_bf16 v[232:235], v[88:91], v[184:187], v[232:235]
  v_mfma_f32_16x16x32_bf16 v[232:235], v[104:107], v[160:163], v[232:235]
  v_mfma_f32_16x16x32_bf16 v[236:239], v[108:111], v[160:163], v[236:239]
  v_mfma_f32_16x16x32_bf16 v[236:239], v[92:95], v[184:187], v[236:239]
  buffer_load_dwordx4 v[64:67], v1, s[12:15], s79 offen offset:2048 sc1
  s_waitcnt vmcnt(10)
  v_mfma_f32_16x16x32_bf16 v[252:255], v[92:95], v[164:167], v[252:255]
  v_mfma_f32_16x16x32_bf16 v[252:255], v[108:111], v[172:175], v[252:255]
  buffer_load_dwordx4 v[28:31], v1, s[12:15], s80 offen offset:3072 sc1
  v_mfma_f32_16x16x32_bf16 v[248:251], v[104:107], v[172:175], v[248:251]
  v_mfma_f32_16x16x32_bf16 v[248:251], v[88:91], v[164:167], v[248:251]
  buffer_load_dwordx4 v[48:51], v1, s[12:15], s79 offen offset:3072 sc1
  v_mfma_f32_16x16x32_bf16 v[244:247], v[84:87], v[164:167], v[244:247]
  v_mfma_f32_16x16x32_bf16 v[244:247], v[100:103], v[172:175], v[244:247]
  v_mfma_f32_16x16x32_bf16 v[240:243], v[96:99], v[172:175], v[240:243]
  v_mfma_f32_16x16x32_bf16 v[240:243], v[80:83], v[164:167], v[240:243]
  s_waitcnt lgkmcnt(0)
  s_bitcmp0_b32 s89, 18
  s_cbranch_scc0 L_sr_91
L_sp_90:
  s_add_u32 s86, s86, 1
  s_cmp_gt_u32 s86, 1048576
  s_cbranch_scc1 L_sr_91
  s_mov_b32 s89, 0
  s_atomic_add s89, s[98:99], 0 glc
  s_waitcnt lgkmcnt(0)
  s_bitcmp0_b32 s89, 18
  s_cbranch_scc1 L_sp_90
L_sr_91:
  s_add_u32 s79, s79, 4096
  buffer_load_dwordx4 v[20:23], v1, s[12:15], s79 offen offset:0 sc1
  s_waitcnt vmcnt(10)
  v_mfma_f32_16x16x32_bf16 v[192:195], v[112:115], v[176:179], v[192:195]
  v_mfma_f32_16x16x32_bf16 v[192:195], v[128:131], v[60:63], v[192:195]
  ds_read_b128 v[40:43], v12 offset:0
  ds_read_b128 v[32:35], v12 offset:1024
  v_mfma_f32_16x16x32_bf16 v[196:199], v[132:135], v[60:63], v[196:199]
  v_mfma_f32_16x16x32_bf16 v[196:199], v[116:119], v[176:179], v[196:199]
  s_bitcmp1_b32 s89, 22
  s_cbranch_scc1 L_np_99
  s_mov_b32 s89, 0
  s_atomic_add s89, s[98:99], 0 glc
L_np_99:
  ds_read_b128 v[36:39], v12 offset:2048
  ds_read_b128 v[160:163], v12 offset:3072
  v_mfma_f32_16x16x32_bf16 v[200:203], v[120:123], v[176:179], v[200:203]
  v_mfma_f32_16x16x32_bf16 v[200:203], v[136:139], v[60:63], v[200:203]
  s_add_u32 s80, s80, 4096
  buffer_load_dwordx4 v[184:187], v1, s[12:15], s80 offen offset:0 sc1
  v_mfma_f32_16x16x32_bf16 v[204:207], v[140:143], v[60:63], v[204:207]
  v_mfma_f32_16x16x32_bf16 v[204:207], v[124:127], v[176:179], v[204:207]
  buffer_load_dwordx4 v[92:95], v1, s[12:15], s79 offen offset:1024 sc1
  s_waitcnt vmcnt(9)
  v_mfma_f32_16x16x32_bf16 v[220:223], v[124:127], v[76:79], v[220:223]
  v_mfma_f32_16x16x32_bf16 v[220:223], v[140:143], v[56:59], v[220:223]
  buffer_load_dwordx4 v[108:111], v1, s[12:15], s79 offen offset:2048 sc1
  v_mfma_f32_16x16x32_bf16 v[216:219], v[136:139], v[56:59], v[216:219]
  v_mfma_f32_16x16x32_bf16 v[216:219], v[120:123], v[76:79], v[216:219]
  buffer_load_dwordx4 v[104:107], v1, s[12:15], s80 offen offset:1024 sc1
  v_mfma_f32_16x16x32_bf16 v[212:215], v[116:119], v[76:79], v[212:215]
  v_mfma_f32_16x16x32_bf16 v[212:215], v[132:135], v[56:59], v[212:215]
  buffer_load_dwordx4 v[88:91], v1, s[12:15], s79 offen offset:3072 sc1
  v_mfma_f32_16x16x32_bf16 v[208:211], v[128:131], v[56:59], v[208:211]
  v_mfma_f32_16x16x32_bf16 v[208:211], v[112:115], v[76:79], v[208:211]
  s_add_u32 s79, s79, 4096
  buffer_load_dwordx4 v[84:87], v1, s[12:15], s79 offen offset:0 sc1
  s_waitcnt vmcnt(10)
  v_mfma_f32_16x16x32_bf16 v[224:227], v[112:115], v[52:55], v[224:227]
  v_mfma_f32_16x16x32_bf16 v[224:227], v[128:131], v[44:47], v[224:227]
  ds_read_b128 v[100:103], v12 offset:4096
  ds_read_b128 v[172:175], v12 offset:5120
  v_mfma_f32_16x16x32_bf16 v[228:231], v[132:135], v[44:47], v[228:231]
  v_mfma_f32_16x16x32_bf16 v[228:231], v[116:119], v[52:55], v[228:231]
  ds_read_b128 v[96:99], v12 offset:6144
  ds_read_b128 v[164:167], v12 offset:7168
  v_mfma_f32_16x16x32_bf16 v[232:235], v[120:123], v[52:55], v[232:235]
  v_mfma_f32_16x16x32_bf16 v[232:235], v[136:139], v[44:47], v[232:235]
  buffer_load_dwordx4 v[80:83], v1, s[12:15], s80 offen offset:2048 sc1
  v_mfma_f32_16x16x32_bf16 v[236:239], v[140:143], v[44:47], v[236:239]
  v_mfma_f32_16x16x32_bf16 v[236:239], v[124:127], v[52:55], v[236:239]
  buffer_load_dwordx4 v[60:63], v1, s[12:15], s79 offen offset:1024 sc1
  s_waitcnt vmcnt(9)
  v_mfma_f32_16x16x32_bf16 v[252:255], v[124:127], v[64:67], v[252:255]
  v_mfma_f32_16x16x32_bf16 v[252:255], v[140:143], v[48:51], v[252:255]
  buffer_load_dwordx4 v[176:179], v1, s[12:15], s79 offen offset:2048 sc1
  v_mfma_f32_16x16x32_bf16 v[248:251], v[136:139], v[48:51], v[248:251]
  v_mfma_f32_16x16x32_bf16 v[248:251], v[120:123], v[64:67], v[248:251]
  buffer_load_dwordx4 v[56:59], v1, s[12:15], s80 offen offset:3072 sc1
  v_mfma_f32_16x16x32_bf16 v[244:247], v[116:119], v[64:67], v[244:247]
  v_mfma_f32_16x16x32_bf16 v[244:247], v[132:135], v[48:51], v[244:247]
  buffer_load_dwordx4 v[76:79], v1, s[12:15], s79 offen offset:3072 sc1
  v_mfma_f32_16x16x32_bf16 v[240:243], v[128:131], v[48:51], v[240:243]
  v_mfma_f32_16x16x32_bf16 v[240:243], v[112:115], v[64:67], v[240:243]
  s_waitcnt lgkmcnt(0)
  s_bitcmp0_b32 s89, 22
  s_cbranch_scc0 L_sr_93
L_sp_92:
  s_add_u32 s86, s86, 1
  s_cmp_gt_u32 s86, 1048576
  s_cbranch_scc1 L_sr_93
  s_mov_b32 s89, 0
  s_atomic_add s89, s[98:99], 0 glc
  s_waitcnt lgkmcnt(0)
  s_bitcmp0_b32 s89, 22
  s_cbranch_scc1 L_sp_92
L_sr_93:
  s_add_u32 s79, s79, 4096
  buffer_load_dwordx4 v[44:47], v1, s[12:15], s79 offen offset:0 sc1
  s_waitcnt vmcnt(10)
  v_mfma_f32_16x16x32_bf16 v[192:195], v[144:147], v[20:23], v[192:195]
  v_mfma_f32_16x16x32_bf16 v[192:195], v[40:43], v[92:95], v[192:195]
  ds_read_b128 v[52:55], v12 offset:8192
  ds_read_b128 v[124:127], v12 offset:9216
  v_mfma_f32_16x16x32_bf16 v[196:199], v[32:35], v[92:95], v[196:199]
  v_mfma_f32_16x16x32_bf16 v[196:199], v[148:151], v[20:23], v[196:199]
  s_bitcmp1_b32 s89, 30
  s_cbranch_scc1 L_np_98
  s_mov_b32 s89, 0
  s_atomic_add s89, s[98:99], 0 glc
L_np_98:
  ds_read_b128 v[140:143], v12 offset:10240
  ds_read_b128 v[136:139], v12 offset:11264
  v_mfma_f32_16x16x32_bf16 v[200:203], v[152:155], v[20:23], v[200:203]
  v_mfma_f32_16x16x32_bf16 v[200:203], v[36:39], v[92:95], v[200:203]
  s_add_u32 s80, s80, 4096
  buffer_load_dwordx4 v[120:123], v1, s[12:15], s80 offen offset:0 sc1
  v_mfma_f32_16x16x32_bf16 v[204:207], v[160:163], v[92:95], v[204:207]
  v_mfma_f32_16x16x32_bf16 v[204:207], v[156:159], v[20:23], v[204:207]
  buffer_load_dwordx4 v[116:119], v1, s[12:15], s79 offen offset:1024 sc1
  s_waitcnt vmcnt(9)
  v_mfma_f32_16x16x32_bf16 v[220:223], v[156:159], v[108:111], v[220:223]
  v_mfma_f32_16x16x32_bf16 v[220:223], v[160:163], v[88:91], v[220:223]
  buffer_load_dwordx4 v[132:135], v1, s[12:15], s79 offen offset:2048 sc1
  v_mfma_f32_16x16x32_bf16 v[216:219], v[36:39], v[88:91], v[216:219]
  v_mfma_f32_16x16x32_bf16 v[216:219], v[152:155], v[108:111], v[216:219]
  buffer_load_dwordx4 v[48:51], v1, s[12:15], s80 offen offset:1024 sc1
  v_mfma_f32_16x16x32_bf16 v[212:215], v[148:151], v[108:111], v[212:215]
  v_mfma_f32_16x16x32_bf16 v[212:215], v[32:35], v[88:91], v[212:215]
  buffer_load_dwordx4 v[128:131], v1, s[12:15], s79 offen offset:3072 sc1
  v_mfma_f32_16x16x32_bf16 v[208:211], v[40:43], v[88:91], v[208:211]
  v_mfma_f32_16x16x32_bf16 v[208:211], v[144:147], v[108:111], v[208:211]
  s_add_u32 s79, s79, 4096
  buffer_load_dwordx4 v[64:67], v1, s[12:15], s79 offen offset:0 sc1
  s_waitcnt vmcnt(10)
  v_mfma_f32_16x16x32_bf16 v[224:227], v[144:147], v[84:87], v[224:227]
  v_mfma_f32_16x16x32_bf16 v[224:227], v[40:43], v[60:63], v[224:227]
  ds_read_b128 v[112:115], v12 offset:12288
  ds_read_b128 v[92:95], v12 offset:13312
  v_mfma_f32_16x16x32_bf16 v[228:231], v[32:35], v[60:63], v[228:231]
  v_mfma_f32_16x16x32_bf16 v[228:231], v[148:151], v[84:87], v[228:231]
  ds_read_b128 v[20:23], v12 offset:14336
  ds_read_b128 v[88:91], v12 offset:15360
  v_mfma_f32_16x16x32_bf16 v[232:235], v[152:155], v[84:87], v[232:235]
  v_mfma_f32_16x16x32_bf16 v[232:235], v[36:39], v[60:63], v[232:235]
  buffer_load_dwordx4 v[108:111], v1, s[12:15], s80 offen offset:2048 sc1
  v_mfma_f32_16x16x32_bf16 v[236:239], v[160:163], v[60:63], v[236:239]
  v_mfma_f32_16x16x32_bf16 v[236:239], v[156:159], v[84:87], v[236:239]
  buffer_load_dwordx4 v[60:63], v1, s[12:15], s79 offen offset:1024 sc1
  s_waitcnt vmcnt(9)
  v_mfma_f32_16x16x32_bf16 v[252:255], v[156:159], v[176:179], v[252:255]
  v_mfma_f32_16x16x32_bf16 v[252:255], v[160:163], v[76:79], v[252:255]
  buffer_load_dwordx4 v[84:87], v1, s[12:15], s79 offen offset:2048 sc1
  v_mfma_f32_16x16x32_bf16 v[248:251], v[36:39], v[76:79], v[248:251]
  v_mfma_f32_16x16x32_bf16 v[248:251], v[152:155], v[176:179], v[248:251]
  buffer_load_dwordx4 v[156:159], v1, s[12:15], s80 offen offset:3072 sc1
  v_mfma_f32_16x16x32_bf16 v[244:247], v[148:151], v[176:179], v[244:247]
  v_mfma_f32_16x16x32_bf16 v[244:247], v[32:35], v[76:79], v[244:247]
  buffer_load_dwordx4 v[160:163], v1, s[12:15], s79 offen offset:3072 sc1
  v_mfma_f32_16x16x32_bf16 v[240:243], v[40:43], v[76:79], v[240:243]
  v_mfma_f32_16x16x32_bf16 v[240:243], v[144:147], v[176:179], v[240:243]
  s_waitcnt lgkmcnt(0)
  s_bitcmp0_b32 s89, 26
  s_cbranch_scc0 L_sr_95
L_sp_94:
  s_add_u32 s86, s86, 1
  s_cmp_gt_u32 s86, 1048576
  s_cbranch_scc1 L_sr_95
  s_mov_b32 s89, 0
  s_atomic_add s89, s[98:99], 0 glc
  s_waitcnt lgkmcnt(0)
  s_bitcmp0_b32 s89, 26
  s_cbranch_scc1 L_sp_94
L_sr_95:
  s_add_u32 s79, s79, 4096
  buffer_load_dwordx4 v[36:39], v1, s[12:15], s79 offen offset:0 sc1
  s_waitcnt vmcnt(10)
  v_mfma_f32_16x16x32_bf16 v[192:195], v[100:103], v[44:47], v[192:195]
  v_mfma_f32_16x16x32_bf16 v[192:195], v[52:55], v[116:119], v[192:195]
  ds_read_b128 v[152:155], v13 offset:0
  ds_read_b128 v[148:151], v13 offset:1024
  v_mfma_f32_16x16x32_bf16 v[196:199], v[124:127], v[116:119], v[196:199]
  v_mfma_f32_16x16x32_bf16 v[196:199], v[172:175], v[44:47], v[196:199]
  ds_read_b128 v[32:35], v13 offset:2048
  ds_read_b128 v[76:79], v13 offset:3072
  v_mfma_f32_16x16x32_bf16 v[200:203], v[96:99], v[44:47], v[200:203]
  v_mfma_f32_16x16x32_bf16 v[200:203], v[140:143], v[116:119], v[200:203]
  buffer_load_dwordx4 v[40:43], v1, s[12:15], s79 offen offset:1024 sc1
  v_mfma_f32_16x16x32_bf16 v[204:207], v[136:139], v[116:119], v[204:207]
  v_mfma_f32_16x16x32_bf16 v[204:207], v[164:167], v[44:47], v[204:207]
  s_bitcmp0_b32 s89, 30
  s_cbranch_scc0 L_sr_97
L_sp_96:
  s_add_u32 s86, s86, 1
  s_cmp_gt_u32 s86, 1048576
  s_cbranch_scc1 L_sr_97
  s_mov_b32 s89, 0
  s_atomic_add s89, s[98:99], 0 glc
  s_waitcnt lgkmcnt(0)
  s_bitcmp0_b32 s89, 30
  s_cbranch_scc1 L_sp_96
L_sr_97:
  s_add_u32 s79, s79, 8192
  buffer_load_dwordx4 v[176:179], v1, s[12:15], s79 offen offset:0 sc1
  s_waitcnt vmcnt(9)
  v_mfma_f32_16x16x32_bf16 v[220:223], v[164:167], v[132:135], v[220:223]
  v_mfma_f32_16x16x32_bf16 v[220:223], v[136:139], v[128:131], v[220:223]
  buffer_load_dwordx4 v[144:147], v1, s[12:15], s79 offen offset:1024 sc1
  v_mfma_f32_16x16x32_bf16 v[216:219], v[140:143], v[128:131], v[216:219]
  v_mfma_f32_16x16x32_bf16 v[216:219], v[96:99], v[132:135], v[216:219]
  buffer_load_dwordx4 v[116:119], v1, s[12:15], s79 offen offset:2048 sc1
  v_mfma_f32_16x16x32_bf16 v[212:215], v[172:175], v[132:135], v[212:215]
  v_mfma_f32_16x16x32_bf16 v[212:215], v[124:127], v[128:131], v[212:215]
  buffer_load_dwordx4 v[44:47], v1, s[12:15], s79 offen offset:3072 sc1
  v_mfma_f32_16x16x32_bf16 v[208:211], v[52:55], v[128:131], v[208:211]
  v_mfma_f32_16x16x32_bf16 v[208:211], v[100:103], v[132:135], v[208:211]
  s_sub_u32 s79, s79, 8192
  buffer_load_dwordx4 v[128:131], v1, s[12:15], s79 offen offset:2048 sc1
  s_waitcnt vmcnt(10)
  v_mfma_f32_16x16x32_bf16 v[224:227], v[100:103], v[64:67], v[224:227]
  v_mfma_f32_16x16x32_bf16 v[224:227], v[52:55], v[60:63], v[224:227]
  buffer_load_dwordx4 v[132:135], v1, s[12:15], s79 offen offset:3072 sc1
  v_mfma_f32_16x16x32_bf16 v[228:231], v[124:127], v[60:63], v[228:231]
  v_mfma_f32_16x16x32_bf16 v[228:231], v[172:175], v[64:67], v[228:231]
  v_mfma_f32_16x16x32_bf16 v[232:235], v[96:99], v[64:67], v[232:235]
  v_mfma_f32_16x16x32_bf16 v[232:235], v[140:143], v[60:63], v[232:235]
  v_mfma_f32_16x16x32_bf16 v[236:239], v[136:139], v[60:63], v[236:239]
  v_mfma_f32_16x16x32_bf16 v[236:239], v[164:167], v[64:67], v[236:239]
  s_add_u32 s79, s79, 12288
  buffer_load_dwordx4 v[60:63], v1, s[12:15], s79 offen offset:0 sc1
  s_waitcnt vmcnt(9)
  v_mfma_f32_16x16x32_bf16 v[252:255], v[164:167], v[84:87], v[252:255]
  v_mfma_f32_16x16x32_bf16 v[252:255], v[136:139], v[160:163], v[252:255]
  buffer_load_dwordx4 v[64:67], v1, s[12:15], s79 offen offset:1024 sc1
  v_mfma_f32_16x16x32_bf16 v[248:251], v[140:143], v[160:163], v[248:251]
  v_mfma_f32_16x16x32_bf16 v[248:251], v[96:99], v[84:87], v[248:251]
  buffer_load_dwordx4 v[164:167], v1, s[12:15], s79 offen offset:2048 sc1
  v_mfma_f32_16x16x32_bf16 v[244:247], v[172:175], v[84:87], v[244:247]
  v_mfma_f32_16x16x32_bf16 v[244:247], v[124:127], v[160:163], v[244:247]
  buffer_load_dwordx4 v[136:139], v1, s[12:15], s79 offen offset:3072 sc1
  v_mfma_f32_16x16x32_bf16 v[240:243], v[52:55], v[160:163], v[240:243]
  v_mfma_f32_16x16x32_bf16 v[240:243], v[100:103], v[84:87], v[240:243]
  s_sub_u32 s79, s79, 8192
  buffer_load_dwordx4 v[140:143], v1, s[12:15], s79 offen offset:0 sc1
  s_waitcnt vmcnt(11) lgkmcnt(3)
  v_mfma_f32_16x16x32_bf16 v[192:195], v[112:115], v[36:39], v[192:195]
  v_mfma_f32_16x16x32_bf16 v[192:195], v[152:155], v[40:43], v[192:195]
  buffer_load_dwordx4 v[96:99], v1, s[12:15], s79 offen offset:1024 sc1
  s_waitcnt lgkmcnt(2)
  v_mfma_f32_16x16x32_bf16 v[196:199], v[148:151], v[40:43], v[196:199]
  v_mfma_f32_16x16x32_bf16 v[196:199], v[92:95], v[36:39], v[196:199]
  s_waitcnt lgkmcnt(1)
  v_mfma_f32_16x16x32_bf16 v[200:203], v[20:23], v[36:39], v[200:203]
  v_mfma_f32_16x16x32_bf16 v[200:203], v[32:35], v[40:43], v[200:203]
  s_waitcnt lgkmcnt(0)
  v_mfma_f32_16x16x32_bf16 v[204:207], v[76:79], v[40:43], v[204:207]
  v_mfma_f32_16x16x32_bf16 v[204:207], v[88:91], v[36:39], v[204:207]
  s_add_u32 s79, s79, 12288
  buffer_load_dwordx4 v[172:175], v1, s[12:15], s79 offen offset:0 sc1
  s_waitcnt vmcnt(11)
  v_mfma_f32_16x16x32_bf16 v[192:195], v[24:27], v[176:179], v[192:195]
  v_mfma_f32_16x16x32_bf16 v[192:195], v[180:183], v[144:147], v[192:195]
  buffer_load_dwordx4 v[124:127], v1, s[12:15], s79 offen offset:1024 sc1
  v_mfma_f32_16x16x32_bf16 v[196:199], v[72:75], v[144:147], v[196:199]
  v_mfma_f32_16x16x32_bf16 v[196:199], v[188:191], v[176:179], v[196:199]
  v_mfma_f32_16x16x32_bf16 v[200:203], v[16:19], v[176:179], v[200:203]
  v_mfma_f32_16x16x32_bf16 v[200:203], v[68:71], v[144:147], v[200:203]
  v_mfma_f32_16x16x32_bf16 v[204:207], v[28:31], v[144:147], v[204:207]
  v_mfma_f32_16x16x32_bf16 v[204:207], v[168:171], v[176:179], v[204:207]
  buffer_load_dwordx4 v[160:163], v1, s[12:15], s79 offen offset:2048 sc1
  s_waitcnt vmcnt(11)
  v_mfma_f32_16x16x32_bf16 v[192:195], v[184:187], v[116:119], v[192:195]
  v_mfma_f32_16x16x32_bf16 v[192:195], v[120:123], v[44:47], v[192:195]
  buffer_load_dwordx4 v[52:55], v1, s[12:15], s79 offen offset:3072 sc1
  v_mfma_f32_16x16x32_bf16 v[196:199], v[48:51], v[44:47], v[196:199]
  v_mfma_f32_16x16x32_bf16 v[196:199], v[104:107], v[116:119], v[196:199]
  v_mfma_f32_16x16x32_bf16 v[200:203], v[80:83], v[116:119], v[200:203]
  v_mfma_f32_16x16x32_bf16 v[200:203], v[108:111], v[44:47], v[200:203]
  v_mfma_f32_16x16x32_bf16 v[204:207], v[156:159], v[44:47], v[204:207]
  v_mfma_f32_16x16x32_bf16 v[204:207], v[56:59], v[116:119], v[204:207]
  s_sub_u32 s79, s79, 12288
  buffer_load_dwordx4 v[84:87], v1, s[12:15], s79 offen offset:2048 sc1
  s_waitcnt vmcnt(11)
  v_mfma_f32_16x16x32_bf16 v[208:211], v[112:115], v[128:131], v[208:211]
  v_mfma_f32_16x16x32_bf16 v[208:211], v[152:155], v[132:135], v[208:211]
  ds_write_b128 v8, v[192:195] offset:0
  buffer_load_dwordx4 v[100:103], v1, s[12:15], s79 offen offset:3072 sc1
  v_mfma_f32_16x16x32_bf16 v[212:215], v[148:151], v[132:135], v[212:215]
  v_mfma_f32_16x16x32_bf16 v[212:215], v[92:95], v[128:131], v[212:215]
  ds_write_b128 v9, v[196:199] offset:0
  v_mfma_f32_16x16x32_bf16 v[216:219], v[20:23], v[128:131], v[216:219]
  v_mfma_f32_16x16x32_bf16 v[216:219], v[32:35], v[132:135], v[216:219]
  ds_write_b128 v10, v[200:203] offset:0
  v_mfma_f32_16x16x32_bf16 v[220:223], v[76:79], v[132:135], v[220:223]
  v_mfma_f32_16x16x32_bf16 v[220:223], v[88:91], v[128:131], v[220:223]
  ds_write_b128 v11, v[204:207] offset:0
  ds_write_b32 v2, v3 offset:12
  s_add_u32 s79, s79, 16384
  buffer_load_dwordx4 v[40:43], v1, s[12:15], s79 offen offset:0 sc1
  s_waitcnt vmcnt(11)
  v_mfma_f32_16x16x32_bf16 v[208:211], v[24:27], v[60:63], v[208:211]
  v_mfma_f32_16x16x32_bf16 v[208:211], v[180:183], v[64:67], v[208:211]
  buffer_load_dwordx4 v[36:39], v1, s[12:15], s79 offen offset:1024 sc1
  v_mfma_f32_16x16x32_bf16 v[212:215], v[72:75], v[64:67], v[212:215]
  v_mfma_f32_16x16x32_bf16 v[212:215], v[188:191], v[60:63], v[212:215]
  v_mfma_f32_16x16x32_bf16 v[216:219], v[16:19], v[60:63], v[216:219]
  v_mfma_f32_16x16x32_bf16 v[216:219], v[68:71], v[64:67], v[216:219]
  v_mfma_f32_16x16x32_bf16 v[220:223], v[28:31], v[64:67], v[220:223]
  v_mfma_f32_16x16x32_bf16 v[220:223], v[168:171], v[60:63], v[220:223]
  buffer_load_dwordx4 v[144:147], v1, s[12:15], s79 offen offset:2048 sc1
  s_waitcnt vmcnt(11)
  v_mfma_f32_16x16x32_bf16 v[208:211], v[184:187], v[164:167], v[208:211]
  v_mfma_f32_16x16x32_bf16 v[208:211], v[120:123], v[136:139], v[208:211]
  buffer_load_dwordx4 v[176:179], v1, s[12:15], s79 offen offset:3072 sc1
  v_mfma_f32_16x16x32_bf16 v[212:215], v[48:51], v[136:139], v[212:215]
  v_mfma_f32_16x16x32_bf16 v[212:215], v[104:107], v[164:167], v[212:215]
  v_mfma_f32_16x16x32_bf16 v[216:219], v[80:83], v[164:167], v[216:219]
  v_mfma_f32_16x16x32_bf16 v[216:219], v[108:111], v[136:139], v[216:219]
  v_mfma_f32_16x16x32_bf16 v[220:223], v[156:159], v[136:139], v[220:223]
  v_mfma_f32_16x16x32_bf16 v[220:223], v[56:59], v[164:167], v[220:223]
  s_waitcnt vmcnt(10)
  v_mfma_f32_16x16x32_bf16 v[224:227], v[112:115], v[140:143], v[224:227]
  v_mfma_f32_16x16x32_bf16 v[224:227], v[152:155], v[96:99], v[224:227]
  ds_write_b128 v8, v[208:211] offset:4096
  v_mfma_f32_16x16x32_bf16 v[228:231], v[148:151], v[96:99], v[228:231]
  v_mfma_f32_16x16x32_bf16 v[228:231], v[92:95], v[140:143], v[228:231]
  ds_write_b128 v9, v[212:215] offset:4096
  v_mfma_f32_16x16x32_bf16 v[232:235], v[20:23], v[140:143], v[232:235]
  v_mfma_f32_16x16x32_bf16 v[232:235], v[32:35], v[96:99], v[232:235]
  ds_write_b128 v10, v[216:219] offset:4096
  v_mfma_f32_16x16x32_bf16 v[236:239], v[76:79], v[96:99], v[236:239]
  v_mfma_f32_16x16x32_bf16 v[236:239], v[88:91], v[140:143], v[236:239]
  ds_write_b128 v11, v[220:223] offset:4096
  ds_write_b32 v2, v3 offset:8
  s_waitcnt vmcnt(8)
  v_mfma_f32_16x16x32_bf16 v[224:227], v[24:27], v[172:175], v[224:227]
  v_mfma_f32_16x16x32_bf16 v[224:227], v[180:183], v[124:127], v[224:227]
  v_mfma_f32_16x16x32_bf16 v[228:231], v[72:75], v[124:127], v[228:231]
  v_mfma_f32_16x16x32_bf16 v[228:231], v[188:191], v[172:175], v[228:231]
  v_mfma_f32_16x16x32_bf16 v[232:235], v[16:19], v[172:175], v[232:235]
  v_mfma_f32_16x16x32_bf16 v[232:235], v[68:71], v[124:127], v[232:235]
  v_mfma_f32_16x16x32_bf16 v[236:239], v[28:31], v[124:127], v[236:239]
  v_mfma_f32_16x16x32_bf16 v[236:239], v[168:171], v[172:175], v[236:239]
  s_waitcnt vmcnt(6)
  v_mfma_f32_16x16x32_bf16 v[224:227], v[184:187], v[160:163], v[224:227]
  v_mfma_f32_16x16x32_bf16 v[224:227], v[120:123], v[52:55], v[224:227]
  v_mfma_f32_16x16x32_bf16 v[228:231], v[48:51], v[52:55], v[228:231]
  v_mfma_f32_16x16x32_bf16 v[228:231], v[104:107], v[160:163], v[228:231]
  v_mfma_f32_16x16x32_bf16 v[232:235], v[80:83], v[160:163], v[232:235]
  v_mfma_f32_16x16x32_bf16 v[232:235], v[108:111], v[52:55], v[232:235]
  v_mfma_f32_16x16x32_bf16 v[236:239], v[156:159], v[52:55], v[236:239]
  v_mfma_f32_16x16x32_bf16 v[236:239], v[56:59], v[160:163], v[236:239]
  s_waitcnt vmcnt(3)
  v_mfma_f32_16x16x32_bf16 v[240:243], v[112:115], v[84:87], v[240:243]
  v_mfma_f32_16x16x32_bf16 v[240:243], v[152:155], v[100:103], v[240:243]
  v_mfma_f32_16x16x32_bf16 v[240:243], v[24:27], v[40:43], v[240:243]
  ds_write_b128 v8, v[224:227] offset:8192
  v_mfma_f32_16x16x32_bf16 v[244:247], v[188:191], v[40:43], v[244:247]
  v_mfma_f32_16x16x32_bf16 v[244:247], v[148:151], v[100:103], v[244:247]
  v_mfma_f32_16x16x32_bf16 v[244:247], v[92:95], v[84:87], v[244:247]
  ds_write_b128 v9, v[228:231] offset:8192
  v_mfma_f32_16x16x32_bf16 v[248:251], v[20:23], v[84:87], v[248:251]
  v_mfma_f32_16x16x32_bf16 v[248:251], v[32:35], v[100:103], v[248:251]
  v_mfma_f32_16x16x32_bf16 v[248:251], v[16:19], v[40:43], v[248:251]
  ds_write_b128 v10, v[232:235] offset:8192
  v_mfma_f32_16x16x32_bf16 v[252:255], v[168:171], v[40:43], v[252:255]
  v_mfma_f32_16x16x32_bf16 v[252:255], v[76:79], v[100:103], v[252:255]
  v_mfma_f32_16x16x32_bf16 v[252:255], v[88:91], v[84:87], v[252:255]
  ds_write_b128 v11, v[236:239] offset:8192
  ds_write_b32 v2, v3 offset:4
  s_waitcnt vmcnt(0)
  v_mfma_f32_16x16x32_bf16 v[240:243], v[180:183], v[36:39], v[240:243]
  v_mfma_f32_16x16x32_bf16 v[240:243], v[184:187], v[144:147], v[240:243]
  v_mfma_f32_16x16x32_bf16 v[240:243], v[120:123], v[176:179], v[240:243]
  v_mfma_f32_16x16x32_bf16 v[244:247], v[48:51], v[176:179], v[244:247]
  v_mfma_f32_16x16x32_bf16 v[244:247], v[104:107], v[144:147], v[244:247]
  v_mfma_f32_16x16x32_bf16 v[244:247], v[72:75], v[36:39], v[244:247]
  v_mfma_f32_16x16x32_bf16 v[248:251], v[68:71], v[36:39], v[248:251]
  v_mfma_f32_16x16x32_bf16 v[248:251], v[80:83], v[144:147], v[248:251]
  v_mfma_f32_16x16x32_bf16 v[248:251], v[108:111], v[176:179], v[248:251]
  v_mfma_f32_16x16x32_bf16 v[252:255], v[156:159], v[176:179], v[252:255]
  v_mfma_f32_16x16x32_bf16 v[252:255], v[56:59], v[144:147], v[252:255]
  v_mfma_f32_16x16x32_bf16 v[252:255], v[28:31], v[36:39], v[252:255]
  ds_write_b128 v8, v[240:243] offset:12288
  s_nop 0
  ds_write_b128 v9, v[244:247] offset:12288
  s_nop 1
  ds_write_b128 v10, v[248:251] offset:12288
  s_nop 1
  ds_write_b128 v11, v[252:255] offset:12288
  ds_write_b32 v2, v3 offset:0
  s_endpgm
L_la:
  s_add_u32 s64, s62, 2
  s_and_b32 s64, s64, 7
  s_add_u32 m0, s82, 49152
  s_lshl_b32 s64, s64, 7
  s_waitcnt vmcnt(10)
  buffer_load_dwordx4 v16, s[4:7], s64 offen offset:0 lds
  buffer_load_dwordx4 v17, s[4:7], s64 offen offset:1024 lds
  s_waitcnt vmcnt(10)
  buffer_load_dwordx4 v18, s[4:7], s64 offen offset:2048 lds
  buffer_load_dwordx4 v19, s[4:7], s64 offen offset:3072 lds
  s_mov_b32 m0, s35
  s_nop 0
  buffer_load_dword v15, s[4:7], 0 offen offset:68 lds
  s_and_b32 s67, s2, 7
  s_lshr_b32 s65, s2, 3
  s_lshl_b32 s60, s67, 2
  s_lshr_b32 s66, s65, 3
  s_add_u32 s60, s60, s66
  s_lshl_b32 s66, s66, 1
  s_add_u32 s65, s65, s66
  s_and_b32 s61, s65, 7
  s_mov_b32 s86, 0
  s_lshl_b32 s65, s60, 2
  s_add_u32 s65, s65, s78
  s_lshl_b32 s66, s65, 7
  s_mul_i32 s65, s65, 73728
  s_add_u32 s79, s65, 4194304
  s_mov_b32 s89, s66
  s_lshl_b32 s65, s61, 2
  s_add_u32 s65, s65, s78
  s_add_u32 s64, s62, 3
  s_and_b32 s64, s64, 7
  s_add_u32 m0, s82, 65536
  s_lshl_b32 s64, s64, 7
  s_waitcnt vmcnt(10)
  buffer_load_dwordx4 v16, s[4:7], s64 offen offset:0 lds
  buffer_load_dwordx4 v17, s[4:7], s64 offen offset:1024 lds
  s_waitcnt vmcnt(10)
  buffer_load_dwordx4 v18, s[4:7], s64 offen offset:2048 lds
  buffer_load_dwordx4 v19, s[4:7], s64 offen offset:3072 lds
  s_mov_b32 m0, s35
  s_nop 0
  buffer_load_dword v15, s[4:7], 0 offen offset:64 lds
  s_lshl_b32 s88, s65, 7
  s_add_u32 s88, s88, 20480
  s_mul_i32 s65, s65, 73728
  s_add_u32 s80, s65, 1048576
  s_mov_b64 s[12:13], s[54:55]
  s_mov_b32 s14, 0x10000000
  s_mov_b32 s15, 0x20000
  s_mov_b64 s[28:29], s[52:53]
  s_mov_b32 s30, 0x100
  s_mov_b32 s31, 0x20000
  v_mov_b32 v29, 0
  v_and_b32 v72, 31, v0
  s_lshl_b32 s65, s57, 5
  v_add_u32 v72, s65, v72
  v_mul_lo_u32 v72, v72, s63
  v_lshrrev_b32 v73, 5, v0
  s_sub_u32 s65, s77, s76
  s_add_u32 s64, s62, 4
  s_and_b32 s64, s64, 7
  s_add_u32 m0, s82, 81920
  s_lshl_b32 s64, s64, 7
  s_waitcnt vmcnt(10)
  buffer_load_dwordx4 v16, s[4:7], s64 offen offset:0 lds
  buffer_load_dwordx4 v17, s[4:7], s64 offen offset:1024 lds
  s_waitcnt vmcnt(10)
  buffer_load_dwordx4 v18, s[4:7], s64 offen offset:2048 lds
  buffer_load_dwordx4 v19, s[4:7], s64 offen offset:3072 lds
  s_mov_b32 m0, s35
  s_nop 0
  buffer_load_dword v15, s[4:7], 0 offen offset:60 lds
  v_mul_lo_u32 v73, v73, s65
  v_add3_u32 v28, v72, v73, s76
  s_lshl_b32 s81, s57, 3
  s_add_u32 s81, s81, s58
  s_lshl_b32 s81, s81, 1
  s_and_b32 s66, s78, 1
  s_add_u32 s81, s81, s66
  s_lshr_b32 s65, s81, 5
  s_lshr_b32 s66, s78, 1
  s_lshl_b32 s66, s66, 3
  s_add_u32 s65, s65, s66
  s_bfe_u32 s66, s81, 0x20003
  s_and_b32 s81, s81, 7
  s_lshl_b32 s68, s81, 2
  s_add_u32 s68, s68, s66
  s_mul_i32 s69, s68, 18
  s_add_u32 s69, s69, s65
  s_add_u32 s64, s62, 5
  s_and_b32 s64, s64, 7
  s_add_u32 m0, s82, 98304
  s_lshl_b32 s64, s64, 7
  s_waitcnt vmcnt(10)
  buffer_load_dwordx4 v16, s[4:7], s64 offen offset:0 lds
  buffer_load_dwordx4 v17, s[4:7], s64 offen offset:1024 lds
  s_waitcnt vmcnt(10)
  buffer_load_dwordx4 v18, s[4:7], s64 offen offset:2048 lds
  buffer_load_dwordx4 v19, s[4:7], s64 offen offset:3072 lds
  s_mov_b32 m0, s35
  s_nop 0
  buffer_load_dword v15, s[4:7], 0 offen offset:56 lds
  s_lshl_b32 s69, s69, 12
  s_add_u32 s84, s69, 1048576
  s_lshl_b32 s68, s68, 7
  s_add_u32 s68, s68, 20480
  s_add_u32 s100, s54, s68
  s_addc_u32 s101, s55, 0
  s_lshl_b32 s67, s66, 2
  s_add_u32 s67, s67, s65
  s_sub_u32 s67, s67, 14
  s_mul_i32 s66, s66, 14
  s_lshr_b32 s68, s65, 1
  s_add_u32 s66, s66, s68
  s_cmp_lt_u32 s65, 2
  s_cselect_b32 s68, 0, 3
  s_cselect_b32 s69, 6, -1
  s_add_u32 s66, s66, s69
  s_and_b32 s69, s65, 1
  s_add_u32 s64, s62, 6
  s_and_b32 s64, s64, 7
  s_add_u32 m0, s82, 114688
  s_lshl_b32 s64, s64, 7
  s_waitcnt vmcnt(10)
  buffer_load_dwordx4 v16, s[4:7], s64 offen offset:0 lds
  buffer_load_dwordx4 v17, s[4:7], s64 offen offset:1024 lds
  s_waitcnt vmcnt(10)
  buffer_load_dwordx4 v18, s[4:7], s64 offen offset:2048 lds
  buffer_load_dwordx4 v19, s[4:7], s64 offen offset:3072 lds
  s_mov_b32 m0, s35
  s_nop 0
  buffer_load_dword v15, s[4:7], 0 offen offset:52 lds
  s_lshl_b32 s69, s69, s68
  s_add_u32 s66, s66, s69
  s_cmp_lt_u32 s65, 14
  s_cselect_b32 s67, s66, s67
  s_cselect_b32 s18, 7, 2
  s_lshl_b32 s18, s18, 18
  s_mov_b32 s19, 0x20000
  s_lshl_b32 s67, s67, 15
  s_lshl_b32 s81, s81, 7
  s_add_u32 s81, s81, s67
  s_cmp_eq_u32 s18, 0x80000
  s_cselect_b32 s16, s40, s48
  s_cselect_b32 s17, s41, s49
  v_and_b32 v72, 6, v70
  v_xor_b32 v72, v72, v71
  v_lshlrev_b32 v72, 4, v72
  v_lshl_add_u32 v20, v70, 10, v72
  s_add_u32 s64, s62, 7
  s_and_b32 s64, s64, 7
  s_add_u32 m0, s82, 131072
  s_lshl_b32 s64, s64, 7
  s_waitcnt vmcnt(10)
  buffer_load_dwordx4 v16, s[4:7], s64 offen offset:0 lds
  buffer_load_dwordx4 v17, s[4:7], s64 offen offset:1024 lds
  s_waitcnt vmcnt(10)
  buffer_load_dwordx4 v18, s[4:7], s64 offen offset:2048 lds
  buffer_load_dwordx4 v19, s[4:7], s64 offen offset:3072 lds
  s_mov_b32 m0, s35
  s_nop 0
  buffer_load_dword v15, s[4:7], 0 offen offset:48 lds
  v_add_u32 v21, 7168, v20
  v_add_u32 v22, 14336, v20
  v_add_u32 v23, 21504, v20
  v_lshrrev_b32 v72, 2, v0
  v_lshlrev_b32 v72, 7, v72
  v_bfe_u32 v73, v0, 3, 2
  v_lshl_add_u32 v72, v73, 5, v72
  v_and_b32 v73, 3, v0
  v_lshl_add_u32 v72, v73, 3, v72
  s_cmp_lt_u32 s78, 2
  s_cselect_b32 s65, 0, 81536
  s_add_u32 s65, s65, s82
  s_add_u32 s85, s65, 65536
  v_add_u32 v24, s85, v72
  v_xor_b32 v25, 32, v24
  v_xor_b32 v26, 64, v24
  v_xor_b32 v27, 96, v24
  s_add_u32 s98, s54, s89
  s_addc_u32 s99, s55, 0
  ds_read_b32 v6, v5 offset:72
  s_waitcnt lgkmcnt(0)
  v_cmp_ne_u32 vcc, 0, v6
  s_cbranch_vccz L_lr_104
L_lp_103:
  s_add_u32 s86, s86, 1
  s_cmp_gt_u32 s86, 1048576
  s_cbranch_scc1 L_lr_104
  ds_read_b32 v6, v5 offset:72
  s_waitcnt lgkmcnt(0)
  v_cmp_ne_u32 vcc, 0, v6
  s_cbranch_vccnz L_lp_103
L_lr_104:
  ds_read_b32 v6, v5 offset:68
  s_waitcnt lgkmcnt(0)
  v_cmp_ne_u32 vcc, 0, v6
  s_cbranch_vccz L_lr_108
L_lp_107:
  s_add_u32 s86, s86, 1
  s_cmp_gt_u32 s86, 1048576
  s_cbranch_scc1 L_lr_108
  ds_read_b32 v6, v5 offset:68
  s_waitcnt lgkmcnt(0)
  v_cmp_ne_u32 vcc, 0, v6
  s_cbranch_vccnz L_lp_107
L_lr_108:
  s_cmp_ge_u32 s78, 2
  s_cbranch_scc1 L_sk_109
  s_mov_b32 m0, s85
  s_nop 0
  buffer_load_dwordx4 v20, s[16:19], s81 offen offset:0 lds
  buffer_load_dwordx4 v21, s[16:19], s81 offen offset:1024 lds
  buffer_load_dwordx4 v22, s[16:19], s81 offen offset:2048 lds
  buffer_load_dwordx4 v23, s[16:19], s81 offen offset:3072 lds
L_sk_109:
  s_add_u32 s64, s83, 0
  s_and_b32 s64, s64, 0xffff
  s_add_u32 m0, s64, 0
  s_add_u32 s64, s70, s74
  buffer_load_dwordx4 v8, s[8:11], s64 offen offset:0 lds
  buffer_load_dwordx4 v9, s[8:11], s64 offen offset:1024 lds
  buffer_load_dwordx4 v10, s[8:11], s64 offen offset:2048 lds
  buffer_load_dwordx4 v11, s[8:11], s64 offen offset:3072 lds
  s_add_u32 s64, s83, 16384
  s_and_b32 s64, s64, 0xffff
  s_add_u32 m0, s64, 0
  s_add_u32 s64, s71, s74
  s_waitcnt vmcnt(7)
  buffer_load_dwordx4 v8, s[8:11], s64 offen offset:0 lds
  buffer_load_dwordx4 v9, s[8:11], s64 offen offset:1024 lds
  s_waitcnt vmcnt(7)
  buffer_load_dwordx4 v10, s[8:11], s64 offen offset:2048 lds
  buffer_load_dwordx4 v11, s[8:11], s64 offen offset:3072 lds
  s_mov_b32 m0, s35
  s_nop 0
  buffer_load_dword v15, s[4:7], 0 offen offset:44 lds
  s_add_u32 s64, s83, 32768
  s_and_b32 s64, s64, 0xffff
  s_add_u32 m0, s64, 0
  s_add_u32 s64, s72, s74
  s_waitcnt vmcnt(7)
  buffer_load_dwordx4 v8, s[8:11], s64 offen offset:0 lds
  buffer_load_dwordx4 v9, s[8:11], s64 offen offset:1024 lds
  s_waitcnt vmcnt(7)
  buffer_load_dwordx4 v10, s[8:11], s64 offen offset:2048 lds
  buffer_load_dwordx4 v11, s[8:11], s64 offen offset:3072 lds
  s_add_u32 s64, s83, 49152
  s_and_b32 s64, s64, 0xffff
  s_add_u32 m0, s64, 0
  s_add_u32 s64, s73, s74
  s_waitcnt vmcnt(7)
  buffer_load_dwordx4 v8, s[8:11], s64 offen offset:0 lds
  buffer_load_dwordx4 v9, s[8:11], s64 offen offset:1024 lds
  s_waitcnt vmcnt(7)
  buffer_load_dwordx4 v10, s[8:11], s64 offen offset:2048 lds
  buffer_load_dwordx4 v11, s[8:11], s64 offen offset:3072 lds
  s_mov_b32 m0, s35
  s_nop 0
  buffer_load_dword v15, s[4:7], 0 offen offset:40 lds
  buffer_load_dword v254, v29, s[28:31], 0 offen sc1
  s_cmp_ge_u32 s78, 2
  s_cbranch_scc1 L_sk_119
  ds_read_b64_tr_b16 v[32:33], v24 offset:0
  ds_read_b64_tr_b16 v[34:35], v24 offset:2048
  ds_read_b64_tr_b16 v[36:37], v25 offset:0
  ds_read_b64_tr_b16 v[38:39], v25 offset:2048
  ds_read_b64_tr_b16 v[40:41], v26 offset:0
  ds_read_b64_tr_b16 v[42:43], v26 offset:2048
  ds_read_b64_tr_b16 v[44:45], v27 offset:0
  ds_read_b64_tr_b16 v[46:47], v27 offset:2048
  s_waitcnt lgkmcnt(0)
  s_waitcnt lgkmcnt(0)
  buffer_store_dwordx4 v[32:35], v1, s[12:15], s84 offen offset:0 sc1
  s_waitcnt lgkmcnt(0)
  buffer_store_dwordx4 v[36:39], v1, s[12:15], s84 offen offset:1024 sc1
  s_waitcnt lgkmcnt(0)
  buffer_store_dwordx4 v[40:43], v1, s[12:15], s84 offen offset:2048 sc1
  s_waitcnt lgkmcnt(0)
  buffer_store_dwordx4 v[44:47], v1, s[12:15], s84 offen offset:3072 sc1
L_sk_119:
  s_waitcnt lgkmcnt(0)
  s_add_u32 s64, s83, 0
  s_and_b32 s64, s64, 0xffff
  s_add_u32 m0, s64, 65536
  s_add_u32 s64, s70, s75
  s_waitcnt vmcnt(7)
  buffer_load_dwordx4 v8, s[8:11], s64 offen offset:0 lds
  buffer_load_dwordx4 v9, s[8:11], s64 offen offset:1024 lds
  s_waitcnt vmcnt(7)
  buffer_load_dwordx4 v10, s[8:11], s64 offen offset:2048 lds
  buffer_load_dwordx4 v11, s[8:11], s64 offen offset:3072 lds
  s_add_u32 s64, s83, 16384
  s_and_b32 s64, s64, 0xffff
  s_add_u32 m0, s64, 65536
  s_add_u32 s64, s71, s75
  s_waitcnt vmcnt(7)
  buffer_load_dwordx4 v8, s[8:11], s64 offen offset:0 lds
  buffer_load_dwordx4 v9, s[8:11], s64 offen offset:1024 lds
  s_waitcnt vmcnt(7)
  buffer_load_dwordx4 v10, s[8:11], s64 offen offset:2048 lds
  buffer_load_dwordx4 v11, s[8:11], s64 offen offset:3072 lds
  s_mov_b32 m0, s35
  s_nop 0
  buffer_load_dword v15, s[4:7], 0 offen offset:36 lds
  ds_read_b32 v6, v5 offset:64
  s_waitcnt lgkmcnt(0)
  v_cmp_ne_u32 vcc, 0, v6
  s_cbranch_vccz L_lr_118
L_lp_117:
  s_add_u32 s86, s86, 1
  s_cmp_gt_u32 s86, 1048576
  s_cbranch_scc1 L_lr_118
  ds_read_b32 v6, v5 offset:64
  s_waitcnt lgkmcnt(0)
  v_cmp_ne_u32 vcc, 0, v6
  s_cbranch_vccnz L_lp_117
L_lr_118:
  s_waitcnt vmcnt(9)
  v_cmp_gt_u32 vcc, 8, v254
  s_cbranch_vccnz L_ip_114
L_ir_115:
  s_cmp_ge_u32 s78, 2
  s_cbranch_scc1 L_sk_120
  s_mov_b32 s3, 0x1
  s_atomic_add s3, s[100:101], 0
L_sk_120:
  s_add_u32 s64, s83, 32768
  s_and_b32 s64, s64, 0xffff
  s_add_u32 m0, s64, 65536
  s_add_u32 s64, s72, s75
  s_waitcnt vmcnt(7)
  buffer_load_dwordx4 v8, s[8:11], s64 offen offset:0 lds
  buffer_load_dwordx4 v9, s[8:11], s64 offen offset:1024 lds
  s_waitcnt vmcnt(7)
  buffer_load_dwordx4 v10, s[8:11], s64 offen offset:2048 lds
  buffer_load_dwordx4 v11, s[8:11], s64 offen offset:3072 lds
  s_add_u32 s64, s83, 49152
  s_and_b32 s64, s64, 0xffff
  s_add_u32 m0, s64, 65536
  s_add_u32 s64, s73, s75
  s_waitcnt vmcnt(7)
  buffer_load_dwordx4 v8, s[8:11], s64 offen offset:0 lds
  buffer_load_dwordx4 v9, s[8:11], s64 offen offset:1024 lds
  s_waitcnt vmcnt(7)
  buffer_load_dwordx4 v10, s[8:11], s64 offen offset:2048 lds
  buffer_load_dwordx4 v11, s[8:11], s64 offen offset:3072 lds
  s_mov_b32 m0, s35
  s_nop 0
  buffer_load_dword v15, s[4:7], 0 offen offset:32 lds
  s_cmp_lg_u32 s78, 0
  s_cbranch_scc1 L_sk_113
  ds_read_b32 v6, v4 offset:1376
  s_waitcnt lgkmcnt(0)
  v_cmp_ne_u32 vcc, 0, v6
  s_cbranch_vccz L_lr_112
L_lp_111:
  s_add_u32 s86, s86, 1
  s_cmp_gt_u32 s86, 1048576
  s_cbranch_scc1 L_lr_112
  ds_read_b32 v6, v4 offset:1376
  s_waitcnt lgkmcnt(0)
  v_cmp_ne_u32 vcc, 0, v6
  s_cbranch_vccnz L_lp_111
L_lr_112:
  s_mov_b32 exec_hi, 0
  buffer_load_dword v255, v28, s[8:11], 0 offen
  s_mov_b64 exec, -1
L_sk_113:
  s_cmp_lt_u32 s78, 2
  s_cbranch_scc1 L_sk_123
  ds_read_b32 v6, v4 offset:1376
  s_waitcnt lgkmcnt(0)
  v_cmp_ne_u32 vcc, 0, v6
  s_cbranch_vccz L_lr_122
L_lp_121:
  s_add_u32 s86, s86, 1
  s_cmp_gt_u32 s86, 1048576
  s_cbranch_scc1 L_lr_122
  ds_read_b32 v6, v4 offset:1376
  s_waitcnt lgkmcnt(0)
  v_cmp_ne_u32 vcc, 0, v6
  s_cbranch_vccnz L_lp_121
L_lr_122:
  s_mov_b32 m0, s85
  s_nop 0
  buffer_load_dwordx4 v20, s[16:19], s81 offen offset:0 lds
  buffer_load_dwordx4 v21, s[16:19], s81 offen offset:1024 lds
  buffer_load_dwordx4 v22, s[16:19], s81 offen offset:2048 lds
  buffer_load_dwordx4 v23, s[16:19], s81 offen offset:3072 lds
L_sk_123:
  s_mov_b64 s[90:91], s[100:101]
  s_add_u32 s100, s54, s88
  s_addc_u32 s101, s55, 0
  s_barrier
  s_add_u32 s64, s83, 0
  s_and_b32 s64, s64, 0xffff
  s_add_u32 m0, s64, 0
  s_add_u32 s64, s70, s76
  s_waitcnt vmcnt(7)
  buffer_load_dwordx4 v8, s[8:11], s64 offen offset:0 lds
  buffer_load_dwordx4 v9, s[8:11], s64 offen offset:1024 lds
  s_waitcnt vmcnt(7)
  buffer_load_dwordx4 v10, s[8:11], s64 offen offset:2048 lds
  buffer_load_dwordx4 v11, s[8:11], s64 offen offset:3072 lds
  s_add_u32 s64, s83, 16384
  s_and_b32 s64, s64, 0xffff
  s_add_u32 m0, s64, 0
  s_add_u32 s64, s71, s76
  s_waitcnt vmcnt(7)
  buffer_load_dwordx4 v8, s[8:11], s64 offen offset:0 lds
  buffer_load_dwordx4 v9, s[8:11], s64 offen offset:1024 lds
  s_waitcnt vmcnt(7)
  buffer_load_dwordx4 v10, s[8:11], s64 offen offset:2048 lds
  buffer_load_dwordx4 v11, s[8:11], s64 offen offset:3072 lds
  s_barrier
  s_cmp_lt_u32 s78, 2
  s_cbranch_scc1 L_sk_124
  s_waitcnt vmcnt(8)
  ds_read_b64_tr_b16 v[176:177], v24 offset:0
  ds_read_b64_tr_b16 v[178:179], v24 offset:2048
  ds_read_b64_tr_b16 v[180:181], v25 offset:0
  ds_read_b64_tr_b16 v[182:183], v25 offset:2048
  ds_read_b64_tr_b16 v[184:185], v26 offset:0
  ds_read_b64_tr_b16 v[186:187], v26 offset:2048
  ds_read_b64_tr_b16 v[188:189], v27 offset:0
  ds_read_b64_tr_b16 v[190:191], v27 offset:2048
  s_waitcnt lgkmcnt(0)
  s_waitcnt lgkmcnt(0)
  buffer_store_dwordx4 v[176:179], v1, s[12:15], s84 offen offset:0 sc1
  s_waitcnt lgkmcnt(0)
  buffer_store_dwordx4 v[180:183], v1, s[12:15], s84 offen offset:1024 sc1
  s_waitcnt lgkmcnt(0)
  buffer_store_dwordx4 v[184:187], v1, s[12:15], s84 offen offset:2048 sc1
  s_waitcnt lgkmcnt(0)
  buffer_store_dwordx4 v[188:191], v1, s[12:15], s84 offen offset:3072 sc1
L_sk_124:
  s_waitcnt lgkmcnt(0)
  s_add_u32 s64, s83, 32768
  s_and_b32 s64, s64, 0xffff
  s_add_u32 m0, s64, 0
  s_add_u32 s64, s72, s76
  s_waitcnt vmcnt(7)
  buffer_load_dwordx4 v8, s[8:11], s64 offen offset:0 lds
  buffer_load_dwordx4 v9, s[8:11], s64 offen offset:1024 lds
  s_waitcnt vmcnt(7)
  buffer_load_dwordx4 v10, s[8:11], s64 offen offset:2048 lds
  buffer_load_dwordx4 v11, s[8:11], s64 offen offset:3072 lds
  s_mov_b32 s89, 0
  s_atomic_add s89, s[100:101], 0 glc
  s_add_u32 s64, s83, 49152
  s_and_b32 s64, s64, 0xffff
  s_add_u32 m0, s64, 0
  s_add_u32 s64, s73, s76
  s_waitcnt vmcnt(7)
  buffer_load_dwordx4 v8, s[8:11], s64 offen offset:0 lds
  buffer_load_dwordx4 v9, s[8:11], s64 offen offset:1024 lds
  s_waitcnt vmcnt(7)
  buffer_load_dwordx4 v10, s[8:11], s64 offen offset:2048 lds
  buffer_load_dwordx4 v11, s[8:11], s64 offen offset:3072 lds
  s_mov_b32 m0, s35
  s_nop 0
  buffer_load_dword v15, s[4:7], 0 offen offset:24 lds
  s_waitcnt lgkmcnt(0)
  s_bitcmp0_b32 s89, 3
  s_cbranch_scc0 L_sr_127
L_sp_126:
  s_add_u32 s86, s86, 1
  s_cmp_gt_u32 s86, 1048576
  s_cbranch_scc1 L_sr_127
  s_mov_b32 s89, 0
  s_atomic_add s89, s[100:101], 0 glc
  s_waitcnt lgkmcnt(0)
  s_bitcmp0_b32 s89, 3
  s_cbranch_scc1 L_sp_126
L_sr_127:
  s_cmp_lt_u32 s78, 2
  s_cbranch_scc1 L_sk_125
  s_mov_b32 s3, 0x10000
  s_waitcnt vmcnt(9)
  s_atomic_add s3, s[90:91], 0
L_sk_125:
  s_waitcnt vmcnt(7)
  buffer_load_dwordx4 v[16:19], v1, s[12:15], s80 offen offset:0 sc1
  buffer_load_dwordx4 v[20:23], v1, s[12:15], s80 offen offset:1024 sc1
  s_waitcnt vmcnt(7)
  buffer_load_dwordx4 v[24:27], v1, s[12:15], s80 offen offset:2048 sc1
  buffer_load_dwordx4 v[28:31], v1, s[12:15], s80 offen offset:3072 sc1
  s_waitcnt vmcnt(7)
  s_add_u32 s80, s80, 4096
  buffer_load_dwordx4 v[32:35], v1, s[12:15], s80 offen offset:0 sc1
  buffer_load_dwordx4 v[36:39], v1, s[12:15], s80 offen offset:1024 sc1
  s_waitcnt vmcnt(7)
  buffer_load_dwordx4 v[40:43], v1, s[12:15], s80 offen offset:2048 sc1
  buffer_load_dwordx4 v[44:47], v1, s[12:15], s80 offen offset:3072 sc1
  s_waitcnt vmcnt(7)
  s_add_u32 s80, s80, 4096
  buffer_load_dwordx4 v[48:51], v1, s[12:15], s80 offen offset:0 sc1
  buffer_load_dwordx4 v[52:55], v1, s[12:15], s80 offen offset:1024 sc1
  s_waitcnt vmcnt(7)
  buffer_load_dwordx4 v[56:59], v1, s[12:15], s80 offen offset:2048 sc1
  buffer_load_dwordx4 v[60:63], v1, s[12:15], s80 offen offset:3072 sc1
  s_waitcnt vmcnt(7)
  s_add_u32 s80, s80, 4096
  buffer_load_dwordx4 v[64:67], v1, s[12:15], s80 offen offset:0 sc1
  buffer_load_dwordx4 v[68:71], v1, s[12:15], s80 offen offset:1024 sc1
  s_waitcnt vmcnt(7)
  buffer_load_dwordx4 v[72:75], v1, s[12:15], s80 offen offset:2048 sc1
  buffer_load_dwordx4 v[76:79], v1, s[12:15], s80 offen offset:3072 sc1
  s_waitcnt vmcnt(7)
  s_add_u32 s80, s80, 4096
  buffer_load_dwordx4 v[80:83], v1, s[12:15], s80 offen offset:0 sc1
  buffer_load_dwordx4 v[84:87], v1, s[12:15], s80 offen offset:1024 sc1
  s_waitcnt vmcnt(7)
  buffer_load_dwordx4 v[88:91], v1, s[12:15], s80 offen offset:2048 sc1
  buffer_load_dwordx4 v[92:95], v1, s[12:15], s80 offen offset:3072 sc1
  s_mov_b32 s89, 0
  s_atomic_add s89, s[100:101], 0 glc
  s_waitcnt vmcnt(7)
  s_add_u32 s80, s80, 4096
  buffer_load_dwordx4 v[96:99], v1, s[12:15], s80 offen offset:0 sc1
  buffer_load_dwordx4 v[100:103], v1, s[12:15], s80 offen offset:1024 sc1
  s_waitcnt vmcnt(7)
  buffer_load_dwordx4 v[104:107], v1, s[12:15], s80 offen offset:2048 sc1
  buffer_load_dwordx4 v[108:111], v1, s[12:15], s80 offen offset:3072 sc1
  s_waitcnt vmcnt(7)
  s_add_u32 s80, s80, 4096
  buffer_load_dwordx4 v[112:115], v1, s[12:15], s80 offen offset:0 sc1
  buffer_load_dwordx4 v[116:119], v1, s[12:15], s80 offen offset:1024 sc1
  s_waitcnt vmcnt(7)
  buffer_load_dwordx4 v[120:123], v1, s[12:15], s80 offen offset:2048 sc1
  buffer_load_dwordx4 v[124:127], v1, s[12:15], s80 offen offset:3072 sc1
  s_waitcnt lgkmcnt(0)
  s_cmp_lt_u32 s89, 0xa0000
  s_cbranch_scc0 L_sr_129
L_sp_128:
  s_add_u32 s86, s86, 1
  s_cmp_gt_u32 s86, 1048576
  s_cbranch_scc1 L_sr_129
  s_mov_b32 s89, 0
  s_atomic_add s89, s[100:101], 0 glc
  s_waitcnt lgkmcnt(0)
  s_cmp_lt_u32 s89, 0xa0000
  s_cbranch_scc1 L_sp_128
L_sr_129:
  s_mov_b32 s89, 0
  s_atomic_add s89, s[98:99], 0 glc
  s_waitcnt vmcnt(7)
  s_add_u32 s80, s80, 4096
  buffer_load_dwordx4 v[128:131], v1, s[12:15], s80 offen offset:0 sc1
  buffer_load_dwordx4 v[132:135], v1, s[12:15], s80 offen offset:1024 sc1
  s_waitcnt vmcnt(7)
  buffer_load_dwordx4 v[136:139], v1, s[12:15], s80 offen offset:2048 sc1
  buffer_load_dwordx4 v[140:143], v1, s[12:15], s80 offen offset:3072 sc1
  s_waitcnt vmcnt(7)
  s_add_u32 s80, s80, 4096
  buffer_load_dwordx4 v[144:147], v1, s[12:15], s80 offen offset:0 sc1
  buffer_load_dwordx4 v[148:151], v1, s[12:15], s80 offen offset:1024 sc1
  s_waitcnt vmcnt(7)
  buffer_load_dwordx4 v[152:155], v1, s[12:15], s80 offen offset:2048 sc1
  buffer_load_dwordx4 v[156:159], v1, s[12:15], s80 offen offset:3072 sc1
  s_waitcnt lgkmcnt(0)
  s_bitcmp0_b32 s89, 2
  s_cbranch_scc0 L_sr_131
L_sp_130:
  s_add_u32 s86, s86, 1
  s_cmp_gt_u32 s86, 1048576
  s_cbranch_scc1 L_sr_131
  s_mov_b32 s89, 0
  s_atomic_add s89, s[98:99], 0 glc
  s_waitcnt lgkmcnt(0)
  s_bitcmp0_b32 s89, 2
  s_cbranch_scc1 L_sp_130
L_sr_131:
  buffer_load_dwordx4 v[160:163], v1, s[12:15], s79 offen offset:0 sc1
  buffer_load_dwordx4 v[164:167], v1, s[12:15], s79 offen offset:1024 sc1
  buffer_load_dwordx4 v[168:171], v1, s[12:15], s79 offen offset:2048 sc1
  buffer_load_dwordx4 v[172:175], v1, s[12:15], s79 offen offset:3072 sc1
  s_add_u32 s79, s79, 4096
  buffer_load_dwordx4 v[176:179], v1, s[12:15], s79 offen offset:0 sc1
  buffer_load_dwordx4 v[180:183], v1, s[12:15], s79 offen offset:1024 sc1
  buffer_load_dwordx4 v[184:187], v1, s[12:15], s79 offen offset:2048 sc1
  buffer_load_dwordx4 v[188:191], v1, s[12:15], s79 offen offset:3072 sc1
  s_lshl_b32 s66, s78, 14
  s_add_u32 s66, s66, 65536
  v_add_u32 v12, s66, v1
  v_bfe_u32 v9, v0, 4, 1
  v_bfe_u32 v10, v0, 1, 1
  v_xor_b32 v9, v9, v10
  v_lshrrev_b32 v10, 5, v0
  v_and_b32 v11, 7, v0
  v_xor_b32 v10, v10, v11
  v_lshl_add_u32 v9, v9, 3, v10
  v_and_b32 v10, 15, v0
  v_lshlrev_b32 v10, 8, v10
  v_lshl_add_u32 v9, v9, 4, v10
  v_add_u32 v8, s66, v9
  v_xor_b32 v9, 32, v8
  v_xor_b32 v10, 64, v8
  v_xor_b32 v11, 96, v8
  ds_read_b32 v6, v4 offset:52
  s_waitcnt lgkmcnt(0)
  v_cmp_ne_u32 vcc, 0, v6
  s_cbranch_vccz L_lr_133
L_lp_132:
  s_add_u32 s86, s86, 1
  s_cmp_gt_u32 s86, 1048576
  s_cbranch_scc1 L_lr_133
  ds_read_b32 v6, v4 offset:52
  s_waitcnt lgkmcnt(0)
  v_cmp_ne_u32 vcc, 0, v6
  s_cbranch_vccnz L_lp_132
L_lr_133:
  s_add_u32 s80, s80, 4096
  s_add_u32 m0, s66, 0
  s_waitcnt vmcnt(7)
  buffer_load_dwordx4 v1, s[12:15], s80 offen offset:0 sc1 lds
  buffer_load_dwordx4 v1, s[12:15], s80 offen offset:1024 sc1 lds
  s_waitcnt vmcnt(7)
  buffer_load_dwordx4 v1, s[12:15], s80 offen offset:2048 sc1 lds
  buffer_load_dwordx4 v1, s[12:15], s80 offen offset:3072 sc1 lds
  s_add_u32 s80, s80, 4096
  s_add_u32 m0, s66, 4096
  s_waitcnt vmcnt(7)
  buffer_load_dwordx4 v1, s[12:15], s80 offen offset:0 sc1 lds
  buffer_load_dwordx4 v1, s[12:15], s80 offen offset:1024 sc1 lds
  s_waitcnt vmcnt(7)
  buffer_load_dwordx4 v1, s[12:15], s80 offen offset:2048 sc1 lds
  buffer_load_dwordx4 v1, s[12:15], s80 offen offset:3072 sc1 lds
  s_add_u32 s80, s80, 4096
  s_add_u32 m0, s66, 8192
  s_bitcmp1_b32 s89, 6
  s_cbranch_scc1 L_np_134
  s_mov_b32 s89, 0
  s_atomic_add s89, s[98:99], 0 glc
L_np_134:
  s_waitcnt vmcnt(7)
  buffer_load_dwordx4 v1, s[12:15], s80 offen offset:0 sc1 lds
  buffer_load_dwordx4 v1, s[12:15], s80 offen offset:1024 sc1 lds
  s_waitcnt vmcnt(7)
  buffer_load_dwordx4 v1, s[12:15], s80 offen offset:2048 sc1 lds
  buffer_load_dwordx4 v1, s[12:15], s80 offen offset:3072 sc1 lds
  s_add_u32 s80, s80, 4096
  s_add_u32 m0, s66, 12288
  s_waitcnt vmcnt(7)
  buffer_load_dwordx4 v1, s[12:15], s80 offen offset:0 sc1 lds
  buffer_load_dwordx4 v1, s[12:15], s80 offen offset:1024 sc1 lds
  s_waitcnt vmcnt(7)
  buffer_load_dwordx4 v1, s[12:15], s80 offen offset:2048 sc1 lds
  buffer_load_dwordx4 v1, s[12:15], s80 offen offset:3072 sc1 lds
  v_mfma_f32_16x16x32_bf16 v[192:195], v[16:19], v[160:163], 0
  v_mfma_f32_16x16x32_bf16 v[192:195], v[32:35], v[164:167], v[192:195]
  v_mfma_f32_16x16x32_bf16 v[196:199], v[36:39], v[164:167], 0
  v_mfma_f32_16x16x32_bf16 v[196:199], v[20:23], v[160:163], v[196:199]
  v_mfma_f32_16x16x32_bf16 v[200:203], v[24:27], v[160:163], 0
  v_mfma_f32_16x16x32_bf16 v[200:203], v[40:43], v[164:167], v[200:203]
  v_mfma_f32_16x16x32_bf16 v[204:207], v[44:47], v[164:167], 0
  v_mfma_f32_16x16x32_bf16 v[204:207], v[28:31], v[160:163], v[204:207]
  s_waitcnt lgkmcnt(0)
  s_bitcmp0_b32 s89, 6
  s_cbranch_scc0 L_sr_136
L_sp_135:
  s_add_u32 s86, s86, 1
  s_cmp_gt_u32 s86, 1048576
  s_cbranch_scc1 L_sr_136
  s_mov_b32 s89, 0
  s_atomic_add s89, s[98:99], 0 glc
  s_waitcnt lgkmcnt(0)
  s_bitcmp0_b32 s89, 6
  s_cbranch_scc1 L_sp_135
L_sr_136:
  s_add_u32 s79, s79, 4096
  buffer_load_dwordx4 v[164:167], v1, s[12:15], s79 offen offset:0 sc1
  v_mfma_f32_16x16x32_bf16 v[220:223], v[28:31], v[168:171], 0
  v_mfma_f32_16x16x32_bf16 v[220:223], v[44:47], v[172:175], v[220:223]
  s_bitcmp1_b32 s89, 10
  s_cbranch_scc1 L_np_153
  s_mov_b32 s89, 0
  s_atomic_add s89, s[98:99], 0 glc
L_np_153:
  buffer_load_dwordx4 v[160:163], v1, s[12:15], s79 offen offset:1024 sc1
  v_mfma_f32_16x16x32_bf16 v[216:219], v[40:43], v[172:175], 0
  v_mfma_f32_16x16x32_bf16 v[216:219], v[24:27], v[168:171], v[216:219]
  v_mfma_f32_16x16x32_bf16 v[212:215], v[20:23], v[168:171], 0
  v_mfma_f32_16x16x32_bf16 v[212:215], v[36:39], v[172:175], v[212:215]
  v_mfma_f32_16x16x32_bf16 v[208:211], v[32:35], v[172:175], 0
  v_mfma_f32_16x16x32_bf16 v[208:211], v[16:19], v[168:171], v[208:211]
  buffer_load_dwordx4 v[172:175], v1, s[12:15], s79 offen offset:2048 sc1
  v_mfma_f32_16x16x32_bf16 v[224:227], v[16:19], v[176:179], 0
  v_mfma_f32_16x16x32_bf16 v[224:227], v[32:35], v[180:183], v[224:227]
  buffer_load_dwordx4 v[168:171], v1, s[12:15], s79 offen offset:3072 sc1
  v_mfma_f32_16x16x32_bf16 v[228:231], v[36:39], v[180:183], 0
  v_mfma_f32_16x16x32_bf16 v[228:231], v[20:23], v[176:179], v[228:231]
  v_mfma_f32_16x16x32_bf16 v[232:235], v[24:27], v[176:179], 0
  v_mfma_f32_16x16x32_bf16 v[232:235], v[40:43], v[180:183], v[232:235]
  v_mfma_f32_16x16x32_bf16 v[236:239], v[44:47], v[180:183], 0
  v_mfma_f32_16x16x32_bf16 v[236:239], v[28:31], v[176:179], v[236:239]
  s_add_u32 s79, s79, 4096
  buffer_load_dwordx4 v[180:183], v1, s[12:15], s79 offen offset:0 sc1
  v_mfma_f32_16x16x32_bf16 v[252:255], v[28:31], v[184:187], 0
  v_mfma_f32_16x16x32_bf16 v[252:255], v[44:47], v[188:191], v[252:255]
  buffer_load_dwordx4 v[176:179], v1, s[12:15], s79 offen offset:1024 sc1
  v_mfma_f32_16x16x32_bf16 v[248:251], v[40:43], v[188:191], 0
  v_mfma_f32_16x16x32_bf16 v[248:251], v[24:27], v[184:187], v[248:251]
  buffer_load_dwordx4 v[28:31], v1, s[12:15], s79 offen offset:2048 sc1
  v_mfma_f32_16x16x32_bf16 v[244:247], v[20:23], v[184:187], 0
  v_mfma_f32_16x16x32_bf16 v[244:247], v[36:39], v[188:191], v[244:247]
  buffer_load_dwordx4 v[44:47], v1, s[12:15], s79 offen offset:3072 sc1
  v_mfma_f32_16x16x32_bf16 v[240:243], v[32:35], v[188:191], 0
  v_mfma_f32_16x16x32_bf16 v[240:243], v[16:19], v[184:187], v[240:243]
  s_waitcnt lgkmcnt(0)
  s_bitcmp0_b32 s89, 10
  s_cbranch_scc0 L_sr_138
L_sp_137:
  s_add_u32 s86, s86, 1
  s_cmp_gt_u32 s86, 1048576
  s_cbranch_scc1 L_sr_138
  s_mov_b32 s89, 0
  s_atomic_add s89, s[98:99], 0 glc
  s_waitcnt lgkmcnt(0)
  s_bitcmp0_b32 s89, 10
  s_cbranch_scc1 L_sp_137
L_sr_138:
  s_add_u32 s79, s79, 4096
  buffer_load_dwordx4 v[40:43], v1, s[12:15], s79 offen offset:0 sc1
  s_waitcnt vmcnt(7)
  v_mfma_f32_16x16x32_bf16 v[192:195], v[48:51], v[164:167], v[192:195]
  v_mfma_f32_16x16x32_bf16 v[192:195], v[64:67], v[160:163], v[192:195]
  s_add_u32 s80, s80, 4096
  buffer_load_dwordx4 v[24:27], v1, s[12:15], s80 offen offset:0 sc1
  v_mfma_f32_16x16x32_bf16 v[196:199], v[68:71], v[160:163], v[196:199]
  v_mfma_f32_16x16x32_bf16 v[196:199], v[52:55], v[164:167], v[196:199]
  buffer_load_dwordx4 v[20:23], v1, s[12:15], s79 offen offset:1024 sc1
  v_mfma_f32_16x16x32_bf16 v[200:203], v[56:59], v[164:167], v[200:203]
  v_mfma_f32_16x16x32_bf16 v[200:203], v[72:75], v[160:163], v[200:203]
  s_bitcmp1_b32 s89, 14
  s_cbranch_scc1 L_np_152
  s_mov_b32 s89, 0
  s_atomic_add s89, s[98:99], 0 glc
L_np_152:
  buffer_load_dwordx4 v[36:39], v1, s[12:15], s79 offen offset:2048 sc1
  v_mfma_f32_16x16x32_bf16 v[204:207], v[76:79], v[160:163], v[204:207]
  v_mfma_f32_16x16x32_bf16 v[204:207], v[60:63], v[164:167], v[204:207]
  buffer_load_dwordx4 v[188:191], v1, s[12:15], s80 offen offset:1024 sc1
  s_waitcnt vmcnt(9)
  v_mfma_f32_16x16x32_bf16 v[220:223], v[60:63], v[172:175], v[220:223]
  v_mfma_f32_16x16x32_bf16 v[220:223], v[76:79], v[168:171], v[220:223]
  buffer_load_dwordx4 v[32:35], v1, s[12:15], s79 offen offset:3072 sc1
  v_mfma_f32_16x16x32_bf16 v[216:219], v[72:75], v[168:171], v[216:219]
  v_mfma_f32_16x16x32_bf16 v[216:219], v[56:59], v[172:175], v[216:219]
  buffer_load_dwordx4 v[184:187], v1, s[12:15], s80 offen offset:2048 sc1
  v_mfma_f32_16x16x32_bf16 v[212:215], v[52:55], v[172:175], v[212:215]
  v_mfma_f32_16x16x32_bf16 v[212:215], v[68:71], v[168:171], v[212:215]
  s_add_u32 s79, s79, 4096
  buffer_load_dwordx4 v[16:19], v1, s[12:15], s79 offen offset:0 sc1
  v_mfma_f32_16x16x32_bf16 v[208:211], v[64:67], v[168:171], v[208:211]
  v_mfma_f32_16x16x32_bf16 v[208:211], v[48:51], v[172:175], v[208:211]
  buffer_load_dwordx4 v[160:163], v1, s[12:15], s79 offen offset:1024 sc1
  s_waitcnt vmcnt(11)
  v_mfma_f32_16x16x32_bf16 v[224:227], v[48:51], v[180:183], v[224:227]
  v_mfma_f32_16x16x32_bf16 v[224:227], v[64:67], v[176:179], v[224:227]
  buffer_load_dwordx4 v[164:167], v1, s[12:15], s80 offen offset:3072 sc1
  v_mfma_f32_16x16x32_bf16 v[228:231], v[68:71], v[176:179], v[228:231]
  v_mfma_f32_16x16x32_bf16 v[228:231], v[52:55], v[180:183], v[228:231]
  v_mfma_f32_16x16x32_bf16 v[232:235], v[56:59], v[180:183], v[232:235]
  v_mfma_f32_16x16x32_bf16 v[232:235], v[72:75], v[176:179], v[232:235]
  v_mfma_f32_16x16x32_bf16 v[236:239], v[76:79], v[176:179], v[236:239]
  v_mfma_f32_16x16x32_bf16 v[236:239], v[60:63], v[180:183], v[236:239]
  buffer_load_dwordx4 v[168:171], v1, s[12:15], s79 offen offset:2048 sc1
  s_waitcnt vmcnt(11)
  v_mfma_f32_16x16x32_bf16 v[252:255], v[60:63], v[28:31], v[252:255]
  v_mfma_f32_16x16x32_bf16 v[252:255], v[76:79], v[44:47], v[252:255]
  s_add_u32 s80, s80, 4096
  buffer_load_dwordx4 v[172:175], v1, s[12:15], s80 offen offset:0 sc1
  v_mfma_f32_16x16x32_bf16 v[248:251], v[72:75], v[44:47], v[248:251]
  v_mfma_f32_16x16x32_bf16 v[248:251], v[56:59], v[28:31], v[248:251]
  v_mfma_f32_16x16x32_bf16 v[244:247], v[52:55], v[28:31], v[244:247]
  v_mfma_f32_16x16x32_bf16 v[244:247], v[68:71], v[44:47], v[244:247]
  v_mfma_f32_16x16x32_bf16 v[240:243], v[64:67], v[44:47], v[240:243]
  v_mfma_f32_16x16x32_bf16 v[240:243], v[48:51], v[28:31], v[240:243]
  buffer_load_dwordx4 v[176:179], v1, s[12:15], s79 offen offset:3072 sc1
  s_waitcnt vmcnt(10)
  v_mfma_f32_16x16x32_bf16 v[192:195], v[80:83], v[40:43], v[192:195]
  v_mfma_f32_16x16x32_bf16 v[192:195], v[96:99], v[20:23], v[192:195]
  s_waitcnt lgkmcnt(0)
  s_bitcmp0_b32 s89, 14
  s_cbranch_scc0 L_sr_140
L_sp_139:
  s_add_u32 s86, s86, 1
  s_cmp_gt_u32 s86, 1048576
  s_cbranch_scc1 L_sr_140
  s_mov_b32 s89, 0
  s_atomic_add s89, s[98:99], 0 glc
  s_waitcnt lgkmcnt(0)
  s_bitcmp0_b32 s89, 14
  s_cbranch_scc1 L_sp_139
L_sr_140:
  s_add_u32 s79, s79, 4096
  buffer_load_dwordx4 v[180:183], v1, s[12:15], s79 offen offset:0 sc1
  v_mfma_f32_16x16x32_bf16 v[196:199], v[100:103], v[20:23], v[196:199]
  v_mfma_f32_16x16x32_bf16 v[196:199], v[84:87], v[40:43], v[196:199]
  buffer_load_dwordx4 v[60:63], v1, s[12:15], s80 offen offset:1024 sc1
  v_mfma_f32_16x16x32_bf16 v[200:203], v[88:91], v[40:43], v[200:203]
  v_mfma_f32_16x16x32_bf16 v[200:203], v[104:107], v[20:23], v[200:203]
  v_mfma_f32_16x16x32_bf16 v[204:207], v[108:111], v[20:23], v[204:207]
  v_mfma_f32_16x16x32_bf16 v[204:207], v[92:95], v[40:43], v[204:207]
  buffer_load_dwordx4 v[76:79], v1, s[12:15], s79 offen offset:1024 sc1
  s_waitcnt vmcnt(10)
  v_mfma_f32_16x16x32_bf16 v[220:223], v[92:95], v[36:39], v[220:223]
  v_mfma_f32_16x16x32_bf16 v[220:223], v[108:111], v[32:35], v[220:223]
  s_bitcmp1_b32 s89, 18
  s_cbranch_scc1 L_np_151
  s_mov_b32 s89, 0
  s_atomic_add s89, s[98:99], 0 glc
L_np_151:
  buffer_load_dwordx4 v[72:75], v1, s[12:15], s79 offen offset:2048 sc1
  v_mfma_f32_16x16x32_bf16 v[216:219], v[104:107], v[32:35], v[216:219]
  v_mfma_f32_16x16x32_bf16 v[216:219], v[88:91], v[36:39], v[216:219]
  buffer_load_dwordx4 v[56:59], v1, s[12:15], s80 offen offset:2048 sc1
  v_mfma_f32_16x16x32_bf16 v[212:215], v[84:87], v[36:39], v[212:215]
  v_mfma_f32_16x16x32_bf16 v[212:215], v[100:103], v[32:35], v[212:215]
  v_mfma_f32_16x16x32_bf16 v[208:211], v[96:99], v[32:35], v[208:211]
  v_mfma_f32_16x16x32_bf16 v[208:211], v[80:83], v[36:39], v[208:211]
  buffer_load_dwordx4 v[52:55], v1, s[12:15], s79 offen offset:3072 sc1
  s_waitcnt vmcnt(10)
  v_mfma_f32_16x16x32_bf16 v[224:227], v[80:83], v[16:19], v[224:227]
  v_mfma_f32_16x16x32_bf16 v[224:227], v[96:99], v[160:163], v[224:227]
  buffer_load_dwordx4 v[68:71], v1, s[12:15], s80 offen offset:3072 sc1
  v_mfma_f32_16x16x32_bf16 v[228:231], v[100:103], v[160:163], v[228:231]
  v_mfma_f32_16x16x32_bf16 v[228:231], v[84:87], v[16:19], v[228:231]
  s_add_u32 s79, s79, 4096
  buffer_load_dwordx4 v[44:47], v1, s[12:15], s79 offen offset:0 sc1
  v_mfma_f32_16x16x32_bf16 v[232:235], v[88:91], v[16:19], v[232:235]
  v_mfma_f32_16x16x32_bf16 v[232:235], v[104:107], v[160:163], v[232:235]
  v_mfma_f32_16x16x32_bf16 v[236:239], v[108:111], v[160:163], v[236:239]
  v_mfma_f32_16x16x32_bf16 v[236:239], v[92:95], v[16:19], v[236:239]
  buffer_load_dwordx4 v[64:67], v1, s[12:15], s79 offen offset:1024 sc1
  s_waitcnt vmcnt(9)
  v_mfma_f32_16x16x32_bf16 v[252:255], v[92:95], v[168:171], v[252:255]
  v_mfma_f32_16x16x32_bf16 v[252:255], v[108:111], v[176:179], v[252:255]
  s_add_u32 s80, s80, 4096
  buffer_load_dwordx4 v[28:31], v1, s[12:15], s80 offen offset:0 sc1
  v_mfma_f32_16x16x32_bf16 v[248:251], v[104:107], v[176:179], v[248:251]
  v_mfma_f32_16x16x32_bf16 v[248:251], v[88:91], v[168:171], v[248:251]
  buffer_load_dwordx4 v[48:51], v1, s[12:15], s79 offen offset:2048 sc1
  v_mfma_f32_16x16x32_bf16 v[244:247], v[84:87], v[168:171], v[244:247]
  v_mfma_f32_16x16x32_bf16 v[244:247], v[100:103], v[176:179], v[244:247]
  buffer_load_dwordx4 v[20:23], v1, s[12:15], s80 offen offset:1024 sc1
  v_mfma_f32_16x16x32_bf16 v[240:243], v[96:99], v[176:179], v[240:243]
  v_mfma_f32_16x16x32_bf16 v[240:243], v[80:83], v[168:171], v[240:243]
  buffer_load_dwordx4 v[40:43], v1, s[12:15], s79 offen offset:3072 sc1
  s_waitcnt vmcnt(10)
  v_mfma_f32_16x16x32_bf16 v[192:195], v[112:115], v[180:183], v[192:195]
  v_mfma_f32_16x16x32_bf16 v[192:195], v[128:131], v[76:79], v[192:195]
  ds_read_b128 v[32:35], v12 offset:0
  ds_read_b128 v[36:39], v12 offset:1024
  v_mfma_f32_16x16x32_bf16 v[196:199], v[132:135], v[76:79], v[196:199]
  v_mfma_f32_16x16x32_bf16 v[196:199], v[116:119], v[180:183], v[196:199]
  ds_read_b128 v[160:163], v12 offset:2048
  ds_read_b128 v[16:19], v12 offset:3072
  v_mfma_f32_16x16x32_bf16 v[200:203], v[120:123], v[180:183], v[200:203]
  v_mfma_f32_16x16x32_bf16 v[200:203], v[136:139], v[76:79], v[200:203]
  s_waitcnt lgkmcnt(0)
  s_bitcmp0_b32 s89, 18
  s_cbranch_scc0 L_sr_142
L_sp_141:
  s_add_u32 s86, s86, 1
  s_cmp_gt_u32 s86, 1048576
  s_cbranch_scc1 L_sr_142
  s_mov_b32 s89, 0
  s_atomic_add s89, s[98:99], 0 glc
  s_waitcnt lgkmcnt(0)
  s_bitcmp0_b32 s89, 18
  s_cbranch_scc1 L_sp_141
L_sr_142:
  s_add_u32 s79, s79, 4096
  buffer_load_dwordx4 v[92:95], v1, s[12:15], s79 offen offset:0 sc1
  v_mfma_f32_16x16x32_bf16 v[204:207], v[140:143], v[76:79], v[204:207]
  v_mfma_f32_16x16x32_bf16 v[204:207], v[124:127], v[180:183], v[204:207]
  buffer_load_dwordx4 v[108:111], v1, s[12:15], s80 offen offset:2048 sc1
  s_waitcnt vmcnt(9)
  v_mfma_f32_16x16x32_bf16 v[220:223], v[124:127], v[72:75], v[220:223]
  v_mfma_f32_16x16x32_bf16 v[220:223], v[140:143], v[52:55], v[220:223]
  buffer_load_dwordx4 v[104:107], v1, s[12:15], s79 offen offset:1024 sc1
  v_mfma_f32_16x16x32_bf16 v[216:219], v[136:139], v[52:55], v[216:219]
  v_mfma_f32_16x16x32_bf16 v[216:219], v[120:123], v[72:75], v[216:219]
  s_bitcmp1_b32 s89, 22
  s_cbranch_scc1 L_np_150
  s_mov_b32 s89, 0
  s_atomic_add s89, s[98:99], 0 glc
L_np_150:
  buffer_load_dwordx4 v[88:91], v1, s[12:15], s79 offen offset:2048 sc1
  v_mfma_f32_16x16x32_bf16 v[212:215], v[116:119], v[72:75], v[212:215]
  v_mfma_f32_16x16x32_bf16 v[212:215], v[132:135], v[52:55], v[212:215]
  buffer_load_dwordx4 v[84:87], v1, s[12:15], s80 offen offset:3072 sc1
  v_mfma_f32_16x16x32_bf16 v[208:211], v[128:131], v[52:55], v[208:211]
  v_mfma_f32_16x16x32_bf16 v[208:211], v[112:115], v[72:75], v[208:211]
  buffer_load_dwordx4 v[100:103], v1, s[12:15], s79 offen offset:3072 sc1
  s_waitcnt vmcnt(10)
  v_mfma_f32_16x16x32_bf16 v[224:227], v[112:115], v[44:47], v[224:227]
  v_mfma_f32_16x16x32_bf16 v[224:227], v[128:131], v[64:67], v[224:227]
  ds_read_b128 v[176:179], v12 offset:4096
  ds_read_b128 v[96:99], v12 offset:5120
  v_mfma_f32_16x16x32_bf16 v[228:231], v[132:135], v[64:67], v[228:231]
  v_mfma_f32_16x16x32_bf16 v[228:231], v[116:119], v[44:47], v[228:231]
  ds_read_b128 v[168:171], v12 offset:6144
  ds_read_b128 v[80:83], v12 offset:7168
  v_mfma_f32_16x16x32_bf16 v[232:235], v[120:123], v[44:47], v[232:235]
  v_mfma_f32_16x16x32_bf16 v[232:235], v[136:139], v[64:67], v[232:235]
  s_add_u32 s80, s80, 4096
  buffer_load_dwordx4 v[76:79], v1, s[12:15], s80 offen offset:0 sc1
  v_mfma_f32_16x16x32_bf16 v[236:239], v[140:143], v[64:67], v[236:239]
  v_mfma_f32_16x16x32_bf16 v[236:239], v[124:127], v[44:47], v[236:239]
  s_add_u32 s79, s79, 4096
  buffer_load_dwordx4 v[180:183], v1, s[12:15], s79 offen offset:0 sc1
  s_waitcnt vmcnt(8)
  v_mfma_f32_16x16x32_bf16 v[252:255], v[124:127], v[48:51], v[252:255]
  v_mfma_f32_16x16x32_bf16 v[252:255], v[140:143], v[40:43], v[252:255]
  buffer_load_dwordx4 v[52:55], v1, s[12:15], s79 offen offset:1024 sc1
  v_mfma_f32_16x16x32_bf16 v[248:251], v[136:139], v[40:43], v[248:251]
  v_mfma_f32_16x16x32_bf16 v[248:251], v[120:123], v[48:51], v[248:251]
  buffer_load_dwordx4 v[72:75], v1, s[12:15], s80 offen offset:1024 sc1
  v_mfma_f32_16x16x32_bf16 v[244:247], v[116:119], v[48:51], v[244:247]
  v_mfma_f32_16x16x32_bf16 v[244:247], v[132:135], v[40:43], v[244:247]
  buffer_load_dwordx4 v[64:67], v1, s[12:15], s79 offen offset:2048 sc1
  v_mfma_f32_16x16x32_bf16 v[240:243], v[128:131], v[40:43], v[240:243]
  v_mfma_f32_16x16x32_bf16 v[240:243], v[112:115], v[48:51], v[240:243]
  buffer_load_dwordx4 v[44:47], v1, s[12:15], s80 offen offset:2048 sc1
  s_waitcnt vmcnt(9)
  v_mfma_f32_16x16x32_bf16 v[192:195], v[144:147], v[92:95], v[192:195]
  v_mfma_f32_16x16x32_bf16 v[192:195], v[32:35], v[104:107], v[192:195]
  ds_read_b128 v[124:127], v12 offset:8192
  ds_read_b128 v[140:143], v12 offset:9216
  v_mfma_f32_16x16x32_bf16 v[196:199], v[36:39], v[104:107], v[196:199]
  v_mfma_f32_16x16x32_bf16 v[196:199], v[148:151], v[92:95], v[196:199]
  ds_read_b128 v[136:139], v12 offset:10240
  ds_read_b128 v[120:123], v12 offset:11264
  v_mfma_f32_16x16x32_bf16 v[200:203], v[152:155], v[92:95], v[200:203]
  v_mfma_f32_16x16x32_bf16 v[200:203], v[160:163], v[104:107], v[200:203]
  buffer_load_dwordx4 v[116:119], v1, s[12:15], s79 offen offset:3072 sc1
  v_mfma_f32_16x16x32_bf16 v[204:207], v[16:19], v[104:107], v[204:207]
  v_mfma_f32_16x16x32_bf16 v[204:207], v[156:159], v[92:95], v[204:207]
  s_waitcnt lgkmcnt(0)
  s_bitcmp0_b32 s89, 22
  s_cbranch_scc0 L_sr_144
L_sp_143:
  s_add_u32 s86, s86, 1
  s_cmp_gt_u32 s86, 1048576
  s_cbranch_scc1 L_sr_144
  s_mov_b32 s89, 0
  s_atomic_add s89, s[98:99], 0 glc
  s_waitcnt lgkmcnt(0)
  s_bitcmp0_b32 s89, 22
  s_cbranch_scc1 L_sp_143
L_sr_144:
  s_add_u32 s79, s79, 4096
  buffer_load_dwordx4 v[132:135], v1, s[12:15], s79 offen offset:0 sc1
  s_waitcnt vmcnt(8)
  v_mfma_f32_16x16x32_bf16 v[220:223], v[156:159], v[88:91], v[220:223]
  v_mfma_f32_16x16x32_bf16 v[220:223], v[16:19], v[100:103], v[220:223]
  buffer_load_dwordx4 v[40:43], v1, s[12:15], s80 offen offset:3072 sc1
  v_mfma_f32_16x16x32_bf16 v[216:219], v[160:163], v[100:103], v[216:219]
  v_mfma_f32_16x16x32_bf16 v[216:219], v[152:155], v[88:91], v[216:219]
  s_bitcmp1_b32 s89, 30
  s_cbranch_scc1 L_np_149
  s_mov_b32 s89, 0
  s_atomic_add s89, s[98:99], 0 glc
L_np_149:
  buffer_load_dwordx4 v[128:131], v1, s[12:15], s79 offen offset:1024 sc1
  v_mfma_f32_16x16x32_bf16 v[212:215], v[148:151], v[88:91], v[212:215]
  v_mfma_f32_16x16x32_bf16 v[212:215], v[36:39], v[100:103], v[212:215]
  buffer_load_dwordx4 v[48:51], v1, s[12:15], s79 offen offset:2048 sc1
  v_mfma_f32_16x16x32_bf16 v[208:211], v[32:35], v[100:103], v[208:211]
  v_mfma_f32_16x16x32_bf16 v[208:211], v[144:147], v[88:91], v[208:211]
  s_add_u32 s80, s80, 4096
  buffer_load_dwordx4 v[112:115], v1, s[12:15], s80 offen offset:0 sc1
  s_waitcnt vmcnt(9)
  v_mfma_f32_16x16x32_bf16 v[224:227], v[144:147], v[180:183], v[224:227]
  v_mfma_f32_16x16x32_bf16 v[224:227], v[32:35], v[52:55], v[224:227]
  ds_read_b128 v[104:107], v12 offset:12288
  ds_read_b128 v[92:95], v12 offset:13312
  v_mfma_f32_16x16x32_bf16 v[228:231], v[36:39], v[52:55], v[228:231]
  v_mfma_f32_16x16x32_bf16 v[228:231], v[148:151], v[180:183], v[228:231]
  ds_read_b128 v[100:103], v12 offset:14336
  ds_read_b128 v[88:91], v12 offset:15360
  v_mfma_f32_16x16x32_bf16 v[232:235], v[152:155], v[180:183], v[232:235]
  v_mfma_f32_16x16x32_bf16 v[232:235], v[160:163], v[52:55], v[232:235]
  v_mfma_f32_16x16x32_bf16 v[236:239], v[16:19], v[52:55], v[236:239]
  v_mfma_f32_16x16x32_bf16 v[236:239], v[156:159], v[180:183], v[236:239]
  buffer_load_dwordx4 v[52:55], v1, s[12:15], s79 offen offset:3072 sc1
  s_waitcnt vmcnt(6)
  v_mfma_f32_16x16x32_bf16 v[252:255], v[156:159], v[64:67], v[252:255]
  v_mfma_f32_16x16x32_bf16 v[252:255], v[16:19], v[116:119], v[252:255]
  buffer_load_dwordx4 v[180:183], v1, s[12:15], s80 offen offset:1024 sc1
  v_mfma_f32_16x16x32_bf16 v[248:251], v[160:163], v[116:119], v[248:251]
  v_mfma_f32_16x16x32_bf16 v[248:251], v[152:155], v[64:67], v[248:251]
  s_add_u32 s79, s79, 4096
  buffer_load_dwordx4 v[156:159], v1, s[12:15], s79 offen offset:0 sc1
  v_mfma_f32_16x16x32_bf16 v[244:247], v[148:151], v[64:67], v[244:247]
  v_mfma_f32_16x16x32_bf16 v[244:247], v[36:39], v[116:119], v[244:247]
  buffer_load_dwordx4 v[16:19], v1, s[12:15], s79 offen offset:1024 sc1
  v_mfma_f32_16x16x32_bf16 v[240:243], v[32:35], v[116:119], v[240:243]
  v_mfma_f32_16x16x32_bf16 v[240:243], v[144:147], v[64:67], v[240:243]
  buffer_load_dwordx4 v[160:163], v1, s[12:15], s80 offen offset:2048 sc1
  s_waitcnt vmcnt(7)
  v_mfma_f32_16x16x32_bf16 v[192:195], v[176:179], v[132:135], v[192:195]
  v_mfma_f32_16x16x32_bf16 v[192:195], v[124:127], v[128:131], v[192:195]
  buffer_load_dwordx4 v[152:155], v1, s[12:15], s79 offen offset:2048 sc1
  v_mfma_f32_16x16x32_bf16 v[196:199], v[140:143], v[128:131], v[196:199]
  v_mfma_f32_16x16x32_bf16 v[196:199], v[96:99], v[132:135], v[196:199]
  buffer_load_dwordx4 v[148:151], v1, s[12:15], s80 offen offset:3072 sc1
  v_mfma_f32_16x16x32_bf16 v[200:203], v[168:171], v[132:135], v[200:203]
  v_mfma_f32_16x16x32_bf16 v[200:203], v[136:139], v[128:131], v[200:203]
  buffer_load_dwordx4 v[36:39], v1, s[12:15], s79 offen offset:3072 sc1
  v_mfma_f32_16x16x32_bf16 v[204:207], v[120:123], v[128:131], v[204:207]
  v_mfma_f32_16x16x32_bf16 v[204:207], v[80:83], v[132:135], v[204:207]
  s_waitcnt lgkmcnt(0)
  s_bitcmp0_b32 s89, 26
  s_cbranch_scc0 L_sr_146
L_sp_145:
  s_add_u32 s86, s86, 1
  s_cmp_gt_u32 s86, 1048576
  s_cbranch_scc1 L_sr_146
  s_mov_b32 s89, 0
  s_atomic_add s89, s[98:99], 0 glc
  s_waitcnt lgkmcnt(0)
  s_bitcmp0_b32 s89, 26
  s_cbranch_scc1 L_sp_145
L_sr_146:
  s_add_u32 s79, s79, 4096
  buffer_load_dwordx4 v[116:119], v1, s[12:15], s79 offen offset:0 sc1
  s_waitcnt vmcnt(8)
  v_mfma_f32_16x16x32_bf16 v[220:223], v[80:83], v[48:51], v[220:223]
  v_mfma_f32_16x16x32_bf16 v[220:223], v[120:123], v[52:55], v[220:223]
  buffer_load_dwordx4 v[32:35], v1, s[12:15], s79 offen offset:1024 sc1
  v_mfma_f32_16x16x32_bf16 v[216:219], v[136:139], v[52:55], v[216:219]
  v_mfma_f32_16x16x32_bf16 v[216:219], v[168:171], v[48:51], v[216:219]
  s_bitcmp0_b32 s89, 30
  s_cbranch_scc0 L_sr_148
L_sp_147:
  s_add_u32 s86, s86, 1
  s_cmp_gt_u32 s86, 1048576
  s_cbranch_scc1 L_sr_148
  s_mov_b32 s89, 0
  s_atomic_add s89, s[98:99], 0 glc
  s_waitcnt lgkmcnt(0)
  s_bitcmp0_b32 s89, 30
  s_cbranch_scc1 L_sp_147
L_sr_148:
  s_add_u32 s79, s79, 8192
  buffer_load_dwordx4 v[64:67], v1, s[12:15], s79 offen offset:0 sc1
  v_mfma_f32_16x16x32_bf16 v[212:215], v[96:99], v[48:51], v[212:215]
  v_mfma_f32_16x16x32_bf16 v[212:215], v[140:143], v[52:55], v[212:215]
  buffer_load_dwordx4 v[144:147], v1, s[12:15], s79 offen offset:1024 sc1
  v_mfma_f32_16x16x32_bf16 v[208:211], v[124:127], v[52:55], v[208:211]
  v_mfma_f32_16x16x32_bf16 v[208:211], v[176:179], v[48:51], v[208:211]
  buffer_load_dwordx4 v[128:131], v1, s[12:15], s79 offen offset:2048 sc1
  s_waitcnt vmcnt(9)
  v_mfma_f32_16x16x32_bf16 v[224:227], v[176:179], v[156:159], v[224:227]
  v_mfma_f32_16x16x32_bf16 v[224:227], v[124:127], v[16:19], v[224:227]
  buffer_load_dwordx4 v[132:135], v1, s[12:15], s79 offen offset:3072 sc1
  v_mfma_f32_16x16x32_bf16 v[228:231], v[140:143], v[16:19], v[228:231]
  v_mfma_f32_16x16x32_bf16 v[228:231], v[96:99], v[156:159], v[228:231]
  s_sub_u32 s79, s79, 8192
  buffer_load_dwordx4 v[52:55], v1, s[12:15], s79 offen offset:2048 sc1
  v_mfma_f32_16x16x32_bf16 v[232:235], v[168:171], v[156:159], v[232:235]
  v_mfma_f32_16x16x32_bf16 v[232:235], v[136:139], v[16:19], v[232:235]
  buffer_load_dwordx4 v[48:51], v1, s[12:15], s79 offen offset:3072 sc1
  v_mfma_f32_16x16x32_bf16 v[236:239], v[120:123], v[16:19], v[236:239]
  v_mfma_f32_16x16x32_bf16 v[236:239], v[80:83], v[156:159], v[236:239]
  s_add_u32 s79, s79, 12288
  buffer_load_dwordx4 v[16:19], v1, s[12:15], s79 offen offset:0 sc1
  s_waitcnt vmcnt(9)
  v_mfma_f32_16x16x32_bf16 v[252:255], v[80:83], v[152:155], v[252:255]
  v_mfma_f32_16x16x32_bf16 v[252:255], v[120:123], v[36:39], v[252:255]
  buffer_load_dwordx4 v[156:159], v1, s[12:15], s79 offen offset:1024 sc1
  v_mfma_f32_16x16x32_bf16 v[248:251], v[136:139], v[36:39], v[248:251]
  v_mfma_f32_16x16x32_bf16 v[248:251], v[168:171], v[152:155], v[248:251]
  buffer_load_dwordx4 v[80:83], v1, s[12:15], s79 offen offset:2048 sc1
  v_mfma_f32_16x16x32_bf16 v[244:247], v[96:99], v[152:155], v[244:247]
  v_mfma_f32_16x16x32_bf16 v[244:247], v[140:143], v[36:39], v[244:247]
  buffer_load_dwordx4 v[120:123], v1, s[12:15], s79 offen offset:3072 sc1
  v_mfma_f32_16x16x32_bf16 v[240:243], v[124:127], v[36:39], v[240:243]
  v_mfma_f32_16x16x32_bf16 v[240:243], v[176:179], v[152:155], v[240:243]
  s_sub_u32 s79, s79, 8192
  buffer_load_dwordx4 v[136:139], v1, s[12:15], s79 offen offset:0 sc1
  s_waitcnt vmcnt(11)
  v_mfma_f32_16x16x32_bf16 v[192:195], v[104:107], v[116:119], v[192:195]
  v_mfma_f32_16x16x32_bf16 v[192:195], v[24:27], v[32:35], v[192:195]
  buffer_load_dwordx4 v[168:171], v1, s[12:15], s79 offen offset:1024 sc1
  v_mfma_f32_16x16x32_bf16 v[196:199], v[188:191], v[32:35], v[196:199]
  v_mfma_f32_16x16x32_bf16 v[196:199], v[92:95], v[116:119], v[196:199]
  v_mfma_f32_16x16x32_bf16 v[200:203], v[100:103], v[116:119], v[200:203]
  v_mfma_f32_16x16x32_bf16 v[200:203], v[184:187], v[32:35], v[200:203]
  v_mfma_f32_16x16x32_bf16 v[204:207], v[164:167], v[32:35], v[204:207]
  v_mfma_f32_16x16x32_bf16 v[204:207], v[88:91], v[116:119], v[204:207]
  s_add_u32 s79, s79, 12288
  buffer_load_dwordx4 v[96:99], v1, s[12:15], s79 offen offset:0 sc1
  s_waitcnt vmcnt(11)
  v_mfma_f32_16x16x32_bf16 v[192:195], v[172:175], v[64:67], v[192:195]
  v_mfma_f32_16x16x32_bf16 v[192:195], v[28:31], v[144:147], v[192:195]
  buffer_load_dwordx4 v[140:143], v1, s[12:15], s79 offen offset:1024 sc1
  v_mfma_f32_16x16x32_bf16 v[196:199], v[20:23], v[144:147], v[196:199]
  v_mfma_f32_16x16x32_bf16 v[196:199], v[60:63], v[64:67], v[196:199]
  v_mfma_f32_16x16x32_bf16 v[200:203], v[56:59], v[64:67], v[200:203]
  v_mfma_f32_16x16x32_bf16 v[200:203], v[108:111], v[144:147], v[200:203]
  v_mfma_f32_16x16x32_bf16 v[204:207], v[84:87], v[144:147], v[204:207]
  v_mfma_f32_16x16x32_bf16 v[204:207], v[68:71], v[64:67], v[204:207]
  buffer_load_dwordx4 v[36:39], v1, s[12:15], s79 offen offset:2048 sc1
  s_waitcnt vmcnt(11)
  v_mfma_f32_16x16x32_bf16 v[192:195], v[76:79], v[128:131], v[192:195]
  v_mfma_f32_16x16x32_bf16 v[192:195], v[112:115], v[132:135], v[192:195]
  buffer_load_dwordx4 v[124:127], v1, s[12:15], s79 offen offset:3072 sc1
  v_mfma_f32_16x16x32_bf16 v[196:199], v[180:183], v[132:135], v[196:199]
  v_mfma_f32_16x16x32_bf16 v[196:199], v[72:75], v[128:131], v[196:199]
  v_mfma_f32_16x16x32_bf16 v[200:203], v[44:47], v[128:131], v[200:203]
  v_mfma_f32_16x16x32_bf16 v[200:203], v[160:163], v[132:135], v[200:203]
  v_mfma_f32_16x16x32_bf16 v[204:207], v[148:151], v[132:135], v[204:207]
  v_mfma_f32_16x16x32_bf16 v[204:207], v[40:43], v[128:131], v[204:207]
  s_sub_u32 s79, s79, 12288
  buffer_load_dwordx4 v[152:155], v1, s[12:15], s79 offen offset:2048 sc1
  s_waitcnt vmcnt(11)
  v_mfma_f32_16x16x32_bf16 v[208:211], v[104:107], v[52:55], v[208:211]
  v_mfma_f32_16x16x32_bf16 v[208:211], v[24:27], v[48:51], v[208:211]
  ds_write_b128 v8, v[192:195] offset:0
  buffer_load_dwordx4 v[176:179], v1, s[12:15], s79 offen offset:3072 sc1
  v_mfma_f32_16x16x32_bf16 v[212:215], v[188:191], v[48:51], v[212:215]
  v_mfma_f32_16x16x32_bf16 v[212:215], v[92:95], v[52:55], v[212:215]
  ds_write_b128 v9, v[196:199] offset:0
  v_mfma_f32_16x16x32_bf16 v[216:219], v[100:103], v[52:55], v[216:219]
  v_mfma_f32_16x16x32_bf16 v[216:219], v[184:187], v[48:51], v[216:219]
  ds_write_b128 v10, v[200:203] offset:0
  v_mfma_f32_16x16x32_bf16 v[220:223], v[164:167], v[48:51], v[220:223]
  v_mfma_f32_16x16x32_bf16 v[220:223], v[88:91], v[52:55], v[220:223]
  ds_write_b128 v11, v[204:207] offset:0
  ds_write_b32 v2, v3 offset:12
  s_add_u32 s79, s79, 16384
  buffer_load_dwordx4 v[32:35], v1, s[12:15], s79 offen offset:0 sc1
  s_waitcnt vmcnt(11)
  v_mfma_f32_16x16x32_bf16 v[208:211], v[172:175], v[16:19], v[208:211]
  v_mfma_f32_16x16x32_bf16 v[208:211], v[28:31], v[156:159], v[208:211]
  buffer_load_dwordx4 v[116:119], v1, s[12:15], s79 offen offset:1024 sc1
  v_mfma_f32_16x16x32_bf16 v[212:215], v[20:23], v[156:159], v[212:215]
  v_mfma_f32_16x16x32_bf16 v[212:215], v[60:63], v[16:19], v[212:215]
  v_mfma_f32_16x16x32_bf16 v[216:219], v[56:59], v[16:19], v[216:219]
  v_mfma_f32_16x16x32_bf16 v[216:219], v[108:111], v[156:159], v[216:219]
  v_mfma_f32_16x16x32_bf16 v[220:223], v[84:87], v[156:159], v[220:223]
  v_mfma_f32_16x16x32_bf16 v[220:223], v[68:71], v[16:19], v[220:223]
  buffer_load_dwordx4 v[144:147], v1, s[12:15], s79 offen offset:2048 sc1
  s_waitcnt vmcnt(11)
  v_mfma_f32_16x16x32_bf16 v[208:211], v[76:79], v[80:83], v[208:211]
  v_mfma_f32_16x16x32_bf16 v[208:211], v[112:115], v[120:123], v[208:211]
  buffer_load_dwordx4 v[64:67], v1, s[12:15], s79 offen offset:3072 sc1
  v_mfma_f32_16x16x32_bf16 v[212:215], v[180:183], v[120:123], v[212:215]
  v_mfma_f32_16x16x32_bf16 v[212:215], v[72:75], v[80:83], v[212:215]
  v_mfma_f32_16x16x32_bf16 v[216:219], v[44:47], v[80:83], v[216:219]
  v_mfma_f32_16x16x32_bf16 v[216:219], v[160:163], v[120:123], v[216:219]
  v_mfma_f32_16x16x32_bf16 v[220:223], v[148:151], v[120:123], v[220:223]
  v_mfma_f32_16x16x32_bf16 v[220:223], v[40:43], v[80:83], v[220:223]
  s_waitcnt vmcnt(10)
  v_mfma_f32_16x16x32_bf16 v[224:227], v[104:107], v[136:139], v[224:227]
  v_mfma_f32_16x16x32_bf16 v[224:227], v[24:27], v[168:171], v[224:227]
  ds_write_b128 v8, v[208:211] offset:4096
  v_mfma_f32_16x16x32_bf16 v[228:231], v[188:191], v[168:171], v[228:231]
  v_mfma_f32_16x16x32_bf16 v[228:231], v[92:95], v[136:139], v[228:231]
  ds_write_b128 v9, v[212:215] offset:4096
  v_mfma_f32_16x16x32_bf16 v[232:235], v[100:103], v[136:139], v[232:235]
  v_mfma_f32_16x16x32_bf16 v[232:235], v[184:187], v[168:171], v[232:235]
  ds_write_b128 v10, v[216:219] offset:4096
  v_mfma_f32_16x16x32_bf16 v[236:239], v[164:167], v[168:171], v[236:239]
  v_mfma_f32_16x16x32_bf16 v[236:239], v[88:91], v[136:139], v[236:239]
  ds_write_b128 v11, v[220:223] offset:4096
  ds_write_b32 v2, v3 offset:8
  s_waitcnt vmcnt(8)
  v_mfma_f32_16x16x32_bf16 v[224:227], v[172:175], v[96:99], v[224:227]
  v_mfma_f32_16x16x32_bf16 v[224:227], v[28:31], v[140:143], v[224:227]
  v_mfma_f32_16x16x32_bf16 v[228:231], v[20:23], v[140:143], v[228:231]
  v_mfma_f32_16x16x32_bf16 v[228:231], v[60:63], v[96:99], v[228:231]
  v_mfma_f32_16x16x32_bf16 v[232:235], v[56:59], v[96:99], v[232:235]
  v_mfma_f32_16x16x32_bf16 v[232:235], v[108:111], v[140:143], v[232:235]
  v_mfma_f32_16x16x32_bf16 v[236:239], v[84:87], v[140:143], v[236:239]
  v_mfma_f32_16x16x32_bf16 v[236:239], v[68:71], v[96:99], v[236:239]
  s_waitcnt vmcnt(6)
  v_mfma_f32_16x16x32_bf16 v[224:227], v[76:79], v[36:39], v[224:227]
  v_mfma_f32_16x16x32_bf16 v[224:227], v[112:115], v[124:127], v[224:227]
  v_mfma_f32_16x16x32_bf16 v[228:231], v[180:183], v[124:127], v[228:231]
  v_mfma_f32_16x16x32_bf16 v[228:231], v[72:75], v[36:39], v[228:231]
  v_mfma_f32_16x16x32_bf16 v[232:235], v[44:47], v[36:39], v[232:235]
  v_mfma_f32_16x16x32_bf16 v[232:235], v[160:163], v[124:127], v[232:235]
  v_mfma_f32_16x16x32_bf16 v[236:239], v[148:151], v[124:127], v[236:239]
  v_mfma_f32_16x16x32_bf16 v[236:239], v[40:43], v[36:39], v[236:239]
  s_waitcnt vmcnt(3)
  v_mfma_f32_16x16x32_bf16 v[240:243], v[104:107], v[152:155], v[240:243]
  v_mfma_f32_16x16x32_bf16 v[240:243], v[24:27], v[176:179], v[240:243]
  v_mfma_f32_16x16x32_bf16 v[240:243], v[172:175], v[32:35], v[240:243]
  ds_write_b128 v8, v[224:227] offset:8192
  v_mfma_f32_16x16x32_bf16 v[244:247], v[60:63], v[32:35], v[244:247]
  v_mfma_f32_16x16x32_bf16 v[244:247], v[188:191], v[176:179], v[244:247]
  v_mfma_f32_16x16x32_bf16 v[244:247], v[92:95], v[152:155], v[244:247]
  ds_write_b128 v9, v[228:231] offset:8192
  v_mfma_f32_16x16x32_bf16 v[248:251], v[100:103], v[152:155], v[248:251]
  v_mfma_f32_16x16x32_bf16 v[248:251], v[184:187], v[176:179], v[248:251]
  v_mfma_f32_16x16x32_bf16 v[248:251], v[56:59], v[32:35], v[248:251]
  ds_write_b128 v10, v[232:235] offset:8192
  v_mfma_f32_16x16x32_bf16 v[252:255], v[68:71], v[32:35], v[252:255]
  v_mfma_f32_16x16x32_bf16 v[252:255], v[164:167], v[176:179], v[252:255]
  v_mfma_f32_16x16x32_bf16 v[252:255], v[88:91], v[152:155], v[252:255]
  ds_write_b128 v11, v[236:239] offset:8192
  ds_write_b32 v2, v3 offset:4
  s_waitcnt vmcnt(0)
  v_mfma_f32_16x16x32_bf16 v[240:243], v[28:31], v[116:119], v[240:243]
  v_mfma_f32_16x16x32_bf16 v[240:243], v[76:79], v[144:147], v[240:243]
  v_mfma_f32_16x16x32_bf16 v[240:243], v[112:115], v[64:67], v[240:243]
  v_mfma_f32_16x16x32_bf16 v[244:247], v[180:183], v[64:67], v[244:247]
  v_mfma_f32_16x16x32_bf16 v[244:247], v[72:75], v[144:147], v[244:247]
  v_mfma_f32_16x16x32_bf16 v[244:247], v[20:23], v[116:119], v[244:247]
  v_mfma_f32_16x16x32_bf16 v[248:251], v[108:111], v[116:119], v[248:251]
  v_mfma_f32_16x16x32_bf16 v[248:251], v[44:47], v[144:147], v[248:251]
  v_mfma_f32_16x16x32_bf16 v[248:251], v[160:163], v[64:67], v[248:251]
  v_mfma_f32_16x16x32_bf16 v[252:255], v[148:151], v[64:67], v[252:255]
  v_mfma_f32_16x16x32_bf16 v[252:255], v[40:43], v[144:147], v[252:255]
  v_mfma_f32_16x16x32_bf16 v[252:255], v[84:87], v[116:119], v[252:255]
  ds_write_b128 v8, v[240:243] offset:12288
  s_nop 0
  ds_write_b128 v9, v[244:247] offset:12288
  s_nop 1
  ds_write_b128 v10, v[248:251] offset:12288
  s_nop 1
  ds_write_b128 v11, v[252:255] offset:12288
  ds_write_b32 v2, v3 offset:0
  s_endpgm
L_lp_26:
  s_add_u32 s86, s86, 1
  s_cmp_gt_u32 s86, 1048576
  s_cbranch_scc1 L_lr_27
  ds_read_b32 v6, v4 offset:1384
  s_waitcnt lgkmcnt(0)
  v_cmp_ne_u32 vcc, 0, v6
  s_cbranch_vccnz L_lp_26
  s_branch L_lr_27
L_lp_28:
  s_add_u32 s86, s86, 1
  s_cmp_gt_u32 s86, 1048576
  s_cbranch_scc1 L_lr_29
  ds_read_b32 v6, v4 offset:1380
  s_waitcnt lgkmcnt(0)
  v_cmp_ne_u32 vcc, 0, v6
  s_cbranch_vccnz L_lp_28
  s_branch L_lr_29
L_lp_30:
  s_add_u32 s86, s86, 1
  s_cmp_gt_u32 s86, 1048576
  s_cbranch_scc1 L_lr_31
  ds_read_b32 v6, v4 offset:1376
  s_waitcnt lgkmcnt(0)
  v_cmp_ne_u32 vcc, 0, v6
  s_cbranch_vccnz L_lp_30
  s_branch L_lr_31
L_lp_32:
  s_add_u32 s86, s86, 1
  s_cmp_gt_u32 s86, 1048576
  s_cbranch_scc1 L_lr_33
  ds_read_b32 v6, v4 offset:1368
  s_waitcnt lgkmcnt(0)
  v_cmp_ne_u32 vcc, 0, v6
  s_cbranch_vccnz L_lp_32
  s_branch L_lr_33
L_lp_34:
  s_add_u32 s86, s86, 1
  s_cmp_gt_u32 s86, 1048576
  s_cbranch_scc1 L_lr_35
  ds_read_b32 v6, v4 offset:1360
  s_waitcnt lgkmcnt(0)
  v_cmp_ne_u32 vcc, 0, v6
  s_cbranch_vccnz L_lp_34
  s_branch L_lr_35
L_lp_41:
  s_add_u32 s86, s86, 1
  s_cmp_gt_u32 s86, 1048576
  s_cbranch_scc1 L_lr_42
  ds_read_b32 v6, v4 offset:1384
  s_waitcnt lgkmcnt(0)
  v_cmp_ne_u32 vcc, 0, v6
  s_cbranch_vccnz L_lp_41
  s_branch L_lr_42
L_lp_43:
  s_add_u32 s86, s86, 1
  s_cmp_gt_u32 s86, 1048576
  s_cbranch_scc1 L_lr_44
  ds_read_b32 v6, v4 offset:1380
  s_waitcnt lgkmcnt(0)
  v_cmp_ne_u32 vcc, 0, v6
  s_cbranch_vccnz L_lp_43
  s_branch L_lr_44
L_lp_45:
  s_add_u32 s86, s86, 1
  s_cmp_gt_u32 s86, 1048576
  s_cbranch_scc1 L_lr_46
  ds_read_b32 v6, v4 offset:1376
  s_waitcnt lgkmcnt(0)
  v_cmp_ne_u32 vcc, 0, v6
  s_cbranch_vccnz L_lp_45
  s_branch L_lr_46
L_lp_47:
  s_add_u32 s86, s86, 1
  s_cmp_gt_u32 s86, 1048576
  s_cbranch_scc1 L_lr_48
  ds_read_b32 v6, v4 offset:1368
  s_waitcnt lgkmcnt(0)
  v_cmp_ne_u32 vcc, 0, v6
  s_cbranch_vccnz L_lp_47
  s_branch L_lr_48
L_ip_66:
  s_add_u32 s86, s86, 1
  s_cmp_gt_u32 s86, 1048576
  s_cbranch_scc1 L_ir_67
  buffer_load_dword v254, v29, s[28:31], 0 offen sc1
  s_waitcnt vmcnt(0)
  v_cmp_gt_u32 vcc, 8, v254
  s_cbranch_vccnz L_ip_66
  s_branch L_ir_67
L_ip_114:
  s_add_u32 s86, s86, 1
  s_cmp_gt_u32 s86, 1048576
  s_cbranch_scc1 L_ir_115
  buffer_load_dword v254, v29, s[28:31], 0 offen sc1
  s_waitcnt vmcnt(0)
  v_cmp_gt_u32 vcc, 8, v254
  s_cbranch_vccnz L_ip_114
  s_branch L_ir_115
L_end:
  s_endpgm
L_code_end:
.section .rodata,"a"
.p2align 6
.amdhsa_kernel parallel_sum__linear_attn_block__dense_activation_mish__prompt_kernel
  .amdhsa_next_free_vgpr 256
  .amdhsa_next_free_sgpr 102
  .amdhsa_accum_offset 256
  .amdhsa_group_segment_fixed_size 0
  .amdhsa_kernarg_size 80
  .amdhsa_user_sgpr_count 2
  .amdhsa_user_sgpr_kernarg_segment_ptr 1
  .amdhsa_system_sgpr_workgroup_id_x 1
.end_amdhsa_kernel
```
